```python
import torch

def _softmax(x, axis=-1):
    return torch.softmax(x, dim=axis)
def _gelu(x):
    return torch.nn.functional.gelu(x, approximate="tanh")
def _silu(x):
    return torch.nn.functional.silu(x)
def _sigmoid(x):
    return torch.sigmoid(x)
def _layernorm(x, axis=-1, eps=1e-5):
    m = x.mean(dim=axis, keepdim=True)
    v = x.var(dim=axis, keepdim=True, unbiased=False)
    return (x - m) / torch.sqrt(v + eps)
def _scatter_add(tgt, idx, src, axis=0):
    return tgt.clone().index_add_(axis, idx, src)
def _segment_sum(src, seg, n):
    out = torch.zeros((n,) + src.shape[1:], dtype=src.dtype)
    return out.index_add_(0, seg, src)
def _pad(x, pw):
    flat = tuple(v for pair in reversed(pw) for v in pair)
    return torch.nn.functional.pad(x, flat)

kernel_name = 'recurrent_scan__linear_attn_block__dense_activation_squared_relu__prompt'

def setup_inputs():

    _w = (lambda a: (lambda t: t.to(torch.bfloat16) if t.is_floating_point() else t)(torch.as_tensor(a)))
    def _A_setup():
        B, S, D = 1, 2048, 512
        return {
            "x": _w((lambda *s: torch.randn(*s, dtype=torch.bfloat16) * 0.05)(B, S, D)),
            "wqkv": _w((lambda *s: torch.randn(*s, dtype=torch.bfloat16) * 0.05)(D, 3 * D)),
            "wo": _w((lambda *s: torch.randn(*s, dtype=torch.bfloat16) * 0.05)(D, D)),
        }
    _A_in = _A_setup()

    def _B_setup():
        B, S, D, F = 1, 2048, 512, 1792
        return {
            "x": _w((lambda *s: torch.randn(*s, dtype=torch.bfloat16) * 0.05)(B, S, D)),
            "w1": _w((lambda *s: torch.randn(*s, dtype=torch.bfloat16) * 0.05)(D, F)),
            "b1": _w((lambda *s: torch.randn(*s, dtype=torch.bfloat16) * 0.2)(F)),
            "w2": _w((lambda *s: torch.randn(*s, dtype=torch.bfloat16) * 0.05)(F, D)),
            "b2": _w((lambda *s: torch.randn(*s, dtype=torch.bfloat16) * 1.6)(D)),
        }
    _B_in = _B_setup()

    return {
        "A_x": _A_in["x"],
        "A_wqkv": _A_in["wqkv"],
        "A_wo": _A_in["wo"],
        "B_x": _B_in["x"],
        "B_w1": _B_in["w1"],
        "B_b1": _B_in["b1"],
        "B_w2": _B_in["w2"],
        "B_b2": _B_in["b2"],
    }

def reference(A_x, A_wqkv, A_wo, B_x, B_w1, B_b1, B_w2, B_b2):
    def _A_ref(x, wqkv, wo):
        B, S, D = x.shape
        H = 32; Dh = D // H
        qkv = (lambda x, *d: x.permute(*d))((x @ wqkv).reshape(B, S, 3, H, Dh), 2, 0, 3, 1, 4)
        q, k, v = qkv[0], qkv[1], qkv[2]
        phi = lambda t: torch.where(t > 0, t + 1, torch.exp(t)) + 1e-6
        pq, pk = phi(q), phi(k)
        kv = torch.einsum("bhsd,bhse->bhde", pk, v)
        z = torch.einsum("bhsd->bhd", pk)
        num = torch.einsum("bhqd,bhde->bhqe", pq, kv)
        den = torch.einsum("bhqd,bhd->bhq", pq, z)[..., None] + 1e-6
        o = num / den
        return (lambda x, *d: x.permute(*d))(o, 0, 2, 1, 3).reshape(B, S, D) @ wo

    def _B_ref(x, w1, b1, w2, b2):
        h = torch.einsum("bsd,df->bsf", x, w1) + b1
        zero = torch.zeros_like(h)
        r = torch.where(h > zero, h, zero)
        h = r * r
        out = torch.einsum("bsf,fd->bsd", h, w2) + b2
        return out

    x = A_x
    xn = _layernorm(x, axis=-1)
    s = _A_ref(xn, A_wqkv, A_wo)
    g = _silu(_B_ref(xn, B_w1, B_b1, B_w2, B_b2))
    return x + s * g
```

```asm
; @launch grid=(256,1,1) block=(256,1,1) lds=163840
.amdgcn_target "amdgcn-amd-amdhsa--gfx950"
.text
.globl recurrent_scan__linear_attn_block__dense_activation_squared_relu__prompt_kernel
.p2align 8
.type recurrent_scan__linear_attn_block__dense_activation_squared_relu__prompt_kernel,@function
recurrent_scan__linear_attn_block__dense_activation_squared_relu__prompt_kernel:
	s_cmp_ge_u32 s2, 256
	s_cbranch_scc1 L_exit
	s_load_dwordx2 s[4:5], s[0:1], 0
	s_load_dwordx16 s[64:79], s[0:1], 0
	s_getpc_b64 s[96:97]
L_pc:
	s_lshr_b32 s59, s2, 3
	v_lshrrev_b32 v3, 6, v0
	s_and_b32 s56, s59, 3
	s_lshl_b32 s56, s56, 15
	v_readfirstlane_b32 s40, v3
	v_lshl_add_u32 v2, v0, 7, s56
	v_min_u32 v2, L_last-L_pc-4, v2
	v_and_b32 v0, 63, v0
	global_load_dword v195, v2, s[96:97]
	s_and_b32 s58, s2, 7
	s_and_b32 s56, s59, 7
	s_lshr_b32 s41, s58, 2
	s_lshl3_add_u32 s41, s41, s56
	s_lshr_b32 s57, s59, 3
	s_lshl1_add_u32 s43, s57, s56
	s_add_u32 s43, s43, s58
	s_and_b32 s43, s43, 7
	v_lshrrev_b32 v32, 3, v0
	v_and_b32 v33, 7, v0
	v_lshrrev_b32 v34, 4, v0
	v_xor_b32 v35, v33, v34
	v_lshlrev_b32 v35, 4, v35
	v_lshl_add_u32 v2, v32, 10, v35
	v_xor_b32 v36, 64, v2
	v_add_u32 v3, 7168, v36
	v_add_u32 v4, 14336, v2
	v_add_u32 v5, 21504, v36
	s_lshl2_add_u32 s62, s41, s40
	s_lshl_b32 s47, s62, 15
	s_lshl_b32 s52, s40, 14
	s_add_u32 s52, s52, 65536
	s_mov_b32 m0, s52
	s_lshl_b32 s48, s43, 7
	s_add_u32 s48, s48, s47
	s_mov_b32 s6, 2097152
	s_mov_b32 s7, 0x20000
	s_waitcnt lgkmcnt(0)
	buffer_load_dwordx4 v2, s[4:7], s48 offen offset:0 lds
	buffer_load_dwordx4 v3, s[4:7], s48 offen offset:1024 lds
	buffer_load_dwordx4 v4, s[4:7], s48 offen offset:2048 lds
	buffer_load_dwordx4 v5, s[4:7], s48 offen offset:3072 lds
L_first:
	s_load_dwordx4 s[80:83], s[0:1], 64
	s_load_dwordx2 s[84:85], s[0:1], 80
	s_lshr_b32 s63, s57, 1
	s_and_b32 s42, s58, 3
	s_and_b32 s57, s57, 1
	s_lshl1_add_u32 s42, s42, s57
	s_lshl3_add_u32 s56, s63, s42
	s_lshl4_add_u32 s56, s41, s56
	s_lshl2_add_u32 s98, s56, s40
	v_lshlrev_b32_e64 v1, 4, v0
	s_or_b32 s3, s2, s40
	s_cmp_lg_u32 s3, 0
	s_cbranch_scc1 L_ep1
	s_waitcnt lgkmcnt(0)
	s_mov_b32 s20, s84
	s_mov_b32 s21, s85
	s_mov_b32 s22, 10059904
	s_mov_b32 s23, 0x20000
	s_mov_b32 s3, 10059776
	buffer_load_dword v194, off, s[20:23], s3 sc1
L_ep1:
	s_lshl_b32 s56, s98, L_end-L_exit-4+11
	buffer_load_dwordx4 v[208:211], v1, s[4:7], s56 offen
	buffer_load_dwordx4 v[212:215], v1, s[4:7], s56 offen offset:1024
	s_movk_i32 s46, 3072
	s_cmp_eq_u32 s63, 0
	s_cselect_b32 s46, s46, 3584
	s_cselect_b32 s8, s66, s72
	s_cselect_b32 s9, s67, s73
	s_mov_b32 s10, 1572864
	s_cselect_b32 s10, s10, 1835008
	s_mov_b32 s11, 0x20000
	v_and_b32 v35, 16, v0
	v_lshrrev_b32 v35, 2, v35
	v_xor_b32 v35, v33, v35
	v_lshlrev_b32 v35, 4, v35
	v_mul_lo_u32 v36, v32, s46
	v_add_u32 v6, v36, v35
	s_lshl_b32 s56, s46, 3
	s_sub_u32 s56, s56, 1024
	v_add_u32 v7, s56, v6
	v_add_u32 v8, s56, v7
	v_add_u32 v9, s56, v8
	s_lshl_b32 s51, s46, 6
	s_lshl_b32 s53, s40, 12
	s_lshr_b32 s56, s40, 1
	s_lshr_b32 s57, s42, 1
	s_mul_i32 s50, s57, 7
	s_and_b32 s49, s42, 1
	s_lshl2_add_u32 s57, s49, s50
	s_lshl_b32 s93, s57, 7
	s_add_u32 s57, s57, s56
	s_lshl3_add_u32 s58, s56, s42
	s_add_u32 s58, s58, 8
	s_cmp_eq_u32 s63, 0
	s_cselect_b32 s48, s58, s57
	s_lshl_b32 s48, s48, 7
	s_and_b32 s56, s40, 1
	s_lshl_b32 s56, s56, 5
	s_mul_i32 s56, s56, s46
	s_add_u32 s48, s48, s56
	s_mul_i32 s59, s43, s51
	s_add_u32 s59, s59, s48
	s_add_u32 m0, s53, 0
	s_nop 0
	buffer_load_dwordx4 v6, s[8:11], s59 offen offset:0 lds
	buffer_load_dwordx4 v7, s[8:11], s59 offen offset:1024 lds
	buffer_load_dwordx4 v8, s[8:11], s59 offen offset:2048 lds
	buffer_load_dwordx4 v9, s[8:11], s59 offen offset:3072 lds
	s_waitcnt lgkmcnt(0)
	s_mov_b32 s20, s84
	s_mov_b32 s21, s85
	s_mov_b32 s22, 10059904
	s_mov_b32 s23, 0x20000
	s_mov_b32 s36, s82
	s_mov_b32 s37, s83
	s_mov_b32 s38, 256
	s_mov_b32 s39, 0x20000
	s_mov_b32 s12, s76
	s_mov_b32 s13, s77
	s_mov_b32 s14, 1835008
	s_mov_b32 s15, 0x20000
	s_mov_b32 s16, s68
	s_mov_b32 s17, s69
	s_mov_b32 s18, 524288
	s_mov_b32 s19, 0x20000
	s_mov_b32 s24, s80
	s_mov_b32 s25, s81
	s_mov_b32 s26, 2097152
	s_mov_b32 s27, 0x20000
	s_mov_b32 s28, s74
	s_mov_b32 s29, s75
	s_mov_b32 s30, 3584
	s_mov_b32 s31, 0x20000
	s_mov_b32 s32, s78
	s_mov_b32 s33, s79
	s_mov_b32 s34, 1024
	s_mov_b32 s35, 0x20000
	buffer_load_dword v193, off, s[32:35], 0
	buffer_load_dword v192, off, s[32:35], 0 offset:512
	s_mov_b32 s74, s62
	s_mul_i32 s62, s62, 147456
	s_lshl_b32 s54, s40, 11
	s_lshl_b32 s55, s40, 10
	s_lshl_b32 s56, s50, 2
	s_lshl1_add_u32 s57, s49, s56
	s_add_u32 s57, s57, 12
	s_lshl_b32 s57, s57, L_end-L_exit-4+10
	s_add_u32 s79, s57, s62
	s_lshl4_add_u32 s57, s49, s56
	s_lshl_b32 s57, s57, 10
	s_add_u32 s76, s57, s62
	s_add_u32 s77, s76, 4096
	s_add_u32 s78, s76, 8192
	s_add_u32 s50, s50, 3
	s_lshl_b32 s50, s50, 7
	s_lshl_b32 s49, s49, 6
	s_add_u32 s99, s50, s49
	s_add_u32 s49, s93, 256
	s_lshl_b32 s57, s42, 7
	s_cmp_eq_u32 s63, 0
	s_cselect_b32 s49, s57, s49
	s_lshl_b32 s56, s40, 4
	s_mul_i32 s56, s56, s46
	s_add_u32 s49, s49, s56
	s_add_u32 s50, s99, s56
	s_lshl2_add_u32 s75, s42, s40
	s_and_b32 s58, s2, 7
	s_lshr_b32 s59, s2, 3
	s_and_b32 s56, s59, 3
	s_lshl2_add_u32 s44, s58, s56
	s_lshr_b32 s45, s59, 2
	s_lshl_b32 s68, s45, 7
	s_mul_i32 s70, s40, 458752
	s_add_u32 s70, s70, s68
	s_lshl_b32 s71, s40, 17
	s_add_u32 s71, s71, s68
	s_lshl2_add_u32 s56, s59, s40
	s_lshr_b32 s57, s56, L_end-L_exit-4+6
	s_bfe_u32 s58, s56, 0x20004
	s_mul_i32 s58, s58, 14
	s_add_u32 s57, s57, s58
	s_and_b32 s56, s56, 15
	s_lshl4_add_u32 s56, s57, s56
	s_lshl_b32 s101, s56, L_end-L_exit-4+11
	s_mul_i32 s56, s44, 294912
	s_mul_i32 s72, s40, 28672
	s_add_u32 s72, s72, s56
	s_lshl_b32 s73, s40, L_end-L_exit-4+13
	s_add_u32 s73, s73, s56
	s_add_u32 s73, s73, 114688
	v_lshl_add_u32 v10, v32, 10, v35
	v_add_u32 v11, 7168, v10
	v_add_u32 v12, 7168, v11
	v_add_u32 v13, 7168, v12
	v_and_b32_e64 v32, 3, v0
	v_bfe_u32 v33, v0, 2, 2
	v_bfe_u32 v34, v0, 4, 1
	v_lshrrev_b32_e64 v35, 5, v0
	v_lshl_add_u32 v36, v35, 3, v33
	v_and_b32 v37, 2, v33
	v_xor_b32 v37, v37, v34
	v_lshlrev_b32_e64 v37, 5, v37
	v_lshl_add_u32 v37, v32, 3, v37
	v_lshl_add_u32 v38, v36, 7, v37
	v_lshlrev_b32_e64 v39, 5, v34
	v_lshl_add_u32 v39, v32, 3, v39
	v_lshl_add_u32 v39, v36, 6, v39
	v_and_b32_e64 v40, 31, v0
	v_bfe_u32 v41, v0, 1, 3
	v_xor_b32 v42, v41, v35
	v_lshlrev_b32 v42, 4, v42
	v_lshl_add_u32 v42, v40, 7, v42
	v_add_u32 v42, s52, v42
	s_add_u32 s56, s40, 0
	s_and_b32 s56, s56, 3
	s_lshl_b32 s57, s56, 11
	v_add_u32 v15, s57, v38
	v_xor_b32 v16, 64, v15
	s_lshl_b32 s57, s56, 10
	v_add_u32 v27, s57, v39
	s_lshl_b32 s57, s56, 5
	v_xor_b32 v23, s57, v42
	s_add_u32 s56, s40, 1
	s_and_b32 s56, s56, 3
	s_lshl_b32 s57, s56, 11
	v_add_u32 v17, s57, v38
	v_xor_b32 v18, 64, v17
	s_lshl_b32 s57, s56, 10
	v_add_u32 v28, s57, v39
	s_lshl_b32 s57, s56, 5
	v_xor_b32 v24, s57, v42
	s_add_u32 s56, s40, 2
	s_and_b32 s56, s56, 3
	s_lshl_b32 s57, s56, 11
	v_add_u32 v19, s57, v38
	v_xor_b32 v20, 64, v19
	s_lshl_b32 s57, s56, 10
	v_add_u32 v29, s57, v39
	s_lshl_b32 s57, s56, 5
	v_xor_b32 v25, s57, v42
	s_add_u32 s56, s40, 3
	s_and_b32 s56, s56, 3
	s_lshl_b32 s57, s56, 11
	v_add_u32 v21, s57, v38
	v_xor_b32 v22, 64, v21
	s_lshl_b32 s57, s56, 10
	v_add_u32 v30, s57, v39
	s_lshl_b32 s57, s56, 5
	v_xor_b32_e64 v26, s57, v42
	v_bfe_u32 v43, v0, 2, 1
	v_cmp_eq_u32_e64 vcc, v43, v34
	v_mov_b32 v44, 0x3f803f80
	s_nop 0
	v_cndmask_b32 v176, 0, v44, vcc
	v_cndmask_b32 v177, 0, v44, vcc
	v_cndmask_b32 v178, 0, v44, vcc
	v_cndmask_b32_e64 v179, 0, v44, vcc
	v_lshl_add_u32 v36, v35, 2, v33
	v_lshl_add_u32 v36, v36, 7, v37
	v_add_u32 v248, s52, v36
	v_xor_b32 v249, 64, v248
	v_add_u32 v250, 147456, v1
	v_lshrrev_b32_e64 v36, 2, v0
	v_mul_u32_u24 v36, 3584, v36
	v_lshl_add_u32 v14, v32, 4, v36
	s_mov_b32 s64, 0xffff0000
	s_mov_b32 s65, 0xffff0000
	s_mov_b32 s66, 0x80008000
	s_mov_b32 s88, 0x358637bd
	s_mov_b32 s89, 0x358637bd
	s_mov_b32 s90, 0x3fb8aa3b
	s_mov_b32 s91, 0x3fb8aa3b
	s_mov_b32 s69, 0
	s_mov_b32 s86, -1
	s_mov_b32 s87, 0
	s_or_b32 s56, s2, s40
	s_cmp_lg_u32 s56, 0
	s_cbranch_scc1 L_ep2
	s_memrealtime s[60:61]
	s_waitcnt vmcnt(8) lgkmcnt(0)
	v_readfirstlane_b32 s56, v194
	s_nop 3
	s_and_b32 s57, s56, 3
	s_lshl_b32 s59, 1, s57
	s_and_b32 s57, s56, 1
	s_bfe_u32 s58, s56, 0x10010
	s_lshl1_add_u32 s57, s58, s57
	s_bitset1_b32 s59, s57
	s_bfe_u32 s57, s56, 0x1000f
	s_lshr_b32 s58, s56, 31
	s_lshl1_add_u32 s57, s58, s57
	s_bitset1_b32 s59, s57
	s_ff0_i32_b32 s57, s59
	s_andn2_b32 s60, s60, 3
	s_or_b32 s60, s60, s57
	s_or_b32 s61, s61, 0x80000000
	s_mul_i32 s58, s57, 0x8001
	s_and_b32 s58, s58, 0x10001
	s_mul_i32 s58, s58, 0x8001
	s_or_b32 s57, s57, s58
	v_mov_b32 v254, s60
	v_mov_b32_e64 v255, s61
	v_mov_b32 v194, s57
	s_mov_b32 s3, 10059776
	s_mov_b64 exec, 1
	buffer_store_dwordx2 v[254:255], off, s[36:39], 0 sc1
	buffer_store_dword v194, off, s[20:23], s3 sc1
	s_mov_b64 exec, -1
L_ep2:
	s_cmp_eq_u32 s63, 0
	s_cbranch_scc0 L_typeB
	v_mov_b32 v216, 0
	v_mov_b32 v217, 0
	v_mov_b32 v218, 0
	v_mov_b32 v219, 0
	v_mov_b32 v220, 0x3f803f80
	s_waitcnt vmcnt(7)
	v_dot2c_f32_bf16 v216, v220, v208
	v_dot2c_f32_bf16 v218, v208, v208
	s_waitcnt vmcnt(6)
	v_dot2c_f32_bf16 v217, v220, v212
	v_dot2c_f32_bf16 v219, v212, v212
	v_dot2c_f32_bf16 v216, v220, v209
	v_dot2c_f32_bf16 v218, v209, v209
	v_dot2c_f32_bf16 v217, v220, v213
	v_dot2c_f32_bf16 v219, v213, v213
	v_dot2c_f32_bf16 v216, v220, v210
	v_dot2c_f32_bf16 v218, v210, v210
	v_dot2c_f32_bf16 v217, v220, v214
	v_dot2c_f32_bf16 v219, v214, v214
	v_dot2c_f32_bf16 v216, v220, v211
	v_dot2c_f32_bf16 v218, v211, v211
	v_dot2c_f32_bf16 v217, v220, v215
	v_dot2c_f32_bf16 v219, v215, v215
	v_add_f32_dpp v216, v216, v216 row_ror:8 row_mask:0xf bank_mask:0xf
	s_nop 0
	v_add_f32_dpp v217, v217, v217 row_ror:8 row_mask:0xf bank_mask:0xf
	v_add_f32_dpp v218, v218, v218 row_ror:8 row_mask:0xf bank_mask:0xf
	v_add_f32_dpp v219, v219, v219 row_ror:8 row_mask:0xf bank_mask:0xf
	v_add_f32_dpp v216, v216, v216 row_ror:4 row_mask:0xf bank_mask:0xf
	v_add_f32_dpp v217, v217, v217 row_ror:4 row_mask:0xf bank_mask:0xf
	v_add_f32_dpp v218, v218, v218 row_ror:4 row_mask:0xf bank_mask:0xf
	v_add_f32_dpp v219, v219, v219 row_ror:4 row_mask:0xf bank_mask:0xf
	v_add_f32_dpp v216, v216, v216 row_ror:2 row_mask:0xf bank_mask:0xf
	v_add_f32_dpp v217, v217, v217 row_ror:2 row_mask:0xf bank_mask:0xf
	v_add_f32_dpp v218, v218, v218 row_ror:2 row_mask:0xf bank_mask:0xf
	v_add_f32_dpp v219, v219, v219 row_ror:2 row_mask:0xf bank_mask:0xf
	v_add_f32_dpp v216, v216, v216 row_ror:1 row_mask:0xf bank_mask:0xf
	v_add_f32_dpp v217, v217, v217 row_ror:1 row_mask:0xf bank_mask:0xf
	v_add_f32_dpp v218, v218, v218 row_ror:1 row_mask:0xf bank_mask:0xf
	v_add_f32_dpp v219, v219, v219 row_ror:1 row_mask:0xf bank_mask:0xf
	v_permlane32_swap_b32 v216, v217
	s_nop 0
	v_permlane32_swap_b32 v218, v219
	v_add_f32 v216, v216, v217
	v_add_f32 v218, v218, v219
	v_mov_b32 v217, v216
	v_mov_b32 v219, v218
	s_nop 0
	v_permlane16_swap_b32 v216, v217
	v_permlane16_swap_b32 v218, v219
	v_add_f32 v216, v216, v217
	v_add_f32 v218, v218, v219
	v_mul_f32 v216, 0x3b000000, v216
	v_mul_f32 v218, 0x3b000000, v218
	v_fma_f32 v218, -v216, v216, v218
	v_max_f32_e64 v218, 0, v218
	v_cvt_pk_bf16_f32 v217, -v216, v218
	v_and_b32 v218, 0xffff0000, v217
	v_lshlrev_b32_e64 v216, 16, v217
	v_add_f32 v218, 0x3727c5ac, v218
	v_cvt_pk_bf16_f32 v218, v218, v218
	v_lshlrev_b32_e64 v218, 16, v218
	v_sqrt_f32 v218, v218
	s_nop 0
	v_cvt_pk_bf16_f32 v202, v218, v216
	v_lshlrev_b32 v218, 16, v202
	v_rcp_f32 v203, v218
	s_add_u32 s56, s43, L_end-L_exit-4+1
	s_and_b32 s56, s56, 7
	s_mul_i32 s57, s56, s51
	s_lshl_b32 s56, s56, 7
	s_add_u32 m0, s52, 4096
	s_add_u32 s58, s56, s47
	s_add_u32 s59, s57, s48
	buffer_load_dwordx4 v2, s[4:7], s58 offen offset:0 lds
	buffer_load_dwordx4 v3, s[4:7], s58 offen offset:1024 lds
	buffer_load_dwordx4 v4, s[4:7], s58 offen offset:2048 lds
	buffer_load_dwordx4 v5, s[4:7], s58 offen offset:3072 lds
	s_add_u32 m0, s53, 16384
	s_nop 0
	buffer_load_dwordx4 v6, s[8:11], s59 offen offset:0 lds
	buffer_load_dwordx4 v7, s[8:11], s59 offen offset:1024 lds
	buffer_load_dwordx4 v8, s[8:11], s59 offen offset:2048 lds
	buffer_load_dwordx4 v9, s[8:11], s59 offen offset:3072 lds
	s_waitcnt vmcnt(10)
	s_barrier
	ds_read_b128 a[0:3], v23 offset:0
	ds_read_b64_tr_b16 v[144:145], v15 offset:0
	ds_read_b64_tr_b16 v[146:147], v15 offset:512
	ds_read_b64_tr_b16 v[148:149], v16 offset:0
	ds_read_b64_tr_b16 v[150:151], v16 offset:512
	ds_read_b64_tr_b16 v[152:153], v15 offset:8192
	ds_read_b64_tr_b16 v[154:155], v15 offset:8704
	ds_read_b64_tr_b16 v[156:157], v16 offset:8192
	ds_read_b64_tr_b16 v[158:159], v16 offset:8704
	s_waitcnt lgkmcnt(0)
	v_mfma_f32_32x32x16_bf16 v[32:47], a[0:3], v[144:147], 0
	ds_read_b128 a[4:7], v24 offset:0
	ds_read_b64_tr_b16 v[160:161], v17 offset:0
	ds_read_b64_tr_b16 v[162:163], v17 offset:512
	v_mfma_f32_16x16x32_bf16 v[224:227], v[176:179], v[144:147], 0
	v_mfma_f32_32x32x16_bf16 v[48:63], a[0:3], v[148:151], 0
	s_add_u32 s56, s43, 2
	s_and_b32 s56, s56, 7
	s_mul_i32 s57, s56, s51
	s_lshl_b32 s56, s56, L_end-L_exit-4+7
	s_add_u32 m0, s52, 8192
	s_add_u32 s58, s56, s47
	s_add_u32 s59, s57, s48
	ds_read_b64_tr_b16 v[164:165], v18 offset:0
	ds_read_b64_tr_b16 v[166:167], v18 offset:512
	ds_read_b64_tr_b16 v[168:169], v17 offset:8192
	v_mfma_f32_16x16x32_bf16 v[228:231], v[176:179], v[148:151], 0
	buffer_load_dwordx4 v2, s[4:7], s58 offen offset:0 lds
	v_mfma_f32_32x32x16_bf16 v[64:79], a[0:3], v[152:155], 0
	ds_read_b64_tr_b16 v[170:171], v17 offset:8704
	ds_read_b64_tr_b16 v[172:173], v18 offset:8192
	ds_read_b64_tr_b16 v[174:175], v18 offset:8704
	v_mfma_f32_16x16x32_bf16 v[232:235], v[176:179], v[152:155], 0
	buffer_load_dwordx4 v3, s[4:7], s58 offen offset:1024 lds
	v_mfma_f32_32x32x16_bf16 v[80:95], a[0:3], v[156:159], 0
	v_mfma_f32_16x16x32_bf16 v[236:239], v[176:179], v[156:159], 0
	s_waitcnt lgkmcnt(0)
	s_nop 0
	v_mfma_f32_32x32x16_bf16 v[32:47], a[4:7], v[160:163], v[32:47]
	ds_read_b128 a[8:11], v25 offset:0
	ds_read_b64_tr_b16 v[144:145], v19 offset:0
	ds_read_b64_tr_b16 v[146:147], v19 offset:512
	v_mfma_f32_32x32x16_bf16 v[48:63], a[4:7], v[164:167], v[48:63]
	ds_read_b64_tr_b16 v[148:149], v20 offset:0
	ds_read_b64_tr_b16 v[150:151], v20 offset:512
	ds_read_b64_tr_b16 v[152:153], v19 offset:8192
	buffer_load_dwordx4 v4, s[4:7], s58 offen offset:2048 lds
	v_mfma_f32_32x32x16_bf16 v[64:79], a[4:7], v[168:171], v[64:79]
	ds_read_b64_tr_b16 v[154:155], v19 offset:8704
	ds_read_b64_tr_b16 v[156:157], v20 offset:8192
	ds_read_b64_tr_b16 v[158:159], v20 offset:8704
	buffer_load_dwordx4 v5, s[4:7], s58 offen offset:3072 lds
	v_mfma_f32_32x32x16_bf16 v[80:95], a[4:7], v[172:175], v[80:95]
	s_add_u32 m0, s53, 32768
	s_nop 0
	buffer_load_dwordx4 v6, s[8:11], s59 offen offset:0 lds
	s_waitcnt lgkmcnt(0)
	v_mfma_f32_32x32x16_bf16 v[32:47], a[8:11], v[144:147], v[32:47]
	ds_read_b128 a[12:15], v26 offset:0
	ds_read_b64_tr_b16 v[160:161], v21 offset:0
	ds_read_b64_tr_b16 v[162:163], v21 offset:512
	v_mfma_f32_32x32x16_bf16 v[48:63], a[8:11], v[148:151], v[48:63]
	ds_read_b64_tr_b16 v[164:165], v22 offset:0
	ds_read_b64_tr_b16 v[166:167], v22 offset:512
	ds_read_b64_tr_b16 v[168:169], v21 offset:8192
	buffer_load_dwordx4 v7, s[8:11], s59 offen offset:1024 lds
	v_mfma_f32_32x32x16_bf16 v[64:79], a[8:11], v[152:155], v[64:79]
	ds_read_b64_tr_b16 v[170:171], v21 offset:8704
	ds_read_b64_tr_b16 v[172:173], v22 offset:8192
	ds_read_b64_tr_b16 v[174:175], v22 offset:8704
	buffer_load_dwordx4 v8, s[8:11], s59 offen offset:2048 lds
	v_mfma_f32_32x32x16_bf16 v[80:95], a[8:11], v[156:159], v[80:95]
	s_waitcnt lgkmcnt(0)
	s_nop 0
	v_mfma_f32_32x32x16_bf16 v[32:47], a[12:15], v[160:163], v[32:47]
	s_waitcnt vmcnt(7)
	s_barrier
	ds_read_b128 a[16:19], v23 offset:4096
	ds_read_b64_tr_b16 v[144:145], v15 offset:16384
	ds_read_b64_tr_b16 v[146:147], v15 offset:16896
	v_mfma_f32_32x32x16_bf16 v[48:63], a[12:15], v[164:167], v[48:63]
	ds_read_b64_tr_b16 v[148:149], v16 offset:16384
	ds_read_b64_tr_b16 v[150:151], v16 offset:16896
	ds_read_b64_tr_b16 v[152:153], v15 offset:24576
	buffer_load_dwordx4 v9, s[8:11], s59 offen offset:3072 lds
	v_mfma_f32_32x32x16_bf16 v[64:79], a[12:15], v[168:171], v[64:79]
	s_add_u32 s56, s43, L_end-L_exit-4+3
	s_and_b32 s56, s56, 7
	s_mul_i32 s57, s56, s51
	s_lshl_b32 s56, s56, 7
	s_add_u32 m0, s52, 12288
	s_add_u32 s58, s56, s47
	s_add_u32 s59, s57, s48
	ds_read_b64_tr_b16 v[154:155], v15 offset:25088
	ds_read_b64_tr_b16 v[156:157], v16 offset:24576
	ds_read_b64_tr_b16 v[158:159], v16 offset:25088
	buffer_load_dwordx4 v2, s[4:7], s58 offen offset:0 lds
	v_mfma_f32_32x32x16_bf16 v[80:95], a[12:15], v[172:175], v[80:95]
	buffer_load_dwordx2 v[254:255], off, s[36:39], 0 sc1
	s_waitcnt lgkmcnt(0)
	v_mfma_f32_32x32x16_bf16 v[32:47], a[16:19], v[144:147], v[32:47]
	ds_read_b128 a[20:23], v24 offset:4096
	ds_read_b64_tr_b16 v[160:161], v17 offset:16384
	ds_read_b64_tr_b16 v[162:163], v17 offset:16896
	v_mfma_f32_16x16x32_bf16 v[224:227], v[176:179], v[144:147], v[224:227]
	v_mfma_f32_32x32x16_bf16 v[48:63], a[16:19], v[148:151], v[48:63]
	ds_read_b64_tr_b16 v[164:165], v18 offset:16384
	ds_read_b64_tr_b16 v[166:167], v18 offset:16896
	ds_read_b64_tr_b16 v[168:169], v17 offset:24576
	v_mfma_f32_16x16x32_bf16 v[228:231], v[176:179], v[148:151], v[228:231]
	buffer_load_dwordx4 v3, s[4:7], s58 offen offset:1024 lds
	v_mfma_f32_32x32x16_bf16 v[64:79], a[16:19], v[152:155], v[64:79]
	ds_read_b64_tr_b16 v[170:171], v17 offset:25088
	ds_read_b64_tr_b16 v[172:173], v18 offset:24576
	ds_read_b64_tr_b16 v[174:175], v18 offset:25088
	v_mfma_f32_16x16x32_bf16 v[232:235], v[176:179], v[152:155], v[232:235]
	buffer_load_dwordx4 v4, s[4:7], s58 offen offset:2048 lds
	v_mfma_f32_32x32x16_bf16 v[80:95], a[16:19], v[156:159], v[80:95]
	v_mfma_f32_16x16x32_bf16 v[236:239], v[176:179], v[156:159], v[236:239]
	s_waitcnt lgkmcnt(0)
	v_mfma_f32_32x32x16_bf16 v[32:47], a[20:23], v[160:163], v[32:47]
	ds_read_b128 a[24:27], v25 offset:4096
	ds_read_b64_tr_b16 v[144:145], v19 offset:16384
	ds_read_b64_tr_b16 v[146:147], v19 offset:16896
	v_mfma_f32_32x32x16_bf16 v[48:63], a[20:23], v[164:167], v[48:63]
	ds_read_b64_tr_b16 v[148:149], v20 offset:16384
	ds_read_b64_tr_b16 v[150:151], v20 offset:16896
	ds_read_b64_tr_b16 v[152:153], v19 offset:24576
	buffer_load_dwordx4 v5, s[4:7], s58 offen offset:3072 lds
	v_mfma_f32_32x32x16_bf16 v[64:79], a[20:23], v[168:171], v[64:79]
	s_add_u32 m0, s53, 49152
	ds_read_b64_tr_b16 v[154:155], v19 offset:25088
	ds_read_b64_tr_b16 v[156:157], v20 offset:24576
	ds_read_b64_tr_b16 v[158:159], v20 offset:25088
	buffer_load_dwordx4 v6, s[8:11], s59 offen offset:0 lds
	v_mfma_f32_32x32x16_bf16 v[80:95], a[20:23], v[172:175], v[80:95]
	buffer_load_dwordx4 v7, s[8:11], s59 offen offset:1024 lds
	s_waitcnt lgkmcnt(0)
	v_mfma_f32_32x32x16_bf16 v[32:47], a[24:27], v[144:147], v[32:47]
	ds_read_b128 a[28:31], v26 offset:4096
	ds_read_b64_tr_b16 v[160:161], v21 offset:16384
	ds_read_b64_tr_b16 v[162:163], v21 offset:16896
	v_mfma_f32_32x32x16_bf16 v[48:63], a[24:27], v[148:151], v[48:63]
	ds_read_b64_tr_b16 v[164:165], v22 offset:16384
	ds_read_b64_tr_b16 v[166:167], v22 offset:16896
	ds_read_b64_tr_b16 v[168:169], v21 offset:24576
	buffer_load_dwordx4 v8, s[8:11], s59 offen offset:2048 lds
	v_mfma_f32_32x32x16_bf16 v[64:79], a[24:27], v[152:155], v[64:79]
	ds_read_b64_tr_b16 v[170:171], v21 offset:25088
	ds_read_b64_tr_b16 v[172:173], v22 offset:24576
	ds_read_b64_tr_b16 v[174:175], v22 offset:25088
	buffer_load_dwordx4 v9, s[8:11], s59 offen offset:3072 lds
	v_mfma_f32_32x32x16_bf16 v[80:95], a[24:27], v[156:159], v[80:95]
	s_waitcnt lgkmcnt(0)
	v_mfma_f32_32x32x16_bf16 v[32:47], a[28:31], v[160:163], v[32:47]
	s_waitcnt vmcnt(9)
	s_barrier
	ds_read_b128 a[32:35], v23 offset:8192
	ds_read_b64_tr_b16 v[144:145], v15 offset:32768
	ds_read_b64_tr_b16 v[146:147], v15 offset:33280
	v_mfma_f32_32x32x16_bf16 v[48:63], a[28:31], v[164:167], v[48:63]
	s_add_u32 s56, s43, 4
	s_and_b32 s56, s56, 7
	s_mul_i32 s57, s56, s51
	s_lshl_b32 s56, s56, 7
	s_add_u32 m0, s52, 0
	s_add_u32 s58, s56, s47
	s_add_u32 s59, s57, s48
	ds_read_b64_tr_b16 v[148:149], v16 offset:32768
	ds_read_b64_tr_b16 v[150:151], v16 offset:33280
	ds_read_b64_tr_b16 v[152:153], v15 offset:40960
	buffer_load_dwordx4 v2, s[4:7], s58 offen offset:0 lds
	v_mfma_f32_32x32x16_bf16 v[64:79], a[28:31], v[168:171], v[64:79]
	ds_read_b64_tr_b16 v[154:155], v15 offset:41472
	ds_read_b64_tr_b16 v[156:157], v16 offset:40960
	ds_read_b64_tr_b16 v[158:159], v16 offset:41472
	buffer_load_dwordx4 v3, s[4:7], s58 offen offset:1024 lds
	v_mfma_f32_32x32x16_bf16 v[80:95], a[28:31], v[172:175], v[80:95]
	buffer_load_dwordx4 v4, s[4:7], s58 offen offset:2048 lds
	s_waitcnt lgkmcnt(0)
	s_nop 0
	v_mfma_f32_32x32x16_bf16 v[32:47], a[32:35], v[144:147], v[32:47]
	ds_read_b128 a[36:39], v24 offset:8192
	ds_read_b64_tr_b16 v[160:161], v17 offset:32768
	ds_read_b64_tr_b16 v[162:163], v17 offset:33280
	v_mfma_f32_16x16x32_bf16 v[224:227], v[176:179], v[144:147], v[224:227]
	v_mfma_f32_32x32x16_bf16 v[48:63], a[32:35], v[148:151], v[48:63]
	ds_read_b64_tr_b16 v[164:165], v18 offset:32768
	ds_read_b64_tr_b16 v[166:167], v18 offset:33280
	ds_read_b64_tr_b16 v[168:169], v17 offset:40960
	v_mfma_f32_16x16x32_bf16 v[228:231], v[176:179], v[148:151], v[228:231]
	buffer_load_dwordx4 v5, s[4:7], s58 offen offset:3072 lds
	v_mfma_f32_32x32x16_bf16 v[64:79], a[32:35], v[152:155], v[64:79]
	s_add_u32 m0, s53, 0
	ds_read_b64_tr_b16 v[170:171], v17 offset:41472
	ds_read_b64_tr_b16 v[172:173], v18 offset:40960
	ds_read_b64_tr_b16 v[174:175], v18 offset:41472
	v_mfma_f32_16x16x32_bf16 v[232:235], v[176:179], v[152:155], v[232:235]
	buffer_load_dwordx4 v6, s[8:11], s59 offen offset:0 lds
	v_mfma_f32_32x32x16_bf16 v[80:95], a[32:35], v[156:159], v[80:95]
	v_mfma_f32_16x16x32_bf16 v[236:239], v[176:179], v[156:159], v[236:239]
	s_waitcnt lgkmcnt(0)
	v_mfma_f32_32x32x16_bf16 v[32:47], a[36:39], v[160:163], v[32:47]
	ds_read_b128 a[40:43], v25 offset:8192
	ds_read_b64_tr_b16 v[144:145], v19 offset:32768
	ds_read_b64_tr_b16 v[146:147], v19 offset:33280
	v_mfma_f32_32x32x16_bf16 v[48:63], a[36:39], v[164:167], v[48:63]
	ds_read_b64_tr_b16 v[148:149], v20 offset:32768
	ds_read_b64_tr_b16 v[150:151], v20 offset:33280
	ds_read_b64_tr_b16 v[152:153], v19 offset:40960
	buffer_load_dwordx4 v7, s[8:11], s59 offen offset:1024 lds
	s_waitcnt vmcnt(13)
	v_cmp_eq_u32 vcc, 0, v255
	s_nop 0
	s_cbranch_vccnz L_slow1
L_back1:
	v_mfma_f32_32x32x16_bf16 v[64:79], a[36:39], v[168:171], v[64:79]
	ds_read_b64_tr_b16 v[154:155], v19 offset:41472
	ds_read_b64_tr_b16 v[156:157], v20 offset:40960
	ds_read_b64_tr_b16 v[158:159], v20 offset:41472
	buffer_load_dwordx4 v8, s[8:11], s59 offen offset:2048 lds
	v_mfma_f32_32x32x16_bf16 v[80:95], a[36:39], v[172:175], v[80:95]
	buffer_load_dwordx4 v9, s[8:11], s59 offen offset:3072 lds
	v_readfirstlane_b32 s60, v254
	v_readfirstlane_b32 s61, v255
	v_and_b32 v253, 15, v0
	v_min_u32 v253, 14, v253
	v_lshl_add_u32 v253, v253, 1, 2
	v_lshrrev_b32 v253, v253, v254
	s_and_b32 s67, s60, 3
	v_and_b32 v253, 3, v253
	s_mul_i32 s3, s67, 0x8001
	s_mov_b32 s63, 0x10001
	s_and_b32 s3, s3, s63
	s_mul_i32 s3, s3, 0x8001
	v_mul_u32_u24 v252, 0x8001, v253
	v_mov_b32_e64 v251, s3
	v_and_b32 v252, s63, v252
	s_bfe_u32 s46, s60, 0x20002
	v_lshl_or_b32 v252, v252, 15, v252
	s_waitcnt lgkmcnt(0)
	v_mfma_f32_32x32x16_bf16 v[32:47], a[40:43], v[144:147], v[32:47]
	ds_read_b128 a[44:47], v26 offset:8192
	ds_read_b64_tr_b16 v[160:161], v21 offset:32768
	ds_read_b64_tr_b16 v[162:163], v21 offset:33280
	v_mov_b32_e64 v200, s60
	v_mfma_f32_32x32x16_bf16 v[48:63], a[40:43], v[148:151], v[48:63]
	s_add_u32 s56, s43, 5
	s_and_b32 s56, s56, 7
	s_mul_i32 s57, s56, s51
	s_lshl_b32 s56, s56, 7
	s_add_u32 m0, s52, 4096
	s_add_u32 s58, s56, s47
	s_add_u32 s59, s57, s48
	ds_read_b64_tr_b16 v[164:165], v22 offset:32768
	ds_read_b64_tr_b16 v[166:167], v22 offset:33280
	ds_read_b64_tr_b16 v[168:169], v21 offset:40960
	v_mov_b32_e64 v201, s61
	buffer_load_dwordx4 v2, s[4:7], s58 offen offset:0 lds
	v_lshrrev_b32_e64 v216, 5, v0
	v_mfma_f32_32x32x16_bf16 v[64:79], a[40:43], v[152:155], v[64:79]
	ds_read_b64_tr_b16 v[170:171], v21 offset:41472
	ds_read_b64_tr_b16 v[172:173], v22 offset:40960
	ds_read_b64_tr_b16 v[174:175], v22 offset:41472
	v_lshlrev_b32_e64 v216, 4, v216
	buffer_load_dwordx4 v3, s[4:7], s58 offen offset:1024 lds
	s_lshl_b32 s3, s98, L_end-L_exit-4+5
	v_mfma_f32_32x32x16_bf16 v[80:95], a[40:43], v[156:159], v[80:95]
	s_add_u32 s3, s3, 10027008
	s_mov_b32 s84, L_end-L_exit-4+1
	s_mov_b32 s85, 1
	s_mov_b64 exec, s[84:85]
	buffer_store_dwordx4 v[200:203], v216, s[20:23], s3 offen sc1
	s_mov_b64 exec, -1
	s_waitcnt lgkmcnt(0)
	v_mfma_f32_32x32x16_bf16 v[32:47], a[44:47], v[160:163], v[32:47]
	s_waitcnt vmcnt(11)
	s_barrier
	ds_read_b128 a[48:51], v23 offset:12288
	ds_read_b64_tr_b16 v[144:145], v15 offset:49152
	ds_read_b64_tr_b16 v[146:147], v15 offset:49664
	v_mfma_f32_32x32x16_bf16 v[48:63], a[44:47], v[164:167], v[48:63]
	ds_read_b64_tr_b16 v[148:149], v16 offset:49152
	ds_read_b64_tr_b16 v[150:151], v16 offset:49664
	ds_read_b64_tr_b16 v[152:153], v15 offset:57344
	buffer_load_dwordx4 v4, s[4:7], s58 offen offset:2048 lds
	v_mfma_f32_32x32x16_bf16 v[64:79], a[44:47], v[168:171], v[64:79]
	ds_read_b64_tr_b16 v[154:155], v15 offset:57856
	ds_read_b64_tr_b16 v[156:157], v16 offset:57344
	ds_read_b64_tr_b16 v[158:159], v16 offset:57856
	buffer_load_dwordx4 v5, s[4:7], s58 offen offset:3072 lds
	v_mfma_f32_32x32x16_bf16 v[80:95], a[44:47], v[172:175], v[80:95]
	s_add_u32 m0, s53, 16384
	s_nop 0
	buffer_load_dwordx4 v6, s[8:11], s59 offen offset:0 lds
	s_waitcnt lgkmcnt(0)
	v_mfma_f32_32x32x16_bf16 v[32:47], a[48:51], v[144:147], v[32:47]
	ds_read_b128 a[52:55], v24 offset:12288
	ds_read_b64_tr_b16 v[160:161], v17 offset:49152
	ds_read_b64_tr_b16 v[162:163], v17 offset:49664
	v_mfma_f32_16x16x32_bf16 v[224:227], v[176:179], v[144:147], v[224:227]
	v_mfma_f32_32x32x16_bf16 v[48:63], a[48:51], v[148:151], v[48:63]
	ds_read_b64_tr_b16 v[164:165], v18 offset:49152
	ds_read_b64_tr_b16 v[166:167], v18 offset:49664
	ds_read_b64_tr_b16 v[168:169], v17 offset:57344
	v_mfma_f32_16x16x32_bf16 v[228:231], v[176:179], v[148:151], v[228:231]
	buffer_load_dwordx4 v7, s[8:11], s59 offen offset:1024 lds
	v_mfma_f32_32x32x16_bf16 v[64:79], a[48:51], v[152:155], v[64:79]
	ds_read_b64_tr_b16 v[170:171], v17 offset:57856
	ds_read_b64_tr_b16 v[172:173], v18 offset:57344
	ds_read_b64_tr_b16 v[174:175], v18 offset:57856
	v_mfma_f32_16x16x32_bf16 v[232:235], v[176:179], v[152:155], v[232:235]
	buffer_load_dwordx4 v8, s[8:11], s59 offen offset:2048 lds
	v_mfma_f32_32x32x16_bf16 v[80:95], a[48:51], v[156:159], v[80:95]
	v_mfma_f32_16x16x32_bf16 v[236:239], v[176:179], v[156:159], v[236:239]
	s_waitcnt lgkmcnt(0)
	s_nop 0
	v_mfma_f32_32x32x16_bf16 v[32:47], a[52:55], v[160:163], v[32:47]
	ds_read_b128 a[56:59], v25 offset:12288
	ds_read_b64_tr_b16 v[144:145], v19 offset:49152
	ds_read_b64_tr_b16 v[146:147], v19 offset:49664
	v_mfma_f32_32x32x16_bf16 v[48:63], a[52:55], v[164:167], v[48:63]
	ds_read_b64_tr_b16 v[148:149], v20 offset:49152
	ds_read_b64_tr_b16 v[150:151], v20 offset:49664
	ds_read_b64_tr_b16 v[152:153], v19 offset:57344
	buffer_load_dwordx4 v9, s[8:11], s59 offen offset:3072 lds
	v_mfma_f32_32x32x16_bf16 v[64:79], a[52:55], v[168:171], v[64:79]
	s_add_u32 s56, s43, 6
	s_and_b32 s56, s56, 7
	s_mul_i32 s57, s56, s51
	s_lshl_b32 s56, s56, 7
	s_add_u32 m0, s52, 8192
	s_add_u32 s58, s56, s47
	s_add_u32 s59, s57, s48
	ds_read_b64_tr_b16 v[154:155], v19 offset:57856
	ds_read_b64_tr_b16 v[156:157], v20 offset:57344
	ds_read_b64_tr_b16 v[158:159], v20 offset:57856
	buffer_load_dwordx4 v2, s[4:7], s58 offen offset:0 lds
	v_mfma_f32_32x32x16_bf16 v[80:95], a[52:55], v[172:175], v[80:95]
	buffer_load_dwordx4 v3, s[4:7], s58 offen offset:1024 lds
	s_waitcnt lgkmcnt(0)
	v_mfma_f32_32x32x16_bf16 v[32:47], a[56:59], v[144:147], v[32:47]
	ds_read_b128 a[60:63], v26 offset:12288
	ds_read_b64_tr_b16 v[160:161], v21 offset:49152
	ds_read_b64_tr_b16 v[162:163], v21 offset:49664
	v_mfma_f32_32x32x16_bf16 v[48:63], a[56:59], v[148:151], v[48:63]
	ds_read_b64_tr_b16 v[164:165], v22 offset:49152
	ds_read_b64_tr_b16 v[166:167], v22 offset:49664
	ds_read_b64_tr_b16 v[168:169], v21 offset:57344
	buffer_load_dwordx4 v4, s[4:7], s58 offen offset:2048 lds
	v_mfma_f32_32x32x16_bf16 v[64:79], a[56:59], v[152:155], v[64:79]
	ds_read_b64_tr_b16 v[170:171], v21 offset:57856
	ds_read_b64_tr_b16 v[172:173], v22 offset:57344
	ds_read_b64_tr_b16 v[174:175], v22 offset:57856
	buffer_load_dwordx4 v5, s[4:7], s58 offen offset:3072 lds
	v_mfma_f32_32x32x16_bf16 v[80:95], a[56:59], v[156:159], v[80:95]
	s_waitcnt lgkmcnt(0)
	v_mfma_f32_32x32x16_bf16 v[32:47], a[60:63], v[160:163], v[32:47]
	s_waitcnt vmcnt(13)
	s_barrier
	ds_read_b128 a[64:67], v23 offset:0
	ds_read_b64_tr_b16 v[144:145], v15 offset:0
	ds_read_b64_tr_b16 v[146:147], v15 offset:512
	v_mfma_f32_32x32x16_bf16 v[48:63], a[60:63], v[164:167], v[48:63]
	s_add_u32 m0, s53, 32768
	ds_read_b64_tr_b16 v[148:149], v16 offset:0
	ds_read_b64_tr_b16 v[150:151], v16 offset:512
	ds_read_b64_tr_b16 v[152:153], v15 offset:8192
	buffer_load_dwordx4 v6, s[8:11], s59 offen offset:0 lds
	v_mfma_f32_32x32x16_bf16 v[64:79], a[60:63], v[168:171], v[64:79]
	ds_read_b64_tr_b16 v[154:155], v15 offset:8704
	ds_read_b64_tr_b16 v[156:157], v16 offset:8192
	ds_read_b64_tr_b16 v[158:159], v16 offset:8704
	buffer_load_dwordx4 v7, s[8:11], s59 offen offset:1024 lds
	v_mfma_f32_32x32x16_bf16 v[80:95], a[60:63], v[172:175], v[80:95]
	buffer_load_dwordx4 v8, s[8:11], s59 offen offset:2048 lds
	s_waitcnt lgkmcnt(0)
	s_nop 0
	v_mfma_f32_32x32x16_bf16 v[32:47], a[64:67], v[144:147], v[32:47]
	ds_read_b128 a[68:71], v24 offset:0
	ds_read_b64_tr_b16 v[160:161], v17 offset:0
	ds_read_b64_tr_b16 v[162:163], v17 offset:512
	v_mfma_f32_16x16x32_bf16 v[224:227], v[176:179], v[144:147], v[224:227]
	v_mfma_f32_32x32x16_bf16 v[48:63], a[64:67], v[148:151], v[48:63]
	ds_read_b64_tr_b16 v[164:165], v18 offset:0
	ds_read_b64_tr_b16 v[166:167], v18 offset:512
	ds_read_b64_tr_b16 v[168:169], v17 offset:8192
	v_mfma_f32_16x16x32_bf16 v[228:231], v[176:179], v[148:151], v[228:231]
	buffer_load_dwordx4 v9, s[8:11], s59 offen offset:3072 lds
	v_mfma_f32_32x32x16_bf16 v[64:79], a[64:67], v[152:155], v[64:79]
	s_add_u32 s56, s43, L_end-L_exit-4+7
	s_and_b32 s56, s56, 7
	s_mul_i32 s57, s56, s51
	s_lshl_b32 s56, s56, 7
	s_add_u32 m0, s52, 12288
	s_add_u32 s58, s56, s47
	s_add_u32 s59, s57, s48
	ds_read_b64_tr_b16 v[170:171], v17 offset:8704
	ds_read_b64_tr_b16 v[172:173], v18 offset:8192
	ds_read_b64_tr_b16 v[174:175], v18 offset:8704
	v_mfma_f32_16x16x32_bf16 v[232:235], v[176:179], v[152:155], v[232:235]
	buffer_load_dwordx4 v2, s[4:7], s58 offen offset:0 lds
	v_mfma_f32_32x32x16_bf16 v[80:95], a[64:67], v[156:159], v[80:95]
	v_mfma_f32_16x16x32_bf16 v[236:239], v[176:179], v[156:159], v[236:239]
	s_waitcnt lgkmcnt(0)
	v_mfma_f32_32x32x16_bf16 v[32:47], a[68:71], v[160:163], v[32:47]
	ds_read_b128 a[72:75], v25 offset:0
	ds_read_b64_tr_b16 v[144:145], v19 offset:0
	ds_read_b64_tr_b16 v[146:147], v19 offset:512
	v_mfma_f32_32x32x16_bf16 v[48:63], a[68:71], v[164:167], v[48:63]
	ds_read_b64_tr_b16 v[148:149], v20 offset:0
	ds_read_b64_tr_b16 v[150:151], v20 offset:512
	ds_read_b64_tr_b16 v[152:153], v19 offset:8192
	buffer_load_dwordx4 v3, s[4:7], s58 offen offset:1024 lds
	v_mfma_f32_32x32x16_bf16 v[64:79], a[68:71], v[168:171], v[64:79]
	ds_read_b64_tr_b16 v[154:155], v19 offset:8704
	ds_read_b64_tr_b16 v[156:157], v20 offset:8192
	ds_read_b64_tr_b16 v[158:159], v20 offset:8704
	buffer_load_dwordx4 v4, s[4:7], s58 offen offset:2048 lds
	v_mfma_f32_32x32x16_bf16 v[80:95], a[68:71], v[172:175], v[80:95]
	buffer_load_dwordx4 v5, s[4:7], s58 offen offset:3072 lds
	s_waitcnt lgkmcnt(0)
	v_mfma_f32_32x32x16_bf16 v[32:47], a[72:75], v[144:147], v[32:47]
	ds_read_b128 a[76:79], v26 offset:0
	ds_read_b64_tr_b16 v[160:161], v21 offset:0
	ds_read_b64_tr_b16 v[162:163], v21 offset:512
	v_mfma_f32_32x32x16_bf16 v[48:63], a[72:75], v[148:151], v[48:63]
	s_add_u32 m0, s53, 49152
	ds_read_b64_tr_b16 v[164:165], v22 offset:0
	ds_read_b64_tr_b16 v[166:167], v22 offset:512
	ds_read_b64_tr_b16 v[168:169], v21 offset:8192
	buffer_load_dwordx4 v6, s[8:11], s59 offen offset:0 lds
	v_mfma_f32_32x32x16_bf16 v[64:79], a[72:75], v[152:155], v[64:79]
	ds_read_b64_tr_b16 v[170:171], v21 offset:8704
	ds_read_b64_tr_b16 v[172:173], v22 offset:8192
	ds_read_b64_tr_b16 v[174:175], v22 offset:8704
	buffer_load_dwordx4 v7, s[8:11], s59 offen offset:1024 lds
	v_mfma_f32_32x32x16_bf16 v[80:95], a[72:75], v[156:159], v[80:95]
	s_waitcnt lgkmcnt(0)
	v_mfma_f32_32x32x16_bf16 v[32:47], a[76:79], v[160:163], v[32:47]
	s_waitcnt vmcnt(14)
	s_barrier
	ds_read_b128 a[80:83], v23 offset:4096
	ds_read_b64_tr_b16 v[144:145], v15 offset:16384
	ds_read_b64_tr_b16 v[146:147], v15 offset:16896
	v_mfma_f32_32x32x16_bf16 v[48:63], a[76:79], v[164:167], v[48:63]
	ds_read_b64_tr_b16 v[148:149], v16 offset:16384
	ds_read_b64_tr_b16 v[150:151], v16 offset:16896
	ds_read_b64_tr_b16 v[152:153], v15 offset:24576
	buffer_load_dwordx4 v8, s[8:11], s59 offen offset:2048 lds
	v_mfma_f32_32x32x16_bf16 v[64:79], a[76:79], v[168:171], v[64:79]
	ds_read_b64_tr_b16 v[154:155], v15 offset:25088
	ds_read_b64_tr_b16 v[156:157], v16 offset:24576
	ds_read_b64_tr_b16 v[158:159], v16 offset:25088
	buffer_load_dwordx4 v9, s[8:11], s59 offen offset:3072 lds
	v_mfma_f32_32x32x16_bf16 v[80:95], a[76:79], v[172:175], v[80:95]
	s_add_u32 s56, s43, 0
	s_and_b32 s56, s56, 7
	s_mul_i32 s57, s56, s51
	s_add_u32 m0, s54, 0
	s_add_u32 s57, s57, s49
	buffer_load_dwordx4 v6, s[8:11], s57 offen lds
	s_waitcnt lgkmcnt(0)
	v_mfma_f32_32x32x16_bf16 v[32:47], a[80:83], v[144:147], v[32:47]
	ds_read_b128 a[84:87], v24 offset:4096
	ds_read_b64_tr_b16 v[160:161], v17 offset:16384
	ds_read_b64_tr_b16 v[162:163], v17 offset:16896
	v_mfma_f32_16x16x32_bf16 v[224:227], v[176:179], v[144:147], v[224:227]
	v_mfma_f32_32x32x16_bf16 v[48:63], a[80:83], v[148:151], v[48:63]
	ds_read_b64_tr_b16 v[164:165], v18 offset:16384
	ds_read_b64_tr_b16 v[166:167], v18 offset:16896
	ds_read_b64_tr_b16 v[168:169], v17 offset:24576
	v_mfma_f32_16x16x32_bf16 v[228:231], v[176:179], v[148:151], v[228:231]
	buffer_load_dwordx4 v7, s[8:11], s57 offen offset:1024 lds
	v_mfma_f32_32x32x16_bf16 v[64:79], a[80:83], v[152:155], v[64:79]
	s_add_u32 s56, s43, L_end-L_exit-4+1
	s_and_b32 s56, s56, 7
	s_mul_i32 s57, s56, s51
	s_add_u32 m0, s54, 8192
	s_add_u32 s57, s57, s49
	ds_read_b64_tr_b16 v[170:171], v17 offset:25088
	ds_read_b64_tr_b16 v[172:173], v18 offset:24576
	ds_read_b64_tr_b16 v[174:175], v18 offset:25088
	v_mfma_f32_16x16x32_bf16 v[232:235], v[176:179], v[152:155], v[232:235]
	buffer_load_dwordx4 v6, s[8:11], s57 offen lds
	v_mfma_f32_32x32x16_bf16 v[80:95], a[80:83], v[156:159], v[80:95]
	v_mfma_f32_16x16x32_bf16 v[236:239], v[176:179], v[156:159], v[236:239]
	s_waitcnt lgkmcnt(0)
	v_mfma_f32_32x32x16_bf16 v[32:47], a[84:87], v[160:163], v[32:47]
	ds_read_b128 a[88:91], v25 offset:4096
	ds_read_b64_tr_b16 v[144:145], v19 offset:16384
	ds_read_b64_tr_b16 v[146:147], v19 offset:16896
	v_mfma_f32_32x32x16_bf16 v[48:63], a[84:87], v[164:167], v[48:63]
	ds_read_b64_tr_b16 v[148:149], v20 offset:16384
	ds_read_b64_tr_b16 v[150:151], v20 offset:16896
	ds_read_b64_tr_b16 v[152:153], v19 offset:24576
	buffer_load_dwordx4 v7, s[8:11], s57 offen offset:1024 lds
	v_mfma_f32_32x32x16_bf16 v[64:79], a[84:87], v[168:171], v[64:79]
	v_and_b32 v191, 31, v0
	v_lshlrev_b32 v191, 4, v191
	s_lshl_b32 s98, s74, L_end-L_exit-4+9
	s_add_u32 s98, s98, 10027008
	ds_read_b64_tr_b16 v[154:155], v19 offset:25088
	ds_read_b64_tr_b16 v[156:157], v20 offset:24576
	ds_read_b64_tr_b16 v[158:159], v20 offset:25088
	buffer_load_dwordx4 v[204:207], v191, s[20:23], s98 offen sc1
	v_mfma_f32_32x32x16_bf16 v[80:95], a[84:87], v[172:175], v[80:95]
	s_lshl2_add_u32 s56, s2, s40
	s_lshr_b32 s57, s2, 3
	s_lshl2_add_u32 s57, s57, s40
	v_and_b32 v198, 15, v0
	v_min_u32 v199, 13, v198
	v_min_u32 v198, 3, v198
	v_cmp_gt_u32 vcc, 16, v0
	s_mul_i32 s58, s56, 14
	v_add_lshl_u32 v197, v199, s58, 7
	s_mul_i32 s58, s57, L_end-L_exit-4+14
	v_add_lshl_u32 v199, v199, s58, 10
	v_add_u32 v199, 384, v199
	v_cndmask_b32 v199, v199, v197, vcc
	s_mul_i32 s58, s56, 4
	v_add_lshl_u32 v197, v198, s58, 7
	s_mul_i32 s58, s57, L_end-L_exit-4+4
	v_add_lshl_u32 v198, v198, s58, 10
	v_add_u32 v198, 384, v198
	v_cndmask_b32 v198, v198, v197, vcc
	s_mov_b64 exec, s[86:87]
	buffer_load_dword v199, v199, s[12:15], 0 offen
	s_mov_b64 exec, -1
	s_waitcnt lgkmcnt(0)
	v_mfma_f32_32x32x16_bf16 v[32:47], a[88:91], v[144:147], v[32:47]
	ds_read_b128 a[92:95], v26 offset:4096
	ds_read_b64_tr_b16 v[160:161], v21 offset:16384
	ds_read_b64_tr_b16 v[162:163], v21 offset:16896
	v_mfma_f32_32x32x16_bf16 v[48:63], a[88:91], v[148:151], v[48:63]
	ds_read_b64_tr_b16 v[164:165], v22 offset:16384
	ds_read_b64_tr_b16 v[166:167], v22 offset:16896
	ds_read_b64_tr_b16 v[168:169], v21 offset:24576
	s_mov_b64 exec, s[86:87]
	buffer_load_dword v198, v198, s[16:19], 0 offen
	s_mov_b64 exec, -1
	v_mfma_f32_32x32x16_bf16 v[64:79], a[88:91], v[152:155], v[64:79]
	ds_read_b64_tr_b16 v[170:171], v21 offset:25088
	ds_read_b64_tr_b16 v[172:173], v22 offset:24576
	ds_read_b64_tr_b16 v[174:175], v22 offset:25088
	v_mfma_f32_32x32x16_bf16 v[80:95], a[88:91], v[156:159], v[80:95]
	s_waitcnt lgkmcnt(0)
	v_mfma_f32_32x32x16_bf16 v[32:47], a[92:95], v[160:163], v[32:47]
	s_waitcnt vmcnt(15)
	s_barrier
	ds_read_b128 a[96:99], v23 offset:8192
	ds_read_b64_tr_b16 v[144:145], v15 offset:32768
	ds_read_b64_tr_b16 v[146:147], v15 offset:33280
	v_mfma_f32_32x32x16_bf16 v[48:63], a[92:95], v[164:167], v[48:63]
	s_add_u32 m0, s52, 0
	s_add_u32 s58, s70, 0
	ds_read_b64_tr_b16 v[148:149], v16 offset:32768
	ds_read_b64_tr_b16 v[150:151], v16 offset:33280
	ds_read_b64_tr_b16 v[152:153], v15 offset:40960
	buffer_load_dwordx4 v10, s[12:15], s58 offen offset:0 lds
	v_mfma_f32_32x32x16_bf16 v[64:79], a[92:95], v[168:171], v[64:79]
	ds_read_b64_tr_b16 v[154:155], v15 offset:41472
	ds_read_b64_tr_b16 v[156:157], v16 offset:40960
	ds_read_b64_tr_b16 v[158:159], v16 offset:41472
	v_mfma_f32_32x32x16_bf16 v[80:95], a[92:95], v[172:175], v[80:95]
	s_waitcnt lgkmcnt(0)
	v_mfma_f32_32x32x16_bf16 v[32:47], a[96:99], v[144:147], v[32:47]
	ds_read_b128 a[100:103], v24 offset:8192
	ds_read_b64_tr_b16 v[160:161], v17 offset:32768
	ds_read_b64_tr_b16 v[162:163], v17 offset:33280
	v_mfma_f32_16x16x32_bf16 v[224:227], v[176:179], v[144:147], v[224:227]
	v_mfma_f32_32x32x16_bf16 v[48:63], a[96:99], v[148:151], v[48:63]
	ds_read_b64_tr_b16 v[164:165], v18 offset:32768
	ds_read_b64_tr_b16 v[166:167], v18 offset:33280
	ds_read_b64_tr_b16 v[168:169], v17 offset:40960
	v_mfma_f32_16x16x32_bf16 v[228:231], v[176:179], v[148:151], v[228:231]
	buffer_load_dwordx4 v11, s[12:15], s58 offen offset:1024 lds
	v_mfma_f32_32x32x16_bf16 v[64:79], a[96:99], v[152:155], v[64:79]
	ds_read_b64_tr_b16 v[170:171], v17 offset:41472
	ds_read_b64_tr_b16 v[172:173], v18 offset:40960
	ds_read_b64_tr_b16 v[174:175], v18 offset:41472
	v_mfma_f32_16x16x32_bf16 v[232:235], v[176:179], v[152:155], v[232:235]
	v_mfma_f32_32x32x16_bf16 v[80:95], a[96:99], v[156:159], v[80:95]
	v_mfma_f32_16x16x32_bf16 v[236:239], v[176:179], v[156:159], v[236:239]
	s_waitcnt lgkmcnt(0)
	v_mfma_f32_32x32x16_bf16 v[32:47], a[100:103], v[160:163], v[32:47]
	ds_read_b128 a[104:107], v25 offset:8192
	ds_read_b64_tr_b16 v[144:145], v19 offset:32768
	ds_read_b64_tr_b16 v[146:147], v19 offset:33280
	v_mfma_f32_32x32x16_bf16 v[48:63], a[100:103], v[164:167], v[48:63]
	ds_read_b64_tr_b16 v[148:149], v20 offset:32768
	ds_read_b64_tr_b16 v[150:151], v20 offset:33280
	ds_read_b64_tr_b16 v[152:153], v19 offset:40960
	buffer_load_dwordx4 v12, s[12:15], s58 offen offset:2048 lds
	v_mfma_f32_32x32x16_bf16 v[64:79], a[100:103], v[168:171], v[64:79]
	ds_read_b64_tr_b16 v[154:155], v19 offset:41472
	ds_read_b64_tr_b16 v[156:157], v20 offset:40960
	ds_read_b64_tr_b16 v[158:159], v20 offset:41472
	v_mfma_f32_32x32x16_bf16 v[80:95], a[100:103], v[172:175], v[80:95]
	s_waitcnt lgkmcnt(0)
	v_mfma_f32_32x32x16_bf16 v[32:47], a[104:107], v[144:147], v[32:47]
	ds_read_b128 a[108:111], v26 offset:8192
	ds_read_b64_tr_b16 v[160:161], v21 offset:32768
	ds_read_b64_tr_b16 v[162:163], v21 offset:33280
	v_mfma_f32_32x32x16_bf16 v[48:63], a[104:107], v[148:151], v[48:63]
	ds_read_b64_tr_b16 v[164:165], v22 offset:32768
	ds_read_b64_tr_b16 v[166:167], v22 offset:33280
	ds_read_b64_tr_b16 v[168:169], v21 offset:40960
	buffer_load_dwordx4 v13, s[12:15], s58 offen offset:3072 lds
	v_mfma_f32_32x32x16_bf16 v[64:79], a[104:107], v[152:155], v[64:79]
	ds_read_b64_tr_b16 v[170:171], v21 offset:41472
	ds_read_b64_tr_b16 v[172:173], v22 offset:40960
	ds_read_b64_tr_b16 v[174:175], v22 offset:41472
	v_mfma_f32_32x32x16_bf16 v[80:95], a[104:107], v[156:159], v[80:95]
	s_waitcnt lgkmcnt(0)
	v_mfma_f32_32x32x16_bf16 v[32:47], a[108:111], v[160:163], v[32:47]
	s_waitcnt vmcnt(11)
	s_barrier
	ds_read_b128 a[112:115], v23 offset:12288
	ds_read_b64_tr_b16 v[144:145], v15 offset:49152
	ds_read_b64_tr_b16 v[146:147], v15 offset:49664
	v_mfma_f32_32x32x16_bf16 v[48:63], a[108:111], v[164:167], v[48:63]
	s_add_u32 s56, s43, 2
	s_and_b32 s56, s56, 7
	s_mul_i32 s57, s56, s51
	s_add_u32 m0, s54, 16384
	s_add_u32 s57, s57, s49
	ds_read_b64_tr_b16 v[148:149], v16 offset:49152
	ds_read_b64_tr_b16 v[150:151], v16 offset:49664
	ds_read_b64_tr_b16 v[152:153], v15 offset:57344
	buffer_load_dwordx4 v6, s[8:11], s57 offen lds
	v_mfma_f32_32x32x16_bf16 v[64:79], a[108:111], v[168:171], v[64:79]
	ds_read_b64_tr_b16 v[154:155], v15 offset:57856
	ds_read_b64_tr_b16 v[156:157], v16 offset:57344
	ds_read_b64_tr_b16 v[158:159], v16 offset:57856
	v_mfma_f32_32x32x16_bf16 v[80:95], a[108:111], v[172:175], v[80:95]
	s_waitcnt lgkmcnt(0)
	v_mfma_f32_32x32x16_bf16 v[32:47], a[112:115], v[144:147], v[32:47]
	ds_read_b128 a[116:119], v24 offset:12288
	ds_read_b64_tr_b16 v[160:161], v17 offset:49152
	ds_read_b64_tr_b16 v[162:163], v17 offset:49664
	v_mfma_f32_16x16x32_bf16 v[224:227], v[176:179], v[144:147], v[224:227]
	v_mfma_f32_32x32x16_bf16 v[48:63], a[112:115], v[148:151], v[48:63]
	ds_read_b64_tr_b16 v[164:165], v18 offset:49152
	ds_read_b64_tr_b16 v[166:167], v18 offset:49664
	ds_read_b64_tr_b16 v[168:169], v17 offset:57344
	v_mfma_f32_16x16x32_bf16 v[228:231], v[176:179], v[148:151], v[228:231]
	buffer_load_dwordx4 v7, s[8:11], s57 offen offset:1024 lds
	v_mfma_f32_32x32x16_bf16 v[64:79], a[112:115], v[152:155], v[64:79]
	ds_read_b64_tr_b16 v[170:171], v17 offset:57856
	ds_read_b64_tr_b16 v[172:173], v18 offset:57344
	ds_read_b64_tr_b16 v[174:175], v18 offset:57856
	v_mfma_f32_16x16x32_bf16 v[232:235], v[176:179], v[152:155], v[232:235]
	v_mfma_f32_32x32x16_bf16 v[80:95], a[112:115], v[156:159], v[80:95]
	v_mfma_f32_16x16x32_bf16 v[236:239], v[176:179], v[156:159], v[236:239]
	s_waitcnt lgkmcnt(0)
	v_mfma_f32_32x32x16_bf16 v[32:47], a[116:119], v[160:163], v[32:47]
	ds_read_b128 a[120:123], v25 offset:12288
	ds_read_b64_tr_b16 v[144:145], v19 offset:49152
	ds_read_b64_tr_b16 v[146:147], v19 offset:49664
	v_mfma_f32_32x32x16_bf16 v[48:63], a[116:119], v[164:167], v[48:63]
	s_add_u32 s56, s43, 3
	s_and_b32 s56, s56, 7
	s_mul_i32 s57, s56, s51
	s_add_u32 m0, s54, 24576
	s_add_u32 s57, s57, s49
	ds_read_b64_tr_b16 v[148:149], v20 offset:49152
	ds_read_b64_tr_b16 v[150:151], v20 offset:49664
	ds_read_b64_tr_b16 v[152:153], v19 offset:57344
	buffer_load_dwordx4 v6, s[8:11], s57 offen lds
	v_mfma_f32_32x32x16_bf16 v[64:79], a[116:119], v[168:171], v[64:79]
	ds_read_b64_tr_b16 v[154:155], v19 offset:57856
	ds_read_b64_tr_b16 v[156:157], v20 offset:57344
	ds_read_b64_tr_b16 v[158:159], v20 offset:57856
	v_mfma_f32_32x32x16_bf16 v[80:95], a[116:119], v[172:175], v[80:95]
	s_waitcnt lgkmcnt(0)
	v_mfma_f32_32x32x16_bf16 v[32:47], a[120:123], v[144:147], v[32:47]
	ds_read_b128 a[124:127], v26 offset:12288
	ds_read_b64_tr_b16 v[160:161], v21 offset:49152
	ds_read_b64_tr_b16 v[162:163], v21 offset:49664
	v_mfma_f32_32x32x16_bf16 v[48:63], a[120:123], v[148:151], v[48:63]
	ds_read_b64_tr_b16 v[164:165], v22 offset:49152
	ds_read_b64_tr_b16 v[166:167], v22 offset:49664
	ds_read_b64_tr_b16 v[168:169], v21 offset:57344
	buffer_load_dwordx4 v7, s[8:11], s57 offen offset:1024 lds
	v_mfma_f32_32x32x16_bf16 v[64:79], a[120:123], v[152:155], v[64:79]
	ds_read_b64_tr_b16 v[170:171], v21 offset:57856
	ds_read_b64_tr_b16 v[172:173], v22 offset:57344
	ds_read_b64_tr_b16 v[174:175], v22 offset:57856
	v_mfma_f32_32x32x16_bf16 v[80:95], a[120:123], v[156:159], v[80:95]
	s_lshl_b32 s3, s40, L_end-L_exit-4+10
	s_add_u32 s3, s3, 131072
	v_add_u32 v247, s3, v1
	v_mov_b32 v225, v228
	v_mov_b32 v226, v232
	v_mov_b32 v227, v236
	ds_write_b128 v247, v[224:227]
	s_waitcnt lgkmcnt(1)
	v_mfma_f32_32x32x16_bf16 v[32:47], a[124:127], v[160:163], v[32:47]
	s_waitcnt vmcnt(11)
	s_waitcnt lgkmcnt(0)
	s_barrier
	ds_read_b64_tr_b16 v[144:145], v15 offset:0
	ds_read_b64_tr_b16 v[146:147], v15 offset:512
	ds_read_b64_tr_b16 v[148:149], v16 offset:0
	ds_read_b64_tr_b16 v[150:151], v16 offset:512
	v_mfma_f32_32x32x16_bf16 v[48:63], a[124:127], v[164:167], v[48:63]
	s_add_u32 m0, s52, 4096
	s_add_u32 s58, s70, 32768
	buffer_load_dwordx4 v10, s[12:15], s58 offen offset:0 lds
	v_mfma_f32_32x32x16_bf16 v[64:79], a[124:127], v[168:171], v[64:79]
	v_mfma_f32_32x32x16_bf16 v[80:95], a[124:127], v[172:175], v[80:95]
	ds_read_b64_tr_b16 v[152:153], v17 offset:0
	ds_read_b64_tr_b16 v[154:155], v17 offset:512
	ds_read_b64_tr_b16 v[156:157], v18 offset:0
	ds_read_b64_tr_b16 v[158:159], v18 offset:512
L_midA:
	v_add_u32 v247, 131072, v1
	ds_read_b128 v[208:211], v247 offset:0
	ds_read_b128 v[212:215], v247 offset:1024
	ds_read_b128 v[216:219], v247 offset:2048
	ds_read_b128 v[220:223], v247 offset:3072
	s_waitcnt vmcnt(11)
	buffer_load_dwordx4 v11, s[12:15], s58 offen offset:1024 lds
	v_cmp_ne_u64 vcc, s[60:61], v[204:205]
	s_nop 0
	s_cbranch_vccnz L_slow2
L_back2:
	v_cndmask_b32 v225, 0, v206, s[86:87]
	v_mov_b32 v228, v207
	v_lshrrev_b32 v224, 16, v225
	v_mov_b32 v226, 0
	v_mov_b32 v227, 0
	v_lshl_or_b32 v224, v224, 16, v224
	s_lshl_b32 s80, s40, L_end-L_exit-4+8
	s_add_u32 s80, s80, 159744
	v_and_b32_e64 v229, 31, v0
	v_lshl_add_u32 v229, v229, 2, s80
	ds_write_b32 v229, v228
	buffer_load_dwordx4 v12, s[12:15], s58 offen offset:2048 lds
	v_lshrrev_b32 v230, 5, v0
	v_lshl_add_u32 v230, v230, 4, s80
	ds_read_b128 v[192:195], v230 offset:0
	s_waitcnt vmcnt(11)
	ds_read_b128 v[196:199], v230 offset:32
	ds_read_b128 v[200:203], v230 offset:64
	ds_read_b128 v[204:207], v230 offset:96
	s_waitcnt lgkmcnt(7)
	v_add_f32 v208, v208, v212
	s_waitcnt lgkmcnt(5)
	v_add_f32 v216, v216, v220
	v_add_f32 v209, v209, v213
	v_add_f32 v217, v217, v221
	v_add_f32 v210, v210, v214
	v_add_f32 v218, v218, v222
	buffer_load_dwordx4 v13, s[12:15], s58 offen offset:3072 lds
	v_add_f32 v211, v211, v215
	v_add_f32 v219, v219, v223
	v_add_f32 v232, v208, v216
	v_add_f32 v233, v209, v217
	v_add_f32 v234, v210, v218
	v_add_f32 v235, v211, v219
	s_add_u32 s56, s43, 4
	s_and_b32 s56, s56, 7
	s_mul_i32 s57, s56, s51
	s_add_u32 m0, s54, 32768
	s_add_u32 s57, s57, s49
	v_cvt_pk_bf16_f32 v210, v232, v232
	v_cvt_pk_bf16_f32 v214, v234, v234
	v_lshlrev_b32 v210, 16, v210
	v_lshlrev_b32 v214, 16, v214
	v_sub_f32 v210, v232, v210
	v_sub_f32 v214, v234, v214
	buffer_load_dwordx4 v6, s[8:11], s57 offen lds
	v_cvt_pk_bf16_f32 v208, v232, v210
	v_cvt_pk_bf16_f32 v212, v234, v214
	v_and_b32 v211, 0xffff0000, v208
	v_and_b32 v215, 0xffff0000, v212
	v_sub_f32 v210, v210, v211
	v_sub_f32 v214, v214, v215
	v_cvt_pk_bf16_f32 v209, 0, v210
	v_cvt_pk_bf16_f32 v213, 0, v214
	v_mov_b32 v210, 0
	v_mov_b32 v214, 0
	v_mov_b32 v211, 0
	v_mov_b32 v215, 0
	buffer_load_dwordx4 v7, s[8:11], s57 offen offset:1024 lds
	v_mfma_f32_32x32x16_bf16 v[32:47], v[224:227], v[208:211], v[32:47]
	v_mfma_f32_32x32x16_bf16 v[64:79], v[224:227], v[212:215], v[64:79]
	v_cvt_pk_bf16_f32 v218, v233, v233
	v_cvt_pk_bf16_f32 v222, v235, v235
	v_lshlrev_b32 v218, 16, v218
	v_lshlrev_b32 v222, 16, v222
	s_add_u32 s56, s43, L_end-L_exit-4+5
	s_and_b32 s56, s56, 7
	s_mul_i32 s57, s56, s51
	s_add_u32 m0, s54, 40960
	s_add_u32 s57, s57, s49
	v_sub_f32 v218, v233, v218
	v_sub_f32_e64 v222, v235, v222
	v_cvt_pk_bf16_f32 v216, v233, v218
	v_cvt_pk_bf16_f32 v220, v235, v222
	v_and_b32 v219, 0xffff0000, v216
	v_and_b32 v223, 0xffff0000, v220
	buffer_load_dwordx4 v6, s[8:11], s57 offen lds
	v_sub_f32 v218, v218, v219
	v_sub_f32 v222, v222, v223
	v_cvt_pk_bf16_f32 v217, 0, v218
	v_cvt_pk_bf16_f32 v221, 0, v222
	v_mov_b32 v218, 0
	v_mov_b32 v222, 0
	v_mov_b32_e64 v219, 0
	v_mov_b32 v223, 0
	s_nop 0
	v_mfma_f32_32x32x16_bf16 v[48:63], v[224:227], v[216:219], v[48:63]
	v_mfma_f32_32x32x16_bf16 v[80:95], v[224:227], v[220:223], v[80:95]
	s_lshl_b32 s80, s40, L_end-L_exit-4+12
	s_add_u32 s80, s80, 143360
	buffer_load_dwordx4 v7, s[8:11], s57 offen offset:1024 lds
	v_add_u32 v136, s80, v1
	s_lshl_b32 s80, s40, 8
	s_add_u32 s80, s80, 160768
	v_and_b32 v137, 31, v0
	v_lshl_add_u32 v137, v137, 2, s80
	s_waitcnt lgkmcnt(3)
	v_pk_fma_f32 v[32:33], v[32:33], v[192:193], s[88:89]
	s_add_u32 m0, s52, 8192
	s_add_u32 s58, s70, 65536
	v_pk_fma_f32 v[34:35], v[34:35], v[194:195], s[88:89]
	v_pk_mul_f32 v[132:133], v[32:33], s[90:91]
	v_pk_mul_f32 v[134:135], v[34:35], s[90:91]
	v_exp_f32_e64 v132, v132 clamp
	v_max_f32_e64 v32, s88, v32
	v_exp_f32_e64 v133, v133 clamp
	buffer_load_dwordx4 v10, s[12:15], s58 offen offset:0 lds
	v_max_f32_e64 v33, s88, v33
	v_exp_f32_e64 v134, v134 clamp
	v_max_f32_e64 v34, s88, v34
	v_exp_f32_e64 v135, v135 clamp
	v_max_f32_e64 v35, s88, v35
	v_pk_add_f32 v[32:33], v[32:33], v[132:133]
	v_pk_add_f32 v[34:35], v[34:35], v[134:135]
	v_pk_mul_f32 v[64:65], v[64:65], v[192:193]
	v_pk_mul_f32 v[66:67], v[66:67], v[194:195]
	v_cvt_pk_bf16_f32 v232, v32, v33
	v_cvt_pk_bf16_f32 v233, v34, v35
	v_cvt_pk_bf16_f32 v240, v64, v65
	buffer_load_dwordx4 v11, s[12:15], s58 offen offset:1024 lds
	v_cvt_pk_bf16_f32 v241, v66, v67
	s_waitcnt lgkmcnt(2)
	s_nop 0
	v_pk_fma_f32 v[36:37], v[36:37], v[196:197], s[88:89]
	v_pk_fma_f32 v[38:39], v[38:39], v[198:199], s[88:89]
	v_pk_mul_f32 v[132:133], v[36:37], s[90:91]
	v_pk_mul_f32 v[134:135], v[38:39], s[90:91]
	v_exp_f32_e64 v132, v132 clamp
	v_max_f32_e64 v36, s88, v36
	v_exp_f32_e64 v133, v133 clamp
	v_max_f32_e64 v37, s88, v37
	v_exp_f32_e64 v134, v134 clamp
	v_max_f32_e64 v38, s88, v38
	v_exp_f32_e64 v135, v135 clamp
	buffer_load_dwordx4 v12, s[12:15], s58 offen offset:2048 lds
	v_max_f32_e64 v39, s88, v39
	v_pk_add_f32 v[36:37], v[36:37], v[132:133]
	v_pk_add_f32 v[38:39], v[38:39], v[134:135]
	v_pk_mul_f32 v[68:69], v[68:69], v[196:197]
	v_pk_mul_f32 v[70:71], v[70:71], v[198:199]
	v_cvt_pk_bf16_f32 v234, v36, v37
	v_cvt_pk_bf16_f32 v235, v38, v39
	v_cvt_pk_bf16_f32 v242, v68, v69
	v_cvt_pk_bf16_f32 v243, v70, v71
	s_waitcnt lgkmcnt(1)
	s_nop 0
	v_pk_fma_f32 v[40:41], v[40:41], v[200:201], s[88:89]
	v_pk_fma_f32 v[42:43], v[42:43], v[202:203], s[88:89]
	v_pk_mul_f32 v[132:133], v[40:41], s[90:91]
	buffer_load_dwordx4 v13, s[12:15], s58 offen offset:3072 lds
	v_pk_mul_f32 v[134:135], v[42:43], s[90:91]
	v_exp_f32_e64 v132, v132 clamp
	v_max_f32_e64 v40, s88, v40
	v_exp_f32_e64 v133, v133 clamp
	v_max_f32_e64 v41, s88, v41
	v_exp_f32_e64 v134, v134 clamp
	s_add_u32 s56, s43, L_end-L_exit-4+6
	s_and_b32 s56, s56, 7
	s_mul_i32 s57, s56, s51
	s_add_u32 m0, s54, 49152
	s_add_u32 s57, s57, s49
	v_max_f32 v42, s88, v42
	v_exp_f32_e64 v135, v135 clamp
	v_max_f32_e64 v43, s88, v43
	v_pk_add_f32 v[40:41], v[40:41], v[132:133]
	v_pk_add_f32 v[42:43], v[42:43], v[134:135]
	v_pk_mul_f32 v[72:73], v[72:73], v[200:201]
	buffer_load_dwordx4 v6, s[8:11], s57 offen lds
	v_pk_mul_f32 v[74:75], v[74:75], v[202:203]
	v_cvt_pk_bf16_f32 v236, v40, v41
	v_cvt_pk_bf16_f32 v237, v42, v43
	v_cvt_pk_bf16_f32 v244, v72, v73
	v_cvt_pk_bf16_f32 v245, v74, v75
	s_waitcnt vmcnt(17)
	ds_read_b64_tr_b16 a[128:129], v248 offset:0
	ds_read_b64_tr_b16 a[130:131], v248 offset:1024
	ds_read_b64_tr_b16 a[132:133], v249 offset:0
	ds_read_b64_tr_b16 a[134:135], v249 offset:1024
	ds_read_b64_tr_b16 a[136:137], v248 offset:2048
	ds_read_b64_tr_b16 a[138:139], v248 offset:3072
	ds_read_b64_tr_b16 a[140:141], v249 offset:2048
	ds_read_b64_tr_b16 a[142:143], v249 offset:3072
	s_waitcnt lgkmcnt(8)
	v_pk_fma_f32 v[44:45], v[44:45], v[204:205], s[88:89]
	v_pk_fma_f32 v[46:47], v[46:47], v[206:207], s[88:89]
	v_pk_mul_f32 v[132:133], v[44:45], s[90:91]
	v_pk_mul_f32 v[134:135], v[46:47], s[90:91]
	v_exp_f32_e64 v132, v132 clamp
	v_max_f32_e64 v44, s88, v44
	buffer_load_dwordx4 v7, s[8:11], s57 offen offset:1024 lds
	v_exp_f32_e64 v133, v133 clamp
	v_max_f32_e64 v45, s88, v45
	v_exp_f32_e64 v134, v134 clamp
	v_max_f32_e64 v46, s88, v46
	v_exp_f32_e64 v135, v135 clamp
	v_max_f32 v47, s88, v47
	s_add_u32 s56, s43, 7
	s_and_b32 s56, s56, L_end-L_exit-4+7
	s_mul_i32 s57, s56, s51
	s_add_u32 m0, s54, 57344
	s_add_u32 s57, s57, s49
	v_pk_add_f32 v[44:45], v[44:45], v[132:133]
	v_pk_add_f32 v[46:47], v[46:47], v[134:135]
	v_pk_mul_f32 v[76:77], v[76:77], v[204:205]
	v_pk_mul_f32 v[78:79], v[78:79], v[206:207]
	v_cvt_pk_bf16_f32 v238, v44, v45
	v_cvt_pk_bf16_f32 v239, v46, v47
	buffer_load_dwordx4 v6, s[8:11], s57 offen lds
	v_cvt_pk_bf16_f32 v246, v76, v77
	v_cvt_pk_bf16_f32 v247, v78, v79
	v_mfma_f32_32x32x16_bf16 v[32:47], v[232:235], v[240:243], 0
	v_mfma_f32_16x16x32_bf16 v[64:67], v[176:179], v[232:235], 0
	v_mfma_f32_32x32x16_bf16 v[32:47], v[236:239], v[244:247], v[32:47]
	v_mfma_f32_16x16x32_bf16 v[64:67], v[176:179], v[236:239], v[64:67]
	v_and_b32_e64 v138, 15, v0
	v_bfe_u32 v139, v0, 4, 1
	v_lshl_add_u32 v138, v139, 5, v138
	s_and_b32 s80, s40, 1
	s_lshl_b32 s80, s80, 4
	v_add_u32_e64 v138, s80, v138
	buffer_load_dwordx4 v7, s[8:11], s57 offen offset:1024 lds
	v_lshlrev_b32 v138, 4, v138
	v_lshrrev_b32 v139, 5, v0
	v_lshl_add_u32 v138, v139, 10, v138
	s_lshr_b32 s80, s40, 1
	s_lshl_b32 s80, s80, 11
	s_add_u32 s80, s80, 143360
	s_add_u32 m0, s52, 12288
	s_add_u32 s58, s70, 98304
	v_add_u32 v138, s80, v138
	v_and_b32 v140, 48, v0
	s_lshl_b32 s80, s40, L_end-L_exit-4+6
	s_add_u32 s80, s80, 160768
	v_add_u32 v139, s80, v140
	s_lshl4_add_u32 s80, s75, s41
	buffer_load_dwordx4 v10, s[12:15], s58 offen offset:0 lds
	s_lshl_b32 s81, s80, L_end-L_exit-4+10
	s_add_u32 s81, s81, 9437184
	s_lshl_b32 s82, s80, L_end-L_exit-4+7
	s_add_u32 s82, s82, 9961472
	v_cndmask_b32 v32, v32, v40, s[64:65]
	v_cndmask_b32 v33, v33, v41, s[64:65]
	v_cndmask_b32 v34, v34, v42, s[64:65]
	v_cndmask_b32 v35, v35, v43, s[64:65]
	v_cndmask_b32 v36, v36, v44, s[64:65]
	v_cndmask_b32 v37, v37, v45, s[64:65]
	v_cndmask_b32 v38, v38, v46, s[64:65]
	v_cndmask_b32 v39, v39, v47, s[64:65]
	buffer_load_dwordx4 v11, s[12:15], s58 offen offset:1024 lds
	ds_write_b128 v136, v[32:35] offset:0
	ds_write_b128 v136, v[36:39] offset:1024
	ds_write_b32 v137, v64 offset:0
	s_waitcnt vmcnt(14)
	s_nop 0
	ds_read_b64_tr_b16 a[144:145], v248 offset:4096
	ds_read_b64_tr_b16 a[146:147], v248 offset:5120
	ds_read_b64_tr_b16 a[148:149], v249 offset:4096
	ds_read_b64_tr_b16 a[150:151], v249 offset:5120
	ds_read_b64_tr_b16 a[152:153], v248 offset:6144
	ds_read_b64_tr_b16 a[154:155], v248 offset:7168
	ds_read_b64_tr_b16 a[156:157], v249 offset:6144
	ds_read_b64_tr_b16 a[158:159], v249 offset:7168
	v_pk_fma_f32 v[48:49], v[48:49], v[192:193], s[88:89]
	v_pk_fma_f32 v[50:51], v[50:51], v[194:195], s[88:89]
	v_pk_mul_f32 v[132:133], v[48:49], s[90:91]
	v_pk_mul_f32 v[134:135], v[50:51], s[90:91]
	v_exp_f32_e64 v132, v132 clamp
	v_max_f32_e64 v48, s88, v48
	v_exp_f32_e64 v133, v133 clamp
	v_max_f32_e64 v49, s88, v49
	buffer_load_dwordx4 v12, s[12:15], s58 offen offset:2048 lds
	v_exp_f32_e64 v134, v134 clamp
	v_max_f32_e64 v50, s88, v50
	v_exp_f32_e64 v135, v135 clamp
	v_max_f32_e64 v51, s88, v51
	v_pk_add_f32 v[48:49], v[48:49], v[132:133]
	v_pk_add_f32 v[50:51], v[50:51], v[134:135]
	v_pk_mul_f32 v[80:81], v[80:81], v[192:193]
	v_pk_mul_f32 v[82:83], v[82:83], v[194:195]
	v_cvt_pk_bf16_f32 v232, v48, v49
	v_cvt_pk_bf16_f32 v233, v50, v51
	v_cvt_pk_bf16_f32 v240, v80, v81
	v_cvt_pk_bf16_f32 v241, v82, v83
	buffer_load_dwordx4 v13, s[12:15], s58 offen offset:3072 lds
	s_waitcnt vmcnt(8)
	s_nop 0
	ds_read_b64_tr_b16 a[160:161], v248 offset:8192
	ds_read_b64_tr_b16 a[162:163], v248 offset:9216
	ds_read_b64_tr_b16 a[164:165], v249 offset:8192
	ds_read_b64_tr_b16 a[166:167], v249 offset:9216
	ds_read_b64_tr_b16 a[168:169], v248 offset:10240
	ds_read_b64_tr_b16 a[170:171], v248 offset:11264
	ds_read_b64_tr_b16 a[172:173], v249 offset:10240
	ds_read_b64_tr_b16 a[174:175], v249 offset:11264
	v_pk_fma_f32 v[52:53], v[52:53], v[196:197], s[88:89]
	v_pk_fma_f32 v[54:55], v[54:55], v[198:199], s[88:89]
	v_pk_mul_f32 v[132:133], v[52:53], s[90:91]
	v_pk_mul_f32 v[134:135], v[54:55], s[90:91]
	v_exp_f32_e64 v132, v132 clamp
	s_waitcnt lgkmcnt(15)
	s_add_u32 m0, s52, 0
	s_add_u32 s58, s70, 262144
	v_max_f32_e64 v52, s88, v52
	v_exp_f32_e64 v133, v133 clamp
	v_max_f32_e64 v53, s88, v53
	v_exp_f32_e64 v134, v134 clamp
	v_max_f32_e64 v54, s88, v54
	v_exp_f32_e64 v135, v135 clamp
	buffer_load_dwordx4 v10, s[12:15], s58 offen offset:0 lds
	v_max_f32_e64 v55, s88, v55
	v_pk_add_f32 v[52:53], v[52:53], v[132:133]
	v_pk_add_f32 v[54:55], v[54:55], v[134:135]
	v_pk_mul_f32 v[84:85], v[84:85], v[196:197]
	v_pk_mul_f32 v[86:87], v[86:87], v[198:199]
	v_cvt_pk_bf16_f32 v234, v52, v53
	v_cvt_pk_bf16_f32 v235, v54, v55
	v_cvt_pk_bf16_f32 v242, v84, v85
	v_cvt_pk_bf16_f32 v243, v86, v87
	v_pk_fma_f32 v[56:57], v[56:57], v[200:201], s[88:89]
	v_pk_fma_f32 v[58:59], v[58:59], v[202:203], s[88:89]
	v_pk_mul_f32 v[132:133], v[56:57], s[90:91]
	buffer_load_dwordx4 v11, s[12:15], s58 offen offset:1024 lds
	v_pk_mul_f32 v[134:135], v[58:59], s[90:91]
	v_exp_f32_e64 v132, v132 clamp
	v_max_f32_e64 v56, s88, v56
	v_exp_f32_e64 v133, v133 clamp
	v_max_f32_e64 v57, s88, v57
	v_exp_f32_e64 v134, v134 clamp
	v_max_f32_e64 v58, s88, v58
	v_exp_f32_e64 v135, v135 clamp
	v_max_f32_e64 v59, s88, v59
	v_pk_add_f32 v[56:57], v[56:57], v[132:133]
	v_pk_add_f32 v[58:59], v[58:59], v[134:135]
	v_pk_mul_f32 v[88:89], v[88:89], v[200:201]
	buffer_load_dwordx4 v12, s[12:15], s58 offen offset:2048 lds
	v_pk_mul_f32 v[90:91], v[90:91], v[202:203]
	v_cvt_pk_bf16_f32 v236, v56, v57
	v_cvt_pk_bf16_f32 v237, v58, v59
	v_cvt_pk_bf16_f32 v244, v88, v89
	v_cvt_pk_bf16_f32 v245, v90, v91
	v_pk_fma_f32 v[60:61], v[60:61], v[204:205], s[88:89]
	v_pk_fma_f32 v[62:63], v[62:63], v[206:207], s[88:89]
	v_pk_mul_f32 v[132:133], v[60:61], s[90:91]
	v_pk_mul_f32 v[134:135], v[62:63], s[90:91]
	v_exp_f32_e64 v132, v132 clamp
	v_max_f32_e64 v60, s88, v60
	v_exp_f32_e64 v133, v133 clamp
	buffer_load_dwordx4 v13, s[12:15], s58 offen offset:3072 lds
	v_max_f32_e64 v61, s88, v61
	v_exp_f32_e64 v134, v134 clamp
	v_max_f32_e64 v62, s88, v62
	v_exp_f32_e64 v135, v135 clamp
	v_max_f32 v63, s88, v63
	v_pk_add_f32 v[60:61], v[60:61], v[132:133]
	s_waitcnt lgkmcnt(8)
	s_add_u32 m0, s52, 4096
	s_add_u32 s58, s70, 294912
	v_pk_add_f32 v[62:63], v[62:63], v[134:135]
	v_pk_mul_f32 v[92:93], v[92:93], v[204:205]
	v_pk_mul_f32 v[94:95], v[94:95], v[206:207]
	v_cvt_pk_bf16_f32 v238, v60, v61
	v_cvt_pk_bf16_f32 v239, v62, v63
	v_cvt_pk_bf16_f32 v246, v92, v93
	buffer_load_dwordx4 v10, s[12:15], s58 offen offset:0 lds
	v_cvt_pk_bf16_f32 v247, v94, v95
	v_mfma_f32_32x32x16_bf16 v[48:63], v[232:235], v[240:243], 0
	v_mfma_f32_16x16x32_bf16 v[80:83], v[176:179], v[232:235], 0
	v_mfma_f32_32x32x16_bf16 v[48:63], v[236:239], v[244:247], v[48:63]
	v_mfma_f32_16x16x32_bf16 v[80:83], v[176:179], v[236:239], v[80:83]
	s_waitcnt vmcnt(5)
	s_nop 0
	ds_read_b64_tr_b16 a[176:177], v248 offset:12288
	ds_read_b64_tr_b16 a[178:179], v248 offset:13312
	ds_read_b64_tr_b16 a[180:181], v249 offset:12288
	ds_read_b64_tr_b16 a[182:183], v249 offset:13312
	ds_read_b64_tr_b16 a[184:185], v248 offset:14336
	ds_read_b64_tr_b16 a[186:187], v248 offset:15360
	ds_read_b64_tr_b16 a[188:189], v249 offset:14336
	ds_read_b64_tr_b16 a[190:191], v249 offset:15360
	s_nop 3
	s_nop 0
	v_cndmask_b32 v48, v48, v56, s[64:65]
	v_cndmask_b32 v49, v49, v57, s[64:65]
	v_cndmask_b32 v50, v50, v58, s[64:65]
	v_cndmask_b32 v51, v51, v59, s[64:65]
	v_cndmask_b32 v52, v52, v60, s[64:65]
	buffer_load_dwordx4 v11, s[12:15], s58 offen offset:1024 lds
	v_cndmask_b32 v53, v53, v61, s[64:65]
	v_cndmask_b32 v54, v54, v62, s[64:65]
	v_cndmask_b32 v55, v55, v63, s[64:65]
	ds_write_b128 v136, v[48:51] offset:2048
	ds_write_b128 v136, v[52:55] offset:3072
	ds_write_b32 v137, v80 offset:128
	s_waitcnt lgkmcnt(0)
	s_barrier
	ds_read_b128 v[192:195], v138 offset:0
	ds_read_b128 v[196:199], v138 offset:4096
	ds_read_b128 v[200:203], v138 offset:8192
	ds_read_b128 v[204:207], v138 offset:12288
	ds_read_b128 v[208:211], v139 offset:0
	buffer_load_dwordx4 v12, s[12:15], s58 offen offset:2048 lds
	ds_read_b128 v[212:215], v139 offset:256
	ds_read_b128 v[216:219], v139 offset:512
	ds_read_b128 v[220:223], v139 offset:768
	s_waitcnt lgkmcnt(6)
	v_pk_add_f32 v[192:193], v[192:193], v[196:197]
	v_pk_add_f32 v[194:195], v[194:195], v[198:199]
	s_waitcnt lgkmcnt(4)
	v_pk_add_f32 v[200:201], v[200:201], v[204:205]
	v_pk_add_f32 v[202:203], v[202:203], v[206:207]
	v_pk_add_f32 v[192:193], v[192:193], v[200:201]
	v_pk_add_f32 v[194:195], v[194:195], v[202:203]
	v_bfi_b32 v192, 3, s67, v192
	v_bfi_b32 v193, 3, v253, v193
	s_waitcnt lgkmcnt(2)
	v_pk_add_f32 v[208:209], v[208:209], v[212:213]
	buffer_load_dwordx4 v13, s[12:15], s58 offen offset:3072 lds
	v_pk_add_f32 v[210:211], v[210:211], v[214:215]
	s_waitcnt lgkmcnt(0)
	v_pk_add_f32 v[216:217], v[216:217], v[220:221]
	v_pk_add_f32 v[218:219], v[218:219], v[222:223]
	v_pk_add_f32 v[208:209], v[208:209], v[216:217]
	v_pk_add_f32 v[210:211], v[210:211], v[218:219]
	v_bfi_b32 v208, 3, s67, v208
	v_bfi_b32 v209, 3, v253, v209
	buffer_store_dwordx4 v[192:195], v1, s[20:23], s81 offen sc1
	s_mov_b32 s84, 0x00010001
	s_mov_b32 s85, 0x00010001
	s_mov_b64 exec, s[84:85]
	buffer_store_dwordx4 v[208:211], v140, s[20:23], s82 offen sc1
	s_mov_b64 exec, -1
	v_mfma_f32_32x32x16_bf16 v[96:111], v[144:147], a[0:3], 0
	s_add_u32 m0, s52, 8192
	s_add_u32 s58, s70, 327680
	ds_read_b64_tr_b16 v[160:161], v19 offset:0
	ds_read_b64_tr_b16 v[162:163], v19 offset:512
	ds_read_b64_tr_b16 v[164:165], v20 offset:0
	ds_read_b64_tr_b16 v[166:167], v20 offset:512
	v_mfma_f32_16x16x32_bf16 v[180:183], v[176:179], v[144:147], 0
	buffer_load_dwordx4 v10, s[12:15], s58 offen offset:0 lds
	v_mfma_f32_32x32x16_bf16 v[112:127], v[148:151], a[0:3], 0
	v_mfma_f32_16x16x32_bf16 v[184:187], v[176:179], v[148:151], 0
	buffer_load_dwordx4 v11, s[12:15], s58 offen offset:1024 lds
	v_mfma_f32_32x32x16_bf16 v[96:111], v[152:155], a[4:7], v[96:111]
	ds_read_b64_tr_b16 v[168:169], v21 offset:0
	ds_read_b64_tr_b16 v[170:171], v21 offset:512
	ds_read_b64_tr_b16 v[172:173], v22 offset:0
	ds_read_b64_tr_b16 v[174:175], v22 offset:512
	buffer_load_dwordx4 v12, s[12:15], s58 offen offset:2048 lds
	v_mfma_f32_32x32x16_bf16 v[112:127], v[156:159], a[4:7], v[112:127]
	buffer_load_dwordx4 v13, s[12:15], s58 offen offset:3072 lds
	s_waitcnt lgkmcnt(4)
	v_mfma_f32_32x32x16_bf16 v[96:111], v[160:163], a[8:11], v[96:111]
	s_add_u32 m0, s52, 12288
	s_add_u32 s58, s70, 360448
	ds_read_b64_tr_b16 v[144:145], v15 offset:8192
	ds_read_b64_tr_b16 v[146:147], v15 offset:8704
	ds_read_b64_tr_b16 v[148:149], v16 offset:8192
	ds_read_b64_tr_b16 v[150:151], v16 offset:8704
	s_waitcnt vmcnt(10)
	ds_read_b64_tr_b16 a[192:193], v248 offset:0
	buffer_load_dwordx4 v10, s[12:15], s58 offen offset:0 lds
	ds_read_b64_tr_b16 a[194:195], v248 offset:1024
	ds_read_b64_tr_b16 a[196:197], v249 offset:0
	ds_read_b64_tr_b16 a[198:199], v249 offset:1024
	v_mfma_f32_32x32x16_bf16 v[112:127], v[164:167], a[8:11], v[112:127]
	ds_read_b64_tr_b16 a[200:201], v248 offset:2048
	ds_read_b64_tr_b16 a[202:203], v248 offset:3072
	buffer_load_dwordx4 v11, s[12:15], s58 offen offset:1024 lds
	ds_read_b64_tr_b16 a[204:205], v249 offset:2048
	ds_read_b64_tr_b16 a[206:207], v249 offset:3072
	s_waitcnt lgkmcnt(12)
	v_mfma_f32_32x32x16_bf16 v[96:111], v[168:171], a[12:15], v[96:111]
	ds_read_b64_tr_b16 v[152:153], v17 offset:8192
	ds_read_b64_tr_b16 v[154:155], v17 offset:8704
	ds_read_b64_tr_b16 v[156:157], v18 offset:8192
	ds_read_b64_tr_b16 v[158:159], v18 offset:8704
	buffer_load_dwordx4 v12, s[12:15], s58 offen offset:2048 lds
	v_mfma_f32_32x32x16_bf16 v[112:127], v[172:175], a[12:15], v[112:127]
	buffer_load_dwordx4 v13, s[12:15], s58 offen offset:3072 lds
	s_waitcnt lgkmcnt(12)
	v_mfma_f32_32x32x16_bf16 v[96:111], v[144:147], a[16:19], v[96:111]
	s_waitcnt lgkmcnt(4)
	s_add_u32 m0, s52, 0
	s_add_u32 s58, s70, 131072
	ds_read_b64_tr_b16 v[160:161], v19 offset:8192
	ds_read_b64_tr_b16 v[162:163], v19 offset:8704
	ds_read_b64_tr_b16 v[164:165], v20 offset:8192
	ds_read_b64_tr_b16 v[166:167], v20 offset:8704
	s_waitcnt vmcnt(10)
	ds_read_b64_tr_b16 a[208:209], v248 offset:4096
	v_mfma_f32_16x16x32_bf16 v[180:183], v[176:179], v[144:147], v[180:183]
	buffer_load_dwordx4 v10, s[12:15], s58 offen offset:0 lds
	ds_read_b64_tr_b16 a[210:211], v248 offset:5120
	ds_read_b64_tr_b16 a[212:213], v249 offset:4096
	ds_read_b64_tr_b16 a[214:215], v249 offset:5120
	v_mfma_f32_32x32x16_bf16 v[112:127], v[148:151], a[16:19], v[112:127]
	ds_read_b64_tr_b16 a[216:217], v248 offset:6144
	ds_read_b64_tr_b16 a[218:219], v248 offset:7168
	v_mfma_f32_16x16x32_bf16 v[184:187], v[176:179], v[148:151], v[184:187]
	buffer_load_dwordx4 v11, s[12:15], s58 offen offset:1024 lds
	ds_read_b64_tr_b16 a[220:221], v249 offset:6144
	ds_read_b64_tr_b16 a[222:223], v249 offset:7168
	s_waitcnt lgkmcnt(12)
	v_mfma_f32_32x32x16_bf16 v[96:111], v[152:155], a[20:23], v[96:111]
	ds_read_b64_tr_b16 v[168:169], v21 offset:8192
	ds_read_b64_tr_b16 v[170:171], v21 offset:8704
	ds_read_b64_tr_b16 v[172:173], v22 offset:8192
	ds_read_b64_tr_b16 v[174:175], v22 offset:8704
	buffer_load_dwordx4 v12, s[12:15], s58 offen offset:2048 lds
	v_mfma_f32_32x32x16_bf16 v[112:127], v[156:159], a[20:23], v[112:127]
	buffer_load_dwordx4 v13, s[12:15], s58 offen offset:3072 lds
	s_waitcnt lgkmcnt(12)
	v_mfma_f32_32x32x16_bf16 v[96:111], v[160:163], a[24:27], v[96:111]
	s_waitcnt lgkmcnt(0)
	s_barrier
	s_add_u32 m0, s52, 4096
	s_add_u32 s58, s70, 163840
	ds_read_b64_tr_b16 v[144:145], v15 offset:16384
	ds_read_b64_tr_b16 v[146:147], v15 offset:16896
	ds_read_b64_tr_b16 v[148:149], v16 offset:16384
	ds_read_b64_tr_b16 v[150:151], v16 offset:16896
	s_waitcnt vmcnt(8)
	ds_read_b64_tr_b16 a[224:225], v248 offset:8192
	buffer_load_dwordx4 v10, s[12:15], s58 offen offset:0 lds
	ds_read_b64_tr_b16 a[226:227], v248 offset:9216
	ds_read_b64_tr_b16 a[228:229], v249 offset:8192
	ds_read_b64_tr_b16 a[230:231], v249 offset:9216
	v_mfma_f32_32x32x16_bf16 v[112:127], v[164:167], a[24:27], v[112:127]
	ds_read_b64_tr_b16 a[232:233], v248 offset:10240
	ds_read_b64_tr_b16 a[234:235], v248 offset:11264
	buffer_load_dwordx4 v11, s[12:15], s58 offen offset:1024 lds
	ds_read_b64_tr_b16 a[236:237], v249 offset:10240
	ds_read_b64_tr_b16 a[238:239], v249 offset:11264
	v_mfma_f32_32x32x16_bf16 v[96:111], v[168:171], a[28:31], v[96:111]
	ds_read_b64_tr_b16 v[152:153], v17 offset:16384
	ds_read_b64_tr_b16 v[154:155], v17 offset:16896
	ds_read_b64_tr_b16 v[156:157], v18 offset:16384
	ds_read_b64_tr_b16 v[158:159], v18 offset:16896
	buffer_load_dwordx4 v12, s[12:15], s58 offen offset:2048 lds
	v_mfma_f32_32x32x16_bf16 v[112:127], v[172:175], a[28:31], v[112:127]
	buffer_load_dwordx4 v13, s[12:15], s58 offen offset:3072 lds
	s_waitcnt lgkmcnt(12)
	v_mfma_f32_32x32x16_bf16 v[96:111], v[144:147], a[32:35], v[96:111]
	s_waitcnt lgkmcnt(4)
	s_add_u32 m0, s52, 8192
	s_add_u32 s58, s70, 393216
	ds_read_b64_tr_b16 v[160:161], v19 offset:16384
	ds_read_b64_tr_b16 v[162:163], v19 offset:16896
	ds_read_b64_tr_b16 v[164:165], v20 offset:16384
	ds_read_b64_tr_b16 v[166:167], v20 offset:16896
	v_mfma_f32_16x16x32_bf16 v[180:183], v[176:179], v[144:147], v[180:183]
	buffer_load_dwordx4 v10, s[12:15], s58 offen offset:0 lds
	v_mfma_f32_32x32x16_bf16 v[112:127], v[148:151], a[32:35], v[112:127]
	v_mfma_f32_16x16x32_bf16 v[184:187], v[176:179], v[148:151], v[184:187]
	buffer_load_dwordx4 v11, s[12:15], s58 offen offset:1024 lds
	s_waitcnt lgkmcnt(4)
	v_mfma_f32_32x32x16_bf16 v[96:111], v[152:155], a[36:39], v[96:111]
	ds_read_b64_tr_b16 v[168:169], v21 offset:16384
	ds_read_b64_tr_b16 v[170:171], v21 offset:16896
	ds_read_b64_tr_b16 v[172:173], v22 offset:16384
	ds_read_b64_tr_b16 v[174:175], v22 offset:16896
	s_waitcnt vmcnt(10)
	ds_read_b64_tr_b16 a[240:241], v248 offset:12288
	buffer_load_dwordx4 v12, s[12:15], s58 offen offset:2048 lds
	ds_read_b64_tr_b16 a[242:243], v248 offset:13312
	ds_read_b64_tr_b16 a[244:245], v249 offset:12288
	ds_read_b64_tr_b16 a[246:247], v249 offset:13312
	v_mfma_f32_32x32x16_bf16 v[112:127], v[156:159], a[36:39], v[112:127]
	ds_read_b64_tr_b16 a[248:249], v248 offset:14336
	ds_read_b64_tr_b16 a[250:251], v248 offset:15360
	buffer_load_dwordx4 v13, s[12:15], s58 offen offset:3072 lds
	ds_read_b64_tr_b16 a[252:253], v249 offset:14336
	ds_read_b64_tr_b16 a[254:255], v249 offset:15360
	s_waitcnt lgkmcnt(12)
	v_mfma_f32_32x32x16_bf16 v[96:111], v[160:163], a[40:43], v[96:111]
	s_waitcnt lgkmcnt(0)
	s_add_u32 m0, s52, 12288
	s_add_u32 s58, s70, 425984
	ds_read_b64_tr_b16 v[144:145], v15 offset:24576
	ds_read_b64_tr_b16 v[146:147], v15 offset:25088
	ds_read_b64_tr_b16 v[148:149], v16 offset:24576
	ds_read_b64_tr_b16 v[150:151], v16 offset:25088
	buffer_load_dwordx4 v10, s[12:15], s58 offen offset:0 lds
	v_mfma_f32_32x32x16_bf16 v[112:127], v[164:167], a[40:43], v[112:127]
	buffer_load_dwordx4 v11, s[12:15], s58 offen offset:1024 lds
	v_mfma_f32_32x32x16_bf16 v[96:111], v[168:171], a[44:47], v[96:111]
	ds_read_b64_tr_b16 v[152:153], v17 offset:24576
	ds_read_b64_tr_b16 v[154:155], v17 offset:25088
	ds_read_b64_tr_b16 v[156:157], v18 offset:24576
	ds_read_b64_tr_b16 v[158:159], v18 offset:25088
	s_waitcnt vmcnt(10)
	s_nop 0
	ds_read_b64_tr_b16 a[0:1], v248 offset:0
	buffer_load_dwordx4 v12, s[12:15], s58 offen offset:2048 lds
	ds_read_b64_tr_b16 a[2:3], v248 offset:1024
	ds_read_b64_tr_b16 a[4:5], v249 offset:0
	ds_read_b64_tr_b16 a[6:7], v249 offset:1024
	v_mfma_f32_32x32x16_bf16 v[112:127], v[172:175], a[44:47], v[112:127]
	ds_read_b64_tr_b16 a[8:9], v248 offset:2048
	ds_read_b64_tr_b16 a[10:11], v248 offset:3072
	buffer_load_dwordx4 v13, s[12:15], s58 offen offset:3072 lds
	ds_read_b64_tr_b16 a[12:13], v249 offset:2048
	ds_read_b64_tr_b16 a[14:15], v249 offset:3072
	s_waitcnt lgkmcnt(12)
	v_mfma_f32_32x32x16_bf16 v[96:111], v[144:147], a[48:51], v[96:111]
	s_waitcnt lgkmcnt(0)
	s_add_u32 m0, s52, L_end-L_exit-4+0
	s_add_u32 s58, s70, 196608
	ds_read_b64_tr_b16 v[160:161], v19 offset:24576
	ds_read_b64_tr_b16 v[162:163], v19 offset:25088
	ds_read_b64_tr_b16 v[164:165], v20 offset:24576
	ds_read_b64_tr_b16 v[166:167], v20 offset:25088
	v_mfma_f32_16x16x32_bf16 v[180:183], v[176:179], v[144:147], v[180:183]
	buffer_load_dwordx4 v10, s[12:15], s58 offen offset:0 lds
	v_mfma_f32_32x32x16_bf16 v[112:127], v[148:151], a[48:51], v[112:127]
	v_mfma_f32_16x16x32_bf16 v[184:187], v[176:179], v[148:151], v[184:187]
	buffer_load_dwordx4 v11, s[12:15], s58 offen offset:1024 lds
	v_mfma_f32_32x32x16_bf16 v[96:111], v[152:155], a[52:55], v[96:111]
	ds_read_b64_tr_b16 v[168:169], v21 offset:24576
	ds_read_b64_tr_b16 v[170:171], v21 offset:25088
	ds_read_b64_tr_b16 v[172:173], v22 offset:24576
	ds_read_b64_tr_b16 v[174:175], v22 offset:25088
	s_waitcnt vmcnt(10)
	s_nop 0
	ds_read_b64_tr_b16 a[16:17], v248 offset:4096
	buffer_load_dwordx4 v12, s[12:15], s58 offen offset:2048 lds
	ds_read_b64_tr_b16 a[18:19], v248 offset:5120
	ds_read_b64_tr_b16 a[20:21], v249 offset:4096
	ds_read_b64_tr_b16 a[22:23], v249 offset:5120
	v_mfma_f32_32x32x16_bf16 v[112:127], v[156:159], a[52:55], v[112:127]
	ds_read_b64_tr_b16 a[24:25], v248 offset:6144
	ds_read_b64_tr_b16 a[26:27], v248 offset:7168
	buffer_load_dwordx4 v13, s[12:15], s58 offen offset:3072 lds
	ds_read_b64_tr_b16 a[28:29], v249 offset:6144
	ds_read_b64_tr_b16 a[30:31], v249 offset:7168
	s_waitcnt lgkmcnt(12)
	v_mfma_f32_32x32x16_bf16 v[96:111], v[160:163], a[56:59], v[96:111]
	s_waitcnt lgkmcnt(8)
	s_barrier
	s_waitcnt lgkmcnt(0)
	s_add_u32 m0, s52, 4096
	s_add_u32 s58, s70, 229376
	ds_read_b64_tr_b16 v[144:145], v15 offset:32768
	ds_read_b64_tr_b16 v[146:147], v15 offset:33280
	ds_read_b64_tr_b16 v[148:149], v16 offset:32768
	ds_read_b64_tr_b16 v[150:151], v16 offset:33280
	buffer_load_dwordx4 v10, s[12:15], s58 offen offset:0 lds
	v_mfma_f32_32x32x16_bf16 v[112:127], v[164:167], a[56:59], v[112:127]
	buffer_load_dwordx4 v11, s[12:15], s58 offen offset:1024 lds
	v_mfma_f32_32x32x16_bf16 v[96:111], v[168:171], a[60:63], v[96:111]
	ds_read_b64_tr_b16 v[152:153], v17 offset:32768
	ds_read_b64_tr_b16 v[154:155], v17 offset:33280
	ds_read_b64_tr_b16 v[156:157], v18 offset:32768
	ds_read_b64_tr_b16 v[158:159], v18 offset:33280
	s_waitcnt vmcnt(10)
	s_nop 0
	ds_read_b64_tr_b16 a[32:33], v248 offset:8192
	buffer_load_dwordx4 v12, s[12:15], s58 offen offset:2048 lds
	ds_read_b64_tr_b16 a[34:35], v248 offset:9216
	ds_read_b64_tr_b16 a[36:37], v249 offset:8192
	ds_read_b64_tr_b16 a[38:39], v249 offset:9216
	v_mfma_f32_32x32x16_bf16 v[112:127], v[172:175], a[60:63], v[112:127]
	ds_read_b64_tr_b16 a[40:41], v248 offset:10240
	ds_read_b64_tr_b16 a[42:43], v248 offset:11264
	buffer_load_dwordx4 v13, s[12:15], s58 offen offset:3072 lds
	ds_read_b64_tr_b16 a[44:45], v249 offset:10240
	ds_read_b64_tr_b16 a[46:47], v249 offset:11264
	s_waitcnt lgkmcnt(12)
	v_mfma_f32_32x32x16_bf16 v[96:111], v[144:147], a[64:67], v[96:111]
	s_waitcnt lgkmcnt(0)
	s_add_u32 m0, s52, 8192
	s_add_u32 s58, s71, L_end-L_exit-4+0
	ds_read_b64_tr_b16 v[160:161], v19 offset:32768
	ds_read_b64_tr_b16 v[162:163], v19 offset:33280
	ds_read_b64_tr_b16 v[164:165], v20 offset:32768
	ds_read_b64_tr_b16 v[166:167], v20 offset:33280
	v_mfma_f32_16x16x32_bf16 v[180:183], v[176:179], v[144:147], v[180:183]
	buffer_load_dwordx4 v10, s[16:19], s58 offen offset:0 lds
	v_mfma_f32_32x32x16_bf16 v[112:127], v[148:151], a[64:67], v[112:127]
	v_mfma_f32_16x16x32_bf16 v[184:187], v[176:179], v[148:151], v[184:187]
	buffer_load_dwordx4 v11, s[16:19], s58 offen offset:1024 lds
	v_mfma_f32_32x32x16_bf16 v[96:111], v[152:155], a[68:71], v[96:111]
	ds_read_b64_tr_b16 v[168:169], v21 offset:32768
	ds_read_b64_tr_b16 v[170:171], v21 offset:33280
	ds_read_b64_tr_b16 v[172:173], v22 offset:32768
	ds_read_b64_tr_b16 v[174:175], v22 offset:33280
	buffer_load_dwordx4 v12, s[16:19], s58 offen offset:2048 lds
	v_mfma_f32_32x32x16_bf16 v[112:127], v[156:159], a[68:71], v[112:127]
	buffer_load_dwordx4 v13, s[16:19], s58 offen offset:3072 lds
	s_waitcnt lgkmcnt(4)
	v_mfma_f32_32x32x16_bf16 v[96:111], v[160:163], a[72:75], v[96:111]
	ds_read_b64_tr_b16 v[144:145], v15 offset:40960
	ds_read_b64_tr_b16 v[146:147], v15 offset:41472
	ds_read_b64_tr_b16 v[148:149], v16 offset:40960
	ds_read_b64_tr_b16 v[150:151], v16 offset:41472
	s_waitcnt vmcnt(12)
	ds_read_b64_tr_b16 a[48:49], v248 offset:12288
	ds_read_b64_tr_b16 a[50:51], v248 offset:13312
	ds_read_b64_tr_b16 a[52:53], v249 offset:12288
	ds_read_b64_tr_b16 a[54:55], v249 offset:13312
	v_mfma_f32_32x32x16_bf16 v[112:127], v[164:167], a[72:75], v[112:127]
	ds_read_b64_tr_b16 a[56:57], v248 offset:14336
	ds_read_b64_tr_b16 a[58:59], v248 offset:15360
	ds_read_b64_tr_b16 a[60:61], v249 offset:14336
	ds_read_b64_tr_b16 a[62:63], v249 offset:15360
	s_waitcnt lgkmcnt(12)
	v_mfma_f32_32x32x16_bf16 v[96:111], v[168:171], a[76:79], v[96:111]
	s_waitcnt lgkmcnt(0)
	s_add_u32 m0, s52, 12288
	s_add_u32 s58, s71, 32768
	ds_read_b64_tr_b16 v[152:153], v17 offset:40960
	ds_read_b64_tr_b16 v[154:155], v17 offset:41472
	ds_read_b64_tr_b16 v[156:157], v18 offset:40960
	ds_read_b64_tr_b16 v[158:159], v18 offset:41472
	buffer_load_dwordx4 v10, s[16:19], s58 offen offset:0 lds
	v_mfma_f32_32x32x16_bf16 v[112:127], v[172:175], a[76:79], v[112:127]
	buffer_load_dwordx4 v11, s[16:19], s58 offen offset:1024 lds
	v_mfma_f32_32x32x16_bf16 v[96:111], v[144:147], a[80:83], v[96:111]
	ds_read_b64_tr_b16 v[160:161], v19 offset:40960
	ds_read_b64_tr_b16 v[162:163], v19 offset:41472
	ds_read_b64_tr_b16 v[164:165], v20 offset:40960
	ds_read_b64_tr_b16 v[166:167], v20 offset:41472
	v_mfma_f32_16x16x32_bf16 v[180:183], v[176:179], v[144:147], v[180:183]
	buffer_load_dwordx4 v12, s[16:19], s58 offen offset:2048 lds
	v_mfma_f32_32x32x16_bf16 v[112:127], v[148:151], a[80:83], v[112:127]
	v_mfma_f32_16x16x32_bf16 v[184:187], v[176:179], v[148:151], v[184:187]
	buffer_load_dwordx4 v13, s[16:19], s58 offen offset:3072 lds
	s_waitcnt lgkmcnt(4)
	v_mfma_f32_32x32x16_bf16 v[96:111], v[152:155], a[84:87], v[96:111]
	ds_read_b64_tr_b16 v[168:169], v21 offset:40960
	ds_read_b64_tr_b16 v[170:171], v21 offset:41472
	ds_read_b64_tr_b16 v[172:173], v22 offset:40960
	ds_read_b64_tr_b16 v[174:175], v22 offset:41472
	s_waitcnt vmcnt(12)
	ds_read_b64_tr_b16 a[64:65], v248 offset:0
	ds_read_b64_tr_b16 a[66:67], v248 offset:1024
	ds_read_b64_tr_b16 a[68:69], v249 offset:0
	ds_read_b64_tr_b16 a[70:71], v249 offset:1024
	v_mfma_f32_32x32x16_bf16 v[112:127], v[156:159], a[84:87], v[112:127]
	ds_read_b64_tr_b16 a[72:73], v248 offset:2048
	ds_read_b64_tr_b16 a[74:75], v248 offset:3072
	ds_read_b64_tr_b16 a[76:77], v249 offset:2048
	ds_read_b64_tr_b16 a[78:79], v249 offset:3072
	s_waitcnt lgkmcnt(12)
	v_mfma_f32_32x32x16_bf16 v[96:111], v[160:163], a[88:91], v[96:111]
	s_waitcnt lgkmcnt(8)
	s_barrier
	s_lshl_b32 s50, s75, 11
	s_add_u32 s50, s50, 9961472
	v_and_b32 v244, 15, v0
	v_lshlrev_b32 v244, 7, v244
	v_and_b32 v245, 48, v0
	v_add_u32 v244, v244, v245
	s_lshl_b32 s48, s75, L_end-L_exit-4+14
	s_add_u32 s48, s48, 9437184
	ds_read_b64_tr_b16 v[144:145], v15 offset:49152
	ds_read_b64_tr_b16 v[146:147], v15 offset:49664
	ds_read_b64_tr_b16 v[148:149], v16 offset:49152
	ds_read_b64_tr_b16 v[150:151], v16 offset:49664
	buffer_load_dwordx4 v[240:243], v244, s[20:23], s50 offen sc1
	v_mfma_f32_32x32x16_bf16 v[112:127], v[164:167], a[88:91], v[112:127]
	s_add_u32 s59, s48, 0
	buffer_load_dwordx4 v[32:35], v1, s[20:23], s59 offen offset:0 sc1
	v_mfma_f32_32x32x16_bf16 v[96:111], v[168:171], a[92:95], v[96:111]
	ds_read_b64_tr_b16 v[152:153], v17 offset:49152
	ds_read_b64_tr_b16 v[154:155], v17 offset:49664
	ds_read_b64_tr_b16 v[156:157], v18 offset:49152
	ds_read_b64_tr_b16 v[158:159], v18 offset:49664
	buffer_load_dwordx4 v[36:39], v1, s[20:23], s59 offen offset:1024 sc1
	v_mfma_f32_32x32x16_bf16 v[112:127], v[172:175], a[92:95], v[112:127]
	buffer_load_dwordx4 v[40:43], v1, s[20:23], s59 offen offset:2048 sc1
	s_waitcnt lgkmcnt(4)
	v_mfma_f32_32x32x16_bf16 v[96:111], v[144:147], a[96:99], v[96:111]
	ds_read_b64_tr_b16 v[160:161], v19 offset:49152
	ds_read_b64_tr_b16 v[162:163], v19 offset:49664
	ds_read_b64_tr_b16 v[164:165], v20 offset:49152
	ds_read_b64_tr_b16 v[166:167], v20 offset:49664
	v_mfma_f32_16x16x32_bf16 v[180:183], v[176:179], v[144:147], v[180:183]
	buffer_load_dwordx4 v[44:47], v1, s[20:23], s59 offen offset:3072 sc1
	v_mfma_f32_32x32x16_bf16 v[112:127], v[148:151], a[96:99], v[112:127]
	s_add_u32 s59, s48, 4096
	v_mfma_f32_16x16x32_bf16 v[184:187], v[176:179], v[148:151], v[184:187]
	buffer_load_dwordx4 v[48:51], v1, s[20:23], s59 offen offset:0 sc1
	s_waitcnt lgkmcnt(4)
	v_mfma_f32_32x32x16_bf16 v[96:111], v[152:155], a[100:103], v[96:111]
	ds_read_b64_tr_b16 v[168:169], v21 offset:49152
	ds_read_b64_tr_b16 v[170:171], v21 offset:49664
	ds_read_b64_tr_b16 v[172:173], v22 offset:49152
	ds_read_b64_tr_b16 v[174:175], v22 offset:49664
	s_waitcnt vmcnt(14)
	ds_read_b64_tr_b16 a[80:81], v248 offset:4096
	buffer_load_dwordx4 v[52:55], v1, s[20:23], s59 offen offset:1024 sc1
	ds_read_b64_tr_b16 a[82:83], v248 offset:5120
	ds_read_b64_tr_b16 a[84:85], v249 offset:4096
	ds_read_b64_tr_b16 a[86:87], v249 offset:5120
	v_mfma_f32_32x32x16_bf16 v[112:127], v[156:159], a[100:103], v[112:127]
	ds_read_b64_tr_b16 a[88:89], v248 offset:6144
	ds_read_b64_tr_b16 a[90:91], v248 offset:7168
	buffer_load_dwordx4 v[56:59], v1, s[20:23], s59 offen offset:2048 sc1
	ds_read_b64_tr_b16 a[92:93], v249 offset:6144
	ds_read_b64_tr_b16 a[94:95], v249 offset:7168
	s_waitcnt lgkmcnt(12)
	v_mfma_f32_32x32x16_bf16 v[96:111], v[160:163], a[104:107], v[96:111]
	ds_read_b64_tr_b16 v[144:145], v15 offset:57344
	ds_read_b64_tr_b16 v[146:147], v15 offset:57856
	ds_read_b64_tr_b16 v[148:149], v16 offset:57344
	ds_read_b64_tr_b16 v[150:151], v16 offset:57856
	buffer_load_dwordx4 v[60:63], v1, s[20:23], s59 offen offset:3072 sc1
	v_mfma_f32_32x32x16_bf16 v[112:127], v[164:167], a[104:107], v[112:127]
	s_add_u32 s59, s48, 8192
	buffer_load_dwordx4 v[64:67], v1, s[20:23], s59 offen offset:0 sc1
	s_waitcnt lgkmcnt(12)
	v_mfma_f32_32x32x16_bf16 v[96:111], v[168:171], a[108:111], v[96:111]
	ds_read_b64_tr_b16 v[152:153], v17 offset:57344
	ds_read_b64_tr_b16 v[154:155], v17 offset:57856
	ds_read_b64_tr_b16 v[156:157], v18 offset:57344
	ds_read_b64_tr_b16 v[158:159], v18 offset:57856
	buffer_load_dwordx4 v[68:71], v1, s[20:23], s59 offen offset:1024 sc1
	v_mfma_f32_32x32x16_bf16 v[112:127], v[172:175], a[108:111], v[112:127]
	buffer_load_dwordx4 v[72:75], v1, s[20:23], s59 offen offset:2048 sc1
	s_waitcnt lgkmcnt(4)
	v_mfma_f32_32x32x16_bf16 v[96:111], v[144:147], a[112:115], v[96:111]
	ds_read_b64_tr_b16 v[160:161], v19 offset:57344
	ds_read_b64_tr_b16 v[162:163], v19 offset:57856
	ds_read_b64_tr_b16 v[164:165], v20 offset:57344
	ds_read_b64_tr_b16 v[166:167], v20 offset:57856
	v_mfma_f32_16x16x32_bf16 v[180:183], v[176:179], v[144:147], v[180:183]
	buffer_load_dwordx4 v[76:79], v1, s[20:23], s59 offen offset:3072 sc1
	v_mfma_f32_32x32x16_bf16 v[112:127], v[148:151], a[112:115], v[112:127]
	s_add_u32 s59, s48, 12288
	v_mfma_f32_16x16x32_bf16 v[184:187], v[176:179], v[148:151], v[184:187]
	buffer_load_dwordx4 v[80:83], v1, s[20:23], s59 offen offset:0 sc1
	s_waitcnt lgkmcnt(4)
	v_mfma_f32_32x32x16_bf16 v[96:111], v[152:155], a[116:119], v[96:111]
	ds_read_b64_tr_b16 v[168:169], v21 offset:57344
	ds_read_b64_tr_b16 v[170:171], v21 offset:57856
	ds_read_b64_tr_b16 v[172:173], v22 offset:57344
	ds_read_b64_tr_b16 v[174:175], v22 offset:57856
	s_lshl_b32 s3, s40, L_end-L_exit-4+10
	s_add_u32 s3, s3, 135168
	v_add_u32_e64 v247, s3, v1
	v_mov_b32 v181, v184
	ds_write_b128 v247, v[180:183]
	s_waitcnt vmcnt(18)
	buffer_load_dwordx4 v[84:87], v1, s[20:23], s59 offen offset:1024 sc1
	ds_read_b64_tr_b16 a[96:97], v248 offset:8192
	ds_read_b64_tr_b16 a[98:99], v248 offset:9216
	ds_read_b64_tr_b16 a[100:101], v249 offset:8192
	v_mfma_f32_32x32x16_bf16 v[112:127], v[156:159], a[116:119], v[112:127]
	ds_read_b64_tr_b16 a[102:103], v249 offset:9216
	ds_read_b64_tr_b16 a[104:105], v248 offset:10240
	ds_read_b64_tr_b16 a[106:107], v248 offset:11264
	buffer_load_dwordx4 v[88:91], v1, s[20:23], s59 offen offset:2048 sc1
	ds_read_b64_tr_b16 a[108:109], v249 offset:10240
	ds_read_b64_tr_b16 a[110:111], v249 offset:11264
	s_waitcnt lgkmcnt(13)
	v_mfma_f32_32x32x16_bf16 v[96:111], v[160:163], a[120:123], v[96:111]
	buffer_load_dwordx4 v[92:95], v1, s[20:23], s59 offen offset:3072 sc1
	v_mfma_f32_32x32x16_bf16 v[112:127], v[164:167], a[120:123], v[112:127]
	s_add_u32 m0, s52, L_end-L_exit-4+0
	s_add_u32 s58, s71, 65536
	buffer_load_dwordx4 v10, s[16:19], s58 offen offset:0 lds
	s_waitcnt lgkmcnt(9)
	v_mfma_f32_32x32x16_bf16 v[96:111], v[168:171], a[124:127], v[96:111]
	s_waitcnt lgkmcnt(0)
	s_barrier
	buffer_load_dwordx4 v11, s[16:19], s58 offen offset:1024 lds
	v_mfma_f32_32x32x16_bf16 v[112:127], v[172:175], a[124:127], v[112:127]
	buffer_load_dwordx4 v12, s[16:19], s58 offen offset:2048 lds
L_p2A:
	v_add_u32 v247, 135168, v1
	ds_read_b128 v[208:211], v247 offset:0
	ds_read_b128 v[212:215], v247 offset:1024
	buffer_load_dwordx4 v13, s[16:19], s58 offen offset:3072 lds
	ds_read_b128 v[216:219], v247 offset:2048
	ds_read_b128 v[220:223], v247 offset:3072
	s_waitcnt lgkmcnt(2)
	v_add_f32 v208, v208, v212
	s_add_u32 m0, s52, 4096
	s_add_u32 s58, s71, 98304
	s_waitcnt lgkmcnt(0)
	v_add_f32 v216, v216, v220
	v_add_f32 v209, v209, v213
	v_add_f32 v217, v217, v221
	buffer_load_dwordx4 v10, s[16:19], s58 offen offset:0 lds
	v_add_f32 v232, v208, v216
	v_add_f32 v233, v209, v217
	v_cvt_pk_bf16_f32 v194, v232, v232
	v_cvt_pk_bf16_f32 v198, v233, v233
	v_lshlrev_b32 v194, 16, v194
	v_lshlrev_b32 v198, 16, v198
	buffer_load_dwordx4 v11, s[16:19], s58 offen offset:1024 lds
	v_sub_f32 v194, v232, v194
	v_sub_f32 v198, v233, v198
	v_cvt_pk_bf16_f32 v192, v232, v194
	v_cvt_pk_bf16_f32 v196, v233, v198
	v_and_b32 v195, 0xffff0000, v192
	v_and_b32 v199, 0xffff0000, v196
	buffer_load_dwordx4 v12, s[16:19], s58 offen offset:2048 lds
	v_sub_f32 v194, v194, v195
	v_sub_f32 v198, v198, v199
	v_cvt_pk_bf16_f32 v193, 0, v194
	v_cvt_pk_bf16_f32 v197, 0, v198
	v_mov_b32 v194, 0
	v_mov_b32 v198, 0
	buffer_load_dwordx4 v13, s[16:19], s58 offen offset:3072 lds
	v_mov_b32 v195, 0
	v_mov_b32 v199, 0
	s_nop 0
	v_mfma_f32_32x32x16_bf16 v[96:111], v[192:195], v[224:227], v[96:111]
	v_mfma_f32_32x32x16_bf16 v[112:127], v[196:199], v[224:227], v[112:127]
	s_nop 10
	v_pk_fma_f32 v[96:97], v[96:97], v[228:229], s[88:89] op_sel_hi:[1,0,1]
	v_pk_fma_f32 v[98:99], v[98:99], v[228:229], s[88:89] op_sel_hi:[1,0,1]
	v_pk_mul_f32 v[200:201], v[96:97], s[90:91]
	v_pk_mul_f32 v[202:203], v[98:99], s[90:91]
	v_exp_f32_e64 v200, v200 clamp
	v_max_f32_e64 v96, s88, v96
	v_exp_f32_e64 v201, v201 clamp
	v_max_f32_e64 v97, s88, v97
	v_exp_f32_e64 v202, v202 clamp
	v_max_f32_e64 v98, s88, v98
	v_exp_f32_e64 v203, v203 clamp
	v_max_f32_e64 v99, s88, v99
	v_pk_add_f32 v[96:97], v[96:97], v[200:201]
	v_pk_add_f32 v[98:99], v[98:99], v[202:203]
	v_cvt_pk_bf16_f32 v128, v96, v97
	v_cvt_pk_bf16_f32 v129, v98, v99
	v_pk_fma_f32 v[100:101], v[100:101], v[228:229], s[88:89] op_sel_hi:[1,0,1]
	v_pk_fma_f32 v[102:103], v[102:103], v[228:229], s[88:89] op_sel_hi:[1,0,1]
	v_pk_mul_f32 v[200:201], v[100:101], s[90:91]
	v_pk_mul_f32 v[202:203], v[102:103], s[90:91]
	v_exp_f32_e64 v200, v200 clamp
	v_max_f32_e64 v100, s88, v100
	v_exp_f32_e64 v201, v201 clamp
	v_max_f32_e64 v101, s88, v101
	v_exp_f32_e64 v202, v202 clamp
	v_max_f32_e64 v102, s88, v102
	v_exp_f32_e64 v203, v203 clamp
	v_max_f32_e64 v103, s88, v103
	v_pk_add_f32 v[100:101], v[100:101], v[200:201]
	v_pk_add_f32 v[102:103], v[102:103], v[202:203]
	v_cvt_pk_bf16_f32 v130, v100, v101
	v_cvt_pk_bf16_f32 v131, v102, v103
	v_pk_fma_f32 v[104:105], v[104:105], v[228:229], s[88:89] op_sel_hi:[1,0,1]
	v_pk_fma_f32 v[106:107], v[106:107], v[228:229], s[88:89] op_sel_hi:[1,0,1]
	v_pk_mul_f32 v[200:201], v[104:105], s[90:91]
	v_pk_mul_f32 v[202:203], v[106:107], s[90:91]
	v_exp_f32_e64 v200, v200 clamp
	v_max_f32_e64 v104, s88, v104
	v_exp_f32_e64 v201, v201 clamp
	v_max_f32_e64 v105, s88, v105
	v_exp_f32_e64 v202, v202 clamp
	v_max_f32_e64 v106, s88, v106
	v_exp_f32_e64 v203, v203 clamp
	v_max_f32_e64 v107, s88, v107
	v_pk_add_f32 v[104:105], v[104:105], v[200:201]
	v_pk_add_f32 v[106:107], v[106:107], v[202:203]
	v_cvt_pk_bf16_f32 v132, v104, v105
	v_cvt_pk_bf16_f32 v133, v106, v107
	v_pk_fma_f32 v[108:109], v[108:109], v[228:229], s[88:89] op_sel_hi:[1,0,1]
	v_pk_fma_f32 v[110:111], v[110:111], v[228:229], s[88:89] op_sel_hi:[1,0,1]
	v_pk_mul_f32 v[200:201], v[108:109], s[90:91]
	v_pk_mul_f32 v[202:203], v[110:111], s[90:91]
	v_exp_f32_e64 v200, v200 clamp
	v_max_f32_e64 v108, s88, v108
	v_exp_f32_e64 v201, v201 clamp
	v_max_f32_e64 v109, s88, v109
	v_exp_f32_e64 v202, v202 clamp
	v_max_f32_e64 v110, s88, v110
	v_exp_f32_e64 v203, v203 clamp
	v_max_f32_e64 v111, s88, v111
	v_pk_add_f32 v[108:109], v[108:109], v[200:201]
	v_pk_add_f32 v[110:111], v[110:111], v[202:203]
	v_cvt_pk_bf16_f32 v134, v108, v109
	v_cvt_pk_bf16_f32 v135, v110, v111
	s_waitcnt vmcnt(24)
	v_xor_b32 v240, s67, v240
	v_xor_b32 v241, s46, v241
	v_or_b32 v254, v240, v241
	s_waitcnt vmcnt(23)
	v_xor_b32 v32, s67, v32
	v_xor_b32_e64 v33, v253, v33
	v_or3_b32 v254, v254, v32, v33
	s_waitcnt vmcnt(22)
	v_xor_b32 v36, s67, v36
	v_xor_b32_e64 v37, v253, v37
	v_or3_b32 v254, v254, v36, v37
	s_waitcnt vmcnt(21)
	v_xor_b32 v40, s67, v40
	v_xor_b32_e64 v41, v253, v41
	v_or3_b32 v254, v254, v40, v41
	s_waitcnt vmcnt(20)
	v_xor_b32 v44, s67, v44
	v_xor_b32_e64 v45, v253, v45
	v_or3_b32 v254, v254, v44, v45
	s_waitcnt vmcnt(19)
	v_xor_b32 v48, s67, v48
	v_xor_b32_e64 v49, v253, v49
	v_or3_b32 v254, v254, v48, v49
	s_waitcnt vmcnt(18)
	v_xor_b32 v52, s67, v52
	v_xor_b32_e64 v53, v253, v53
	v_or3_b32 v254, v254, v52, v53
	s_waitcnt vmcnt(17)
	v_xor_b32 v56, s67, v56
	v_xor_b32_e64 v57, v253, v57
	v_or3_b32 v254, v254, v56, v57
	s_waitcnt vmcnt(16)
	v_xor_b32 v60, s67, v60
	v_xor_b32_e64 v61, v253, v61
	v_or3_b32 v254, v254, v60, v61
	s_waitcnt vmcnt(15)
	v_xor_b32 v64, s67, v64
	v_xor_b32_e64 v65, v253, v65
	v_or3_b32 v254, v254, v64, v65
	s_waitcnt vmcnt(14)
	v_xor_b32 v68, s67, v68
	v_xor_b32_e64 v69, v253, v69
	v_or3_b32 v254, v254, v68, v69
	s_waitcnt vmcnt(13)
	v_xor_b32 v72, s67, v72
	v_xor_b32_e64 v73, v253, v73
	v_or3_b32 v254, v254, v72, v73
	s_waitcnt vmcnt(12)
	v_xor_b32 v76, s67, v76
	v_xor_b32_e64 v77, v253, v77
	v_or3_b32 v254, v254, v76, v77
	s_waitcnt vmcnt(11)
	v_xor_b32 v80, s67, v80
	v_xor_b32_e64 v81, v253, v81
	v_or3_b32 v254, v254, v80, v81
	s_waitcnt vmcnt(10)
	v_xor_b32 v84, s67, v84
	v_xor_b32_e64 v85, v253, v85
	v_or3_b32 v254, v254, v84, v85
	s_waitcnt vmcnt(9)
	v_xor_b32 v88, s67, v88
	v_xor_b32_e64 v89, v253, v89
	v_or3_b32 v254, v254, v88, v89
	s_waitcnt vmcnt(8)
	v_xor_b32 v92, s67, v92
	v_xor_b32_e64 v93, v253, v93
	v_or3_b32 v254, v254, v92, v93
	v_and_b32 v254, 3, v254
	v_cmp_ne_u32 vcc, 0, v254
	s_nop 0
	s_cbranch_vccnz L_slow3
L_back3:
	v_pk_add_f32 v[32:33], v[32:33], v[36:37]
	v_pk_add_f32 v[34:35], v[34:35], v[38:39]
	v_pk_add_f32 v[40:41], v[40:41], v[44:45]
	v_pk_add_f32 v[42:43], v[42:43], v[46:47]
	v_pk_add_f32 v[48:49], v[48:49], v[52:53]
	v_pk_add_f32 v[50:51], v[50:51], v[54:55]
	v_pk_add_f32 v[56:57], v[56:57], v[60:61]
	v_pk_add_f32 v[58:59], v[58:59], v[62:63]
	v_pk_add_f32 v[64:65], v[64:65], v[68:69]
	v_pk_add_f32 v[66:67], v[66:67], v[70:71]
	v_pk_add_f32 v[72:73], v[72:73], v[76:77]
	v_pk_add_f32 v[74:75], v[74:75], v[78:79]
	v_pk_add_f32 v[80:81], v[80:81], v[84:85]
	v_pk_add_f32 v[82:83], v[82:83], v[86:87]
	v_pk_add_f32 v[88:89], v[88:89], v[92:93]
	v_pk_add_f32 v[90:91], v[90:91], v[94:95]
	v_pk_add_f32 v[32:33], v[32:33], v[40:41]
	v_pk_add_f32 v[34:35], v[34:35], v[42:43]
	v_pk_add_f32 v[48:49], v[48:49], v[56:57]
	v_pk_add_f32 v[50:51], v[50:51], v[58:59]
	v_pk_add_f32 v[64:65], v[64:65], v[72:73]
	v_pk_add_f32 v[66:67], v[66:67], v[74:75]
	v_pk_add_f32 v[80:81], v[80:81], v[88:89]
	v_pk_add_f32 v[82:83], v[82:83], v[90:91]
	v_pk_add_f32 v[32:33], v[32:33], v[48:49]
	v_pk_add_f32 v[34:35], v[34:35], v[50:51]
	v_pk_add_f32 v[64:65], v[64:65], v[80:81]
	v_pk_add_f32 v[66:67], v[66:67], v[82:83]
	v_pk_add_f32 v[32:33], v[32:33], v[64:65]
	v_pk_add_f32 v[34:35], v[34:35], v[66:67]
	v_cvt_pk_bf16_f32 v246, v32, v33
	v_cvt_pk_bf16_f32 v247, v34, v35
	s_add_u32 s100, s72, L_end-L_exit-4+0
	v_add_f32_dpp v240, v240, v240 row_ror:8 row_mask:0xf bank_mask:0xf
	v_add_f32_dpp v241, v241, v241 row_ror:8 row_mask:0xf bank_mask:0xf
	v_add_f32_dpp v242, v242, v242 row_ror:8 row_mask:0xf bank_mask:0xf
	buffer_load_dwordx4 v[32:35], v1, s[20:23], s100 offen offset:0 sc1
	v_add_f32_dpp v243, v243, v243 row_ror:8 row_mask:0xf bank_mask:0xf
	v_add_f32_dpp v240, v240, v240 row_ror:4 row_mask:0xf bank_mask:0xf
	v_add_f32_dpp v241, v241, v241 row_ror:4 row_mask:0xf bank_mask:0xf
	v_add_f32_dpp v242, v242, v242 row_ror:4 row_mask:0xf bank_mask:0xf
	v_add_f32_dpp v243, v243, v243 row_ror:4 row_mask:0xf bank_mask:0xf
	v_add_f32_dpp v240, v240, v240 row_ror:2 row_mask:0xf bank_mask:0xf
	buffer_load_dwordx4 v[36:39], v250, s[20:23], s100 offen offset:0 sc1
	v_add_f32_dpp v241, v241, v241 row_ror:2 row_mask:0xf bank_mask:0xf
	v_add_f32_dpp v242, v242, v242 row_ror:2 row_mask:0xf bank_mask:0xf
	v_add_f32_dpp v243, v243, v243 row_ror:2 row_mask:0xf bank_mask:0xf
	v_add_f32_dpp v240, v240, v240 row_ror:1 row_mask:0xf bank_mask:0xf
	v_add_f32_dpp v241, v241, v241 row_ror:1 row_mask:0xf bank_mask:0xf
	v_add_f32_dpp v242, v242, v242 row_ror:1 row_mask:0xf bank_mask:0xf
	buffer_load_dwordx4 v[40:43], v1, s[20:23], s100 offen offset:1024 sc1
	v_add_f32_dpp v243, v243, v243 row_ror:1 row_mask:0xf bank_mask:0xf
	v_and_b32_e64 v244, 15, v0
	v_bfe_u32 v245, v0, 4, 1
	v_lshl_add_u32 v244, v245, 5, v244
	v_lshlrev_b32 v244, 4, v244
	v_lshrrev_b32 v245, 5, v0
	buffer_load_dwordx4 v[44:47], v250, s[20:23], s100 offen offset:1024 sc1
	v_lshl_add_u32 v244, v245, 3, v244
	s_lshl_b32 s80, s40, L_end-L_exit-4+10
	s_add_u32 s80, s80, 131072
	v_add_u32_e64 v244, s80, v244
	v_cvt_pk_bf16_f32 v240, v240, v241
	v_cvt_pk_bf16_f32 v241, v242, v243
	buffer_load_dwordx4 v[48:51], v1, s[20:23], s100 offen offset:2048 sc1
	ds_write_b64 v244, v[240:241] offset:256
	ds_write_b64 v244, v[246:247]
	v_add_u32 v244, 131072, v1
	v_pk_fma_f32 v[112:113], v[112:113], v[228:229], s[88:89] op_sel_hi:[1,0,1]
	v_pk_fma_f32 v[114:115], v[114:115], v[228:229], s[88:89] op_sel_hi:[1,0,1]
	v_pk_mul_f32 v[200:201], v[112:113], s[90:91]
	buffer_load_dwordx4 v[52:55], v250, s[20:23], s100 offen offset:2048 sc1
	v_pk_mul_f32 v[202:203], v[114:115], s[90:91]
	v_exp_f32_e64 v200, v200 clamp
	v_max_f32_e64 v112, s88, v112
	v_exp_f32_e64 v201, v201 clamp
	v_max_f32_e64 v113, s88, v113
	v_exp_f32_e64 v202, v202 clamp
	buffer_load_dwordx4 v[56:59], v1, s[20:23], s100 offen offset:3072 sc1
	v_max_f32_e64 v114, s88, v114
	v_exp_f32_e64 v203, v203 clamp
	v_max_f32_e64 v115, s88, v115
	v_pk_add_f32 v[112:113], v[112:113], v[200:201]
	v_pk_add_f32 v[114:115], v[114:115], v[202:203]
	v_cvt_pk_bf16_f32 v136, v112, v113
	buffer_load_dwordx4 v[60:63], v250, s[20:23], s100 offen offset:3072 sc1
	v_cvt_pk_bf16_f32 v137, v114, v115
	v_pk_fma_f32 v[116:117], v[116:117], v[228:229], s[88:89] op_sel_hi:[1,0,1]
	v_pk_fma_f32 v[118:119], v[118:119], v[228:229], s[88:89] op_sel_hi:[1,0,1]
	s_add_u32 s100, s72, 4096
	v_pk_mul_f32 v[200:201], v[116:117], s[90:91]
	v_pk_mul_f32 v[202:203], v[118:119], s[90:91]
	v_exp_f32_e64 v200, v200 clamp
	buffer_load_dwordx4 v[64:67], v1, s[20:23], s100 offen offset:0 sc1
	v_max_f32_e64 v116, s88, v116
	v_exp_f32_e64 v201, v201 clamp
	v_max_f32_e64 v117, s88, v117
	v_exp_f32_e64 v202, v202 clamp
	v_max_f32_e64 v118, s88, v118
	v_exp_f32_e64 v203, v203 clamp
	buffer_load_dwordx4 v[68:71], v250, s[20:23], s100 offen offset:0 sc1
	v_max_f32_e64 v119, s88, v119
	v_pk_add_f32 v[116:117], v[116:117], v[200:201]
	v_pk_add_f32 v[118:119], v[118:119], v[202:203]
	v_cvt_pk_bf16_f32 v138, v116, v117
	v_cvt_pk_bf16_f32 v139, v118, v119
	v_pk_fma_f32 v[120:121], v[120:121], v[228:229], s[88:89] op_sel_hi:[1,0,1]
	buffer_load_dwordx4 v[72:75], v1, s[20:23], s100 offen offset:1024 sc1
	v_pk_fma_f32 v[122:123], v[122:123], v[228:229], s[88:89] op_sel_hi:[1,0,1]
	v_pk_mul_f32 v[200:201], v[120:121], s[90:91]
	v_pk_mul_f32 v[202:203], v[122:123], s[90:91]
	v_exp_f32_e64 v200, v200 clamp
	v_max_f32_e64 v120, s88, v120
	v_exp_f32_e64 v201, v201 clamp
	buffer_load_dwordx4 v[76:79], v250, s[20:23], s100 offen offset:1024 sc1
	v_max_f32_e64 v121, s88, v121
	v_exp_f32_e64 v202, v202 clamp
	v_max_f32_e64 v122, s88, v122
	v_exp_f32_e64 v203, v203 clamp
	v_max_f32_e64 v123, s88, v123
	v_pk_add_f32 v[120:121], v[120:121], v[200:201]
	buffer_load_dwordx4 v[80:83], v1, s[20:23], s100 offen offset:2048 sc1
	v_pk_add_f32 v[122:123], v[122:123], v[202:203]
	v_cvt_pk_bf16_f32 v140, v120, v121
	v_cvt_pk_bf16_f32 v141, v122, v123
	v_pk_fma_f32 v[124:125], v[124:125], v[228:229], s[88:89] op_sel_hi:[1,0,1]
	v_pk_fma_f32 v[126:127], v[126:127], v[228:229], s[88:89] op_sel_hi:[1,0,1]
	v_pk_mul_f32 v[200:201], v[124:125], s[90:91]
	buffer_load_dwordx4 v[84:87], v250, s[20:23], s100 offen offset:2048 sc1
	v_pk_mul_f32 v[202:203], v[126:127], s[90:91]
	v_exp_f32_e64 v200, v200 clamp
	v_max_f32_e64 v124, s88, v124
	v_exp_f32_e64 v201, v201 clamp
	v_max_f32_e64 v125, s88, v125
	v_exp_f32_e64 v202, v202 clamp
	v_max_f32_e64 v126, s88, v126
	v_exp_f32_e64 v203, v203 clamp
	v_max_f32_e64 v127, s88, v127
	v_pk_add_f32 v[124:125], v[124:125], v[200:201]
	v_pk_add_f32 v[126:127], v[126:127], v[202:203]
	v_cvt_pk_bf16_f32 v142, v124, v125
	v_cvt_pk_bf16_f32 v143, v126, v127
	s_waitcnt lgkmcnt(0)
	s_barrier
	ds_read_b128 v[144:147], v244 offset:0
	ds_read_b128 v[148:151], v244 offset:1024
	ds_read_b128 v[152:155], v244 offset:2048
	ds_read_b128 v[156:159], v244 offset:3072
	s_lshl_b32 s80, s42, 12
	s_add_u32 s80, s80, 114688
	s_add_u32 s80, s80, s62
	s_waitcnt lgkmcnt(3)
	v_mfma_f32_32x32x16_bf16 v[96:111], v[144:147], v[128:131], 0
	s_waitcnt lgkmcnt(2)
	v_mfma_f32_32x32x16_bf16 v[112:127], v[148:151], v[132:135], 0
	s_waitcnt lgkmcnt(1)
	v_mfma_f32_32x32x16_bf16 v[160:175], v[152:155], v[136:139], 0
	s_waitcnt lgkmcnt(0)
	v_mfma_f32_32x32x16_bf16 v[176:191], v[156:159], v[140:143], 0
	ds_read_b64_tr_b16 a[112:113], v248 offset:12288
	ds_read_b64_tr_b16 a[114:115], v248 offset:13312
	ds_read_b64_tr_b16 a[116:117], v249 offset:12288
	ds_read_b64_tr_b16 a[118:119], v249 offset:13312
	ds_read_b64_tr_b16 a[120:121], v248 offset:14336
	ds_read_b64_tr_b16 a[122:123], v248 offset:15360
	ds_read_b64_tr_b16 a[124:125], v249 offset:14336
	ds_read_b64_tr_b16 a[126:127], v249 offset:15360
	v_add_f32_e64 v104, s88, v104
	v_rcp_f32 v104, v104
	s_nop 0
	v_pk_mul_f32 v[96:97], v[96:97], v[104:105] op_sel_hi:[1,0]
	v_pk_mul_f32 v[98:99], v[98:99], v[104:105] op_sel_hi:[1,0]
	v_pk_mul_f32 v[100:101], v[100:101], v[104:105] op_sel_hi:[1,0]
	v_pk_mul_f32 v[102:103], v[102:103], v[104:105] op_sel_hi:[1,0]
	v_add_u32 v96, 0x10000, v96
	v_add_u32 v97, 0x10000, v97
	v_add_u32 v98, 0x10000, v98
	v_add_u32 v99, 0x10000, v99
	v_and_b32 v96, 0xfffe0000, v96
	v_and_b32 v97, 0xfffe0000, v97
	v_and_b32 v98, 0xfffe0000, v98
	v_and_b32 v99, 0xfffe0000, v99
	v_cvt_pk_bf16_f32 v224, v96, v97
	v_cvt_pk_bf16_f32 v225, v98, v99
	v_cvt_pk_bf16_f32 v226, v100, v101
	v_cvt_pk_bf16_f32 v227, v102, v103
	v_bfi_b32 v224, s63, v251, v224
	v_bfi_b32 v225, s63, v252, v225
	buffer_store_dwordx4 v[224:227], v1, s[20:23], s80 offen offset:0 sc1
	v_add_f32_e64 v120, s88, v120
	v_rcp_f32 v120, v120
	s_nop 0
	v_pk_mul_f32 v[112:113], v[112:113], v[120:121] op_sel_hi:[1,0]
	v_pk_mul_f32 v[114:115], v[114:115], v[120:121] op_sel_hi:[1,0]
	v_pk_mul_f32 v[116:117], v[116:117], v[120:121] op_sel_hi:[1,0]
	v_pk_mul_f32 v[118:119], v[118:119], v[120:121] op_sel_hi:[1,0]
	v_add_u32 v112, 0x10000, v112
	v_add_u32 v113, 0x10000, v113
	v_add_u32 v114, 0x10000, v114
	v_add_u32 v115, 0x10000, v115
	v_and_b32 v112, 0xfffe0000, v112
	v_and_b32 v113, 0xfffe0000, v113
	v_and_b32 v114, 0xfffe0000, v114
	v_and_b32 v115, 0xfffe0000, v115
	v_cvt_pk_bf16_f32 v228, v112, v113
	v_cvt_pk_bf16_f32 v229, v114, v115
	v_cvt_pk_bf16_f32 v230, v116, v117
	v_cvt_pk_bf16_f32 v231, v118, v119
	v_bfi_b32 v228, s63, v251, v228
	v_bfi_b32 v229, s63, v252, v229
	buffer_store_dwordx4 v[228:231], v1, s[20:23], s80 offen offset:1024 sc1
	v_add_f32_e64 v168, s88, v168
	v_rcp_f32 v168, v168
	s_nop 0
	v_pk_mul_f32 v[160:161], v[160:161], v[168:169] op_sel_hi:[1,0]
	v_pk_mul_f32 v[162:163], v[162:163], v[168:169] op_sel_hi:[1,0]
	v_pk_mul_f32 v[164:165], v[164:165], v[168:169] op_sel_hi:[1,0]
	v_pk_mul_f32 v[166:167], v[166:167], v[168:169] op_sel_hi:[1,0]
	v_add_u32 v160, 0x10000, v160
	v_add_u32 v161, 0x10000, v161
	v_add_u32 v162, 0x10000, v162
	v_add_u32 v163, 0x10000, v163
	v_and_b32 v160, 0xfffe0000, v160
	v_and_b32 v161, 0xfffe0000, v161
	v_and_b32 v162, 0xfffe0000, v162
	v_and_b32 v163, 0xfffe0000, v163
	v_cvt_pk_bf16_f32 v232, v160, v161
	v_cvt_pk_bf16_f32 v233, v162, v163
	v_cvt_pk_bf16_f32 v234, v164, v165
	v_cvt_pk_bf16_f32 v235, v166, v167
	v_bfi_b32 v232, s63, v251, v232
	v_bfi_b32 v233, s63, v252, v233
	buffer_store_dwordx4 v[232:235], v1, s[20:23], s80 offen offset:2048 sc1
	v_add_f32_e64 v184, s88, v184
	v_rcp_f32 v184, v184
	s_nop 0
	v_pk_mul_f32 v[176:177], v[176:177], v[184:185] op_sel_hi:[1,0]
	v_pk_mul_f32 v[178:179], v[178:179], v[184:185] op_sel_hi:[1,0]
	v_pk_mul_f32 v[180:181], v[180:181], v[184:185] op_sel_hi:[1,0]
	v_pk_mul_f32 v[182:183], v[182:183], v[184:185] op_sel_hi:[1,0]
	v_add_u32 v176, 0x10000, v176
	v_add_u32 v177, 0x10000, v177
	v_add_u32 v178, 0x10000, v178
	v_add_u32 v179, 0x10000, v179
	v_and_b32 v176, 0xfffe0000, v176
	v_and_b32 v177, 0xfffe0000, v177
	v_and_b32 v178, 0xfffe0000, v178
	v_and_b32 v179, 0xfffe0000, v179
	v_cvt_pk_bf16_f32 v236, v176, v177
	v_cvt_pk_bf16_f32 v237, v178, v179
	v_cvt_pk_bf16_f32 v238, v180, v181
	v_cvt_pk_bf16_f32 v239, v182, v183
	v_bfi_b32 v236, s63, v251, v236
	v_bfi_b32 v237, s63, v252, v237
	buffer_store_dwordx4 v[236:239], v1, s[20:23], s80 offen offset:3072 sc1
	s_waitcnt vmcnt(17)
	v_bitop3_b32 v32, v32, v251, s66 bitop3:0x78
	s_waitcnt vmcnt(16)
	v_bitop3_b32 v36, v36, v251, s66 bitop3:0x78
	v_bitop3_b32 v33, v33, v252, s66 bitop3:0x78
	v_bitop3_b32 v37, v37, v252, s66 bitop3:0x78
	v_or3_b32 v254, v32, v36, v33
	v_bitop3_b32 v254, v254, v37, s66 bitop3:0xa8
	v_cmp_ne_u32_e64 vcc, 0, v254
	s_nop 0
	s_cbranch_vccnz L_slow4
L_back4:
	v_mfma_f32_32x32x16_bf16 v[160:175], a[128:131], v[32:35], 0
	v_mfma_f32_32x32x16_bf16 v[176:191], a[132:135], v[32:35], 0
	s_waitcnt vmcnt(15)
	v_bitop3_b32 v40, v40, v251, s66 bitop3:0x78
	s_waitcnt vmcnt(14)
	v_bitop3_b32 v44, v44, v251, s66 bitop3:0x78
	v_bitop3_b32 v41, v41, v252, s66 bitop3:0x78
	v_mfma_f32_32x32x16_bf16 v[192:207], a[128:131], v[36:39], 0
	v_bitop3_b32 v45, v45, v252, s66 bitop3:0x78
	v_or3_b32 v254, v40, v44, v41
	v_bitop3_b32 v254, v254, v45, s66 bitop3:0xa8
	v_cmp_ne_u32 vcc, 0, v254
	v_mfma_f32_32x32x16_bf16 v[208:223], a[132:135], v[36:39], 0
	s_cbranch_vccnz L_slow5
L_back5:
	v_mfma_f32_32x32x16_bf16 v[160:175], a[136:139], v[40:43], v[160:175]
	v_and_b32_e64 v8, 31, v0
	buffer_load_dwordx4 v[88:91], v1, s[20:23], s100 offen offset:3072 sc1
	v_lshrrev_b32 v9, 5, v0
	v_and_b32 v14, 7, v0
	v_mfma_f32_32x32x16_bf16 v[176:191], a[140:143], v[40:43], v[176:191]
	v_xor_b32_e64 v9, v9, v14
	buffer_load_dwordx4 v[92:95], v250, s[20:23], s100 offen offset:3072 sc1
	v_lshlrev_b32_e64 v9, 4, v9
	v_lshl_add_u32 v9, v8, 8, v9
	s_waitcnt vmcnt(15)
	v_bitop3_b32 v48, v48, v251, s66 bitop3:0x78
	s_waitcnt vmcnt(14)
	v_bitop3_b32 v52, v52, v251, s66 bitop3:0x78
	v_bitop3_b32 v49, v49, v252, s66 bitop3:0x78
	v_mfma_f32_32x32x16_bf16 v[192:207], a[136:139], v[44:47], v[192:207]
	s_lshl_b32 s80, s40, 14
	v_add_u32 v2, s80, v9
	v_xor_b32_e64 v3, 32, v2
	v_bitop3_b32 v53, v53, v252, s66 bitop3:0x78
	v_or3_b32 v254, v48, v52, v49
	v_bitop3_b32 v254, v254, v53, s66 bitop3:0xa8
	v_cmp_ne_u32_e64 vcc, 0, v254
	v_mfma_f32_32x32x16_bf16 v[208:223], a[140:143], v[44:47], v[208:223]
	s_cbranch_vccnz L_slow6
L_back6:
	v_xor_b32 v4, 64, v2
	v_xor_b32 v5, 96, v2
	v_lshrrev_b32_e64 v8, 3, v0
	v_mfma_f32_32x32x16_bf16 v[160:175], a[144:147], v[48:51], v[160:175]
	s_add_u32 s100, s72, 16384
	v_lshlrev_b32_e64 v9, 1, v14
	buffer_load_dwordx4 v[32:35], v1, s[20:23], s100 offen offset:0 sc1
	v_xor_b32 v9, v9, v8
	v_lshlrev_b32 v9, 4, v9
	v_mfma_f32_32x32x16_bf16 v[176:191], a[148:151], v[48:51], v[176:191]
	v_lshl_add_u32 v9, v8, 8, v9
	buffer_load_dwordx4 v[36:39], v250, s[20:23], s100 offen offset:0 sc1
	s_lshl_b32 s80, s40, 11
	v_add_u32 v6, s80, v9
	s_waitcnt vmcnt(15)
	v_bitop3_b32 v56, v56, v251, s66 bitop3:0x78
	s_waitcnt vmcnt(14)
	v_bitop3_b32 v60, v60, v251, s66 bitop3:0x78
	v_bitop3_b32 v57, v57, v252, s66 bitop3:0x78
	v_mfma_f32_32x32x16_bf16 v[192:207], a[144:147], v[52:55], v[192:207]
	v_xor_b32_e64 v7, 16, v6
	v_add_u32 v28, 65536, v6
	v_add_u32 v29, 65536, v7
	v_bitop3_b32 v61, v61, v252, s66 bitop3:0x78
	v_or3_b32 v254, v56, v60, v57
	v_bitop3_b32 v254, v254, v61, s66 bitop3:0xa8
	v_cmp_ne_u32 vcc, 0, v254
	v_mfma_f32_32x32x16_bf16 v[208:223], a[148:151], v[52:55], v[208:223]
	s_cbranch_vccnz L_slow7
L_back7:
	v_add_u32 v30, 65536, v2
	v_lshlrev_b32_e64 v9, 4, v14
	v_lshl_add_u32 v15, v8, 10, v9
	v_mfma_f32_32x32x16_bf16 v[160:175], a[152:155], v[56:59], v[160:175]
	buffer_load_dwordx4 v[40:43], v1, s[20:23], s100 offen offset:1024 sc1
	v_lshlrev_b32 v14, 4, v8
	v_mfma_f32_32x32x16_bf16 v[176:191], a[156:159], v[56:59], v[176:191]
	s_lshl3_add_u32 s80, s44, s40
	buffer_load_dwordx4 v[44:47], v250, s[20:23], s100 offen offset:1024 sc1
	s_lshl_b32 s81, s80, 13
	s_waitcnt vmcnt(15)
	v_bitop3_b32 v64, v64, v251, s66 bitop3:0x78
	s_waitcnt vmcnt(14)
	v_bitop3_b32 v68, v68, v251, s66 bitop3:0x78
	v_bitop3_b32 v65, v65, v252, s66 bitop3:0x78
	v_mfma_f32_32x32x16_bf16 v[192:207], a[152:155], v[60:63], v[192:207]
	s_add_u32 s54, s81, s68
	s_add_u32 s53, s54, 32768
	v_bitop3_b32 v69, v69, v252, s66 bitop3:0x78
	v_or3_b32 v254, v64, v68, v65
	v_bitop3_b32 v254, v254, v69, s66 bitop3:0xa8
	v_cmp_ne_u32_e64 vcc, 0, v254
	v_mfma_f32_32x32x16_bf16 v[208:223], a[156:159], v[60:63], v[208:223]
	s_cbranch_vccnz L_slow8
L_back8:
	s_lshl_b32 s80, s80, 7
	s_add_u32 s47, s80, 10027008
	v_mfma_f32_32x32x16_bf16 v[160:175], a[160:163], v[64:67], v[160:175]
	buffer_load_dwordx4 v[48:51], v1, s[20:23], s100 offen offset:2048 sc1
	ds_read_b64_tr_b16 a[128:129], v248 offset:0
	v_mfma_f32_32x32x16_bf16 v[176:191], a[164:167], v[64:67], v[176:191]
	ds_read_b64_tr_b16 a[130:131], v248 offset:1024
	buffer_load_dwordx4 v[52:55], v250, s[20:23], s100 offen offset:2048 sc1
	ds_read_b64_tr_b16 a[132:133], v249 offset:0
	ds_read_b64_tr_b16 a[134:135], v249 offset:1024
	s_waitcnt vmcnt(15)
	v_bitop3_b32 v72, v72, v251, s66 bitop3:0x78
	s_waitcnt vmcnt(14)
	v_bitop3_b32 v76, v76, v251, s66 bitop3:0x78
	v_bitop3_b32 v73, v73, v252, s66 bitop3:0x78
	v_mfma_f32_32x32x16_bf16 v[192:207], a[160:163], v[68:71], v[192:207]
	ds_read_b64_tr_b16 a[136:137], v248 offset:2048
	ds_read_b64_tr_b16 a[138:139], v248 offset:3072
	v_bitop3_b32 v77, v77, v252, s66 bitop3:0x78
	v_or3_b32 v254, v72, v76, v73
	v_bitop3_b32 v254, v254, v77, s66 bitop3:0xa8
	v_cmp_ne_u32 vcc, 0, v254
	v_mfma_f32_32x32x16_bf16 v[208:223], a[164:167], v[68:71], v[208:223]
	s_cbranch_vccnz L_slow9
L_back9:
	ds_read_b64_tr_b16 a[140:141], v249 offset:2048
	ds_read_b64_tr_b16 a[142:143], v249 offset:3072
	v_mfma_f32_32x32x16_bf16 v[160:175], a[168:171], v[72:75], v[160:175]
	buffer_load_dwordx4 v[56:59], v1, s[20:23], s100 offen offset:3072 sc1
	v_mfma_f32_32x32x16_bf16 v[176:191], a[172:175], v[72:75], v[176:191]
	buffer_load_dwordx4 v[60:63], v250, s[20:23], s100 offen offset:3072 sc1
	s_waitcnt vmcnt(15)
	v_bitop3_b32 v80, v80, v251, s66 bitop3:0x78
	s_waitcnt vmcnt(14)
	v_bitop3_b32 v84, v84, v251, s66 bitop3:0x78
	v_bitop3_b32 v81, v81, v252, s66 bitop3:0x78
	v_mfma_f32_32x32x16_bf16 v[192:207], a[168:171], v[76:79], v[192:207]
	buffer_load_dwordx4 v[16:19], v15, s[4:7], s54 offen
	v_bitop3_b32 v85, v85, v252, s66 bitop3:0x78
	v_or3_b32 v254, v80, v84, v81
	v_bitop3_b32 v254, v254, v85, s66 bitop3:0xa8
	v_cmp_ne_u32 vcc, 0, v254
	v_mfma_f32_32x32x16_bf16 v[208:223], a[172:175], v[76:79], v[208:223]
	s_cbranch_vccnz L_slow10
L_back10:
	v_mfma_f32_32x32x16_bf16 v[160:175], a[176:179], v[80:83], v[160:175]
	s_add_u32 s100, s72, 20480
	buffer_load_dwordx4 v[64:67], v1, s[20:23], s100 offen offset:0 sc1
	ds_read_b64_tr_b16 a[144:145], v248 offset:4096
	v_mfma_f32_32x32x16_bf16 v[176:191], a[180:183], v[80:83], v[176:191]
	ds_read_b64_tr_b16 a[146:147], v248 offset:5120
	buffer_load_dwordx4 v[68:71], v250, s[20:23], s100 offen offset:0 sc1
	ds_read_b64_tr_b16 a[148:149], v249 offset:4096
	ds_read_b64_tr_b16 a[150:151], v249 offset:5120
	s_waitcnt vmcnt(12)
	v_bitop3_b32 v88, v88, v251, s66 bitop3:0x78
	s_waitcnt vmcnt(11)
	v_bitop3_b32 v92, v92, v251, s66 bitop3:0x78
	v_bitop3_b32 v89, v89, v252, s66 bitop3:0x78
	v_mfma_f32_32x32x16_bf16 v[192:207], a[176:179], v[84:87], v[192:207]
	ds_read_b64_tr_b16 a[152:153], v248 offset:6144
	buffer_load_dwordx4 v[20:23], v15, s[4:7], s53 offen
	ds_read_b64_tr_b16 a[154:155], v248 offset:7168
	v_bitop3_b32 v93, v93, v252, s66 bitop3:0x78
	v_or3_b32 v254, v88, v92, v89
	v_bitop3_b32 v254, v254, v93, s66 bitop3:0xa8
	v_cmp_ne_u32 vcc, 0, v254
	v_mfma_f32_32x32x16_bf16 v[208:223], a[180:183], v[84:87], v[208:223]
	s_cbranch_vccnz L_slow11
L_back11:
	ds_read_b64_tr_b16 a[156:157], v249 offset:6144
	ds_read_b64_tr_b16 a[158:159], v249 offset:7168
	v_mfma_f32_32x32x16_bf16 v[160:175], a[184:187], v[88:91], v[160:175]
	buffer_load_dwordx4 v[72:75], v1, s[20:23], s100 offen offset:1024 sc1
	v_mfma_f32_32x32x16_bf16 v[176:191], a[188:191], v[88:91], v[176:191]
	buffer_load_dwordx4 v[76:79], v250, s[20:23], s100 offen offset:1024 sc1
	s_waitcnt vmcnt(13)
	v_bitop3_b32 v32, v32, v251, s66 bitop3:0x78
	s_waitcnt vmcnt(12)
	v_bitop3_b32 v36, v36, v251, s66 bitop3:0x78
	v_bitop3_b32 v33, v33, v252, s66 bitop3:0x78
	v_mfma_f32_32x32x16_bf16 v[192:207], a[184:187], v[92:95], v[192:207]
	buffer_load_dwordx4 v[24:27], v9, s[32:35], s68 offen
	v_bitop3_b32 v37, v37, v252, s66 bitop3:0x78
	v_or3_b32 v254, v32, v36, v33
	v_bitop3_b32 v254, v254, v37, s66 bitop3:0xa8
	v_cmp_ne_u32 vcc, 0, v254
	v_mfma_f32_32x32x16_bf16 v[208:223], a[188:191], v[92:95], v[208:223]
	s_cbranch_vccnz L_slow12
L_back12:
	v_mfma_f32_32x32x16_bf16 v[160:175], a[192:195], v[32:35], v[160:175]
	buffer_load_dwordx4 v[80:83], v1, s[20:23], s100 offen offset:2048 sc1
	v_mfma_f32_32x32x16_bf16 v[176:191], a[196:199], v[32:35], v[176:191]
	buffer_load_dwordx4 v[84:87], v250, s[20:23], s100 offen offset:2048 sc1
	s_waitcnt vmcnt(14)
	v_bitop3_b32 v40, v40, v251, s66 bitop3:0x78
	s_waitcnt vmcnt(13)
	v_bitop3_b32 v44, v44, v251, s66 bitop3:0x78
	v_bitop3_b32 v41, v41, v252, s66 bitop3:0x78
	v_mfma_f32_32x32x16_bf16 v[192:207], a[192:195], v[36:39], v[192:207]
	buffer_load_dwordx4 v[240:243], v14, s[20:23], s47 offen sc1
	v_bitop3_b32 v45, v45, v252, s66 bitop3:0x78
	v_or3_b32 v254, v40, v44, v41
	v_bitop3_b32 v254, v254, v45, s66 bitop3:0xa8
	v_cmp_ne_u32 vcc, 0, v254
	v_mfma_f32_32x32x16_bf16 v[208:223], a[196:199], v[36:39], v[208:223]
	s_cbranch_vccnz L_slow13
L_back13:
	v_mfma_f32_32x32x16_bf16 v[160:175], a[200:203], v[40:43], v[160:175]
	buffer_load_dwordx4 v[88:91], v1, s[20:23], s100 offen offset:3072 sc1
	v_mfma_f32_32x32x16_bf16 v[176:191], a[204:207], v[40:43], v[176:191]
	buffer_load_dwordx4 v[92:95], v250, s[20:23], s100 offen offset:3072 sc1
	s_waitcnt vmcnt(15)
	v_bitop3_b32 v48, v48, v251, s66 bitop3:0x78
	s_waitcnt vmcnt(14)
	v_bitop3_b32 v52, v52, v251, s66 bitop3:0x78
	v_bitop3_b32 v49, v49, v252, s66 bitop3:0x78
	v_mfma_f32_32x32x16_bf16 v[192:207], a[200:203], v[44:47], v[192:207]
	buffer_load_dwordx4 v[244:247], v14, s[20:23], s47 offen offset:512 sc1
	v_bitop3_b32 v53, v53, v252, s66 bitop3:0x78
	v_or3_b32 v254, v48, v52, v49
	v_bitop3_b32 v254, v254, v53, s66 bitop3:0xa8
	v_cmp_ne_u32 vcc, 0, v254
	v_mfma_f32_32x32x16_bf16 v[208:223], a[204:207], v[44:47], v[208:223]
	s_cbranch_vccnz L_slow14
L_back14:
	v_mfma_f32_32x32x16_bf16 v[160:175], a[208:211], v[48:51], v[160:175]
	s_add_u32 s100, s72, 8192
	buffer_load_dwordx4 v[32:35], v1, s[20:23], s100 offen offset:0 sc1
	v_mfma_f32_32x32x16_bf16 v[176:191], a[212:215], v[48:51], v[176:191]
	buffer_load_dwordx4 v[36:39], v1, s[20:23], s100 offen offset:1024 sc1
	s_waitcnt vmcnt(16)
	v_bitop3_b32 v56, v56, v251, s66 bitop3:0x78
	s_waitcnt vmcnt(15)
	v_bitop3_b32 v60, v60, v251, s66 bitop3:0x78
	v_bitop3_b32 v57, v57, v252, s66 bitop3:0x78
	v_mfma_f32_32x32x16_bf16 v[192:207], a[208:211], v[52:55], v[192:207]
	v_bitop3_b32 v61, v61, v252, s66 bitop3:0x78
	v_or3_b32 v254, v56, v60, v57
	v_bitop3_b32 v254, v254, v61, s66 bitop3:0xa8
	v_cmp_ne_u32 vcc, 0, v254
	v_mfma_f32_32x32x16_bf16 v[208:223], a[212:215], v[52:55], v[208:223]
	s_cbranch_vccnz L_slow15
L_back15:
	v_mfma_f32_32x32x16_bf16 v[160:175], a[216:219], v[56:59], v[160:175]
	buffer_load_dwordx4 v[40:43], v1, s[20:23], s100 offen offset:2048 sc1
	v_mfma_f32_32x32x16_bf16 v[176:191], a[220:223], v[56:59], v[176:191]
	buffer_load_dwordx4 v[44:47], v1, s[20:23], s100 offen offset:3072 sc1
	s_waitcnt vmcnt(15)
	v_bitop3_b32 v64, v64, v251, s66 bitop3:0x78
	s_waitcnt vmcnt(14)
	v_bitop3_b32 v68, v68, v251, s66 bitop3:0x78
	v_bitop3_b32 v65, v65, v252, s66 bitop3:0x78
	v_mfma_f32_32x32x16_bf16 v[192:207], a[216:219], v[60:63], v[192:207]
	v_bitop3_b32 v69, v69, v252, s66 bitop3:0x78
	v_or3_b32 v254, v64, v68, v65
	v_bitop3_b32 v254, v254, v69, s66 bitop3:0xa8
	v_cmp_ne_u32 vcc, 0, v254
	v_mfma_f32_32x32x16_bf16 v[208:223], a[220:223], v[60:63], v[208:223]
	s_cbranch_vccnz L_slow16
L_back16:
	v_mfma_f32_32x32x16_bf16 v[160:175], a[224:227], v[64:67], v[160:175]
	s_add_u32 s100, s72, 24576
	buffer_load_dwordx4 v[48:51], v1, s[20:23], s100 offen offset:0 sc1
	v_mfma_f32_32x32x16_bf16 v[176:191], a[228:231], v[64:67], v[176:191]
	buffer_load_dwordx4 v[52:55], v1, s[20:23], s100 offen offset:1024 sc1
	s_waitcnt vmcnt(14)
	v_bitop3_b32 v72, v72, v251, s66 bitop3:0x78
	s_waitcnt vmcnt(13)
	v_bitop3_b32 v76, v76, v251, s66 bitop3:0x78
	v_bitop3_b32 v73, v73, v252, s66 bitop3:0x78
	v_mfma_f32_32x32x16_bf16 v[192:207], a[224:227], v[68:71], v[192:207]
	v_bitop3_b32 v77, v77, v252, s66 bitop3:0x78
	v_or3_b32 v254, v72, v76, v73
	v_bitop3_b32 v254, v254, v77, s66 bitop3:0xa8
	v_cmp_ne_u32 vcc, 0, v254
	v_mfma_f32_32x32x16_bf16 v[208:223], a[228:231], v[68:71], v[208:223]
	s_cbranch_vccnz L_slow17
L_back17:
	v_mfma_f32_32x32x16_bf16 v[160:175], a[232:235], v[72:75], v[160:175]
	buffer_load_dwordx4 v[56:59], v1, s[20:23], s100 offen offset:2048 sc1
	v_mfma_f32_32x32x16_bf16 v[176:191], a[236:239], v[72:75], v[176:191]
	buffer_load_dwordx4 v[60:63], v1, s[20:23], s100 offen offset:3072 sc1
	s_waitcnt vmcnt(13)
	v_bitop3_b32 v80, v80, v251, s66 bitop3:0x78
	s_waitcnt vmcnt(12)
	v_bitop3_b32 v84, v84, v251, s66 bitop3:0x78
	v_bitop3_b32 v81, v81, v252, s66 bitop3:0x78
	v_mfma_f32_32x32x16_bf16 v[192:207], a[232:235], v[76:79], v[192:207]
	v_bitop3_b32 v85, v85, v252, s66 bitop3:0x78
	v_or3_b32 v254, v80, v84, v81
	v_bitop3_b32 v254, v254, v85, s66 bitop3:0xa8
	v_cmp_ne_u32 vcc, 0, v254
	v_mfma_f32_32x32x16_bf16 v[208:223], a[236:239], v[76:79], v[208:223]
	s_cbranch_vccnz L_slow18
L_back18:
	v_mfma_f32_32x32x16_bf16 v[160:175], a[240:243], v[80:83], v[160:175]
	s_add_u32 s100, s72, 12288
	buffer_load_dwordx4 v[64:67], v1, s[20:23], s100 offen offset:0 sc1
	v_mfma_f32_32x32x16_bf16 v[176:191], a[244:247], v[80:83], v[176:191]
	buffer_load_dwordx4 v[68:71], v1, s[20:23], s100 offen offset:1024 sc1
	s_waitcnt vmcnt(12)
	v_bitop3_b32 v88, v88, v251, s66 bitop3:0x78
	s_waitcnt vmcnt(11)
	v_bitop3_b32 v92, v92, v251, s66 bitop3:0x78
	v_bitop3_b32 v89, v89, v252, s66 bitop3:0x78
	v_mfma_f32_32x32x16_bf16 v[192:207], a[240:243], v[84:87], v[192:207]
	v_bitop3_b32 v93, v93, v252, s66 bitop3:0x78
	v_or3_b32 v254, v88, v92, v89
	v_bitop3_b32 v254, v254, v93, s66 bitop3:0xa8
	v_cmp_ne_u32 vcc, 0, v254
	v_mfma_f32_32x32x16_bf16 v[208:223], a[244:247], v[84:87], v[208:223]
	s_cbranch_vccnz L_slow19
L_back19:
	v_mfma_f32_32x32x16_bf16 v[160:175], a[248:251], v[88:91], v[160:175]
	buffer_load_dwordx4 v[72:75], v1, s[20:23], s100 offen offset:2048 sc1
	v_mfma_f32_32x32x16_bf16 v[176:191], a[252:255], v[88:91], v[176:191]
	buffer_load_dwordx4 v[76:79], v1, s[20:23], s100 offen offset:3072 sc1
	s_waitcnt vmcnt(11)
	v_bitop3_b32 v32, v32, v251, s66 bitop3:0x78
	s_waitcnt vmcnt(10)
	v_bitop3_b32 v36, v36, v251, s66 bitop3:0x78
	v_bitop3_b32 v33, v33, v252, s66 bitop3:0x78
	v_mfma_f32_32x32x16_bf16 v[192:207], a[248:251], v[92:95], v[192:207]
	v_bitop3_b32 v37, v37, v252, s66 bitop3:0x78
	v_or3_b32 v254, v32, v36, v33
	v_bitop3_b32 v254, v254, v37, s66 bitop3:0xa8
	v_cmp_ne_u32 vcc, 0, v254
	v_mfma_f32_32x32x16_bf16 v[208:223], a[252:255], v[92:95], v[208:223]
	s_cbranch_vccnz L_slow20
L_back20:
	v_mfma_f32_32x32x16_bf16 v[160:175], a[0:3], v[32:35], v[160:175]
	s_add_u32 s100, s72, 8192
	buffer_load_dwordx4 v[80:83], v250, s[20:23], s100 offen offset:0 sc1
	v_mfma_f32_32x32x16_bf16 v[176:191], a[4:7], v[32:35], v[176:191]
	buffer_load_dwordx4 v[84:87], v250, s[20:23], s100 offen offset:1024 sc1
	s_waitcnt vmcnt(11)
	v_bitop3_b32 v40, v40, v251, s66 bitop3:0x78
	s_waitcnt vmcnt(10)
	v_bitop3_b32 v44, v44, v251, s66 bitop3:0x78
	v_bitop3_b32 v41, v41, v252, s66 bitop3:0x78
	v_mfma_f32_32x32x16_bf16 v[160:175], a[8:11], v[36:39], v[160:175]
	v_bitop3_b32 v45, v45, v252, s66 bitop3:0x78
	v_or3_b32 v254, v40, v44, v41
	v_bitop3_b32 v254, v254, v45, s66 bitop3:0xa8
	v_cmp_ne_u32 vcc, 0, v254
	v_mfma_f32_32x32x16_bf16 v[176:191], a[12:15], v[36:39], v[176:191]
	s_cbranch_vccnz L_slow21
L_back21:
	v_mfma_f32_32x32x16_bf16 v[160:175], a[16:19], v[40:43], v[160:175]
	buffer_load_dwordx4 v[88:91], v250, s[20:23], s100 offen offset:2048 sc1
	v_mfma_f32_32x32x16_bf16 v[176:191], a[20:23], v[40:43], v[176:191]
	buffer_load_dwordx4 v[92:95], v250, s[20:23], s100 offen offset:3072 sc1
	s_waitcnt vmcnt(11)
	v_bitop3_b32 v48, v48, v251, s66 bitop3:0x78
	s_waitcnt vmcnt(10)
	v_bitop3_b32 v52, v52, v251, s66 bitop3:0x78
	v_bitop3_b32 v49, v49, v252, s66 bitop3:0x78
	v_mfma_f32_32x32x16_bf16 v[160:175], a[24:27], v[44:47], v[160:175]
	v_bitop3_b32 v53, v53, v252, s66 bitop3:0x78
	v_or3_b32 v254, v48, v52, v49
	v_bitop3_b32 v254, v254, v53, s66 bitop3:0xa8
	v_cmp_ne_u32 vcc, 0, v254
	v_mfma_f32_32x32x16_bf16 v[176:191], a[28:31], v[44:47], v[176:191]
	s_cbranch_vccnz L_slow22
L_back22:
	v_mfma_f32_32x32x16_bf16 v[160:175], a[32:35], v[48:51], v[160:175]
	s_add_u32 s100, s72, 24576
	buffer_load_dwordx4 v[32:35], v250, s[20:23], s100 offen offset:0 sc1
	v_mfma_f32_32x32x16_bf16 v[176:191], a[36:39], v[48:51], v[176:191]
	buffer_load_dwordx4 v[36:39], v250, s[20:23], s100 offen offset:1024 sc1
	s_waitcnt vmcnt(11)
	v_bitop3_b32 v56, v56, v251, s66 bitop3:0x78
	s_waitcnt vmcnt(10)
	v_bitop3_b32 v60, v60, v251, s66 bitop3:0x78
	v_bitop3_b32 v57, v57, v252, s66 bitop3:0x78
	v_mfma_f32_32x32x16_bf16 v[160:175], a[40:43], v[52:55], v[160:175]
	v_bitop3_b32 v61, v61, v252, s66 bitop3:0x78
	v_or3_b32 v254, v56, v60, v57
	v_bitop3_b32 v254, v254, v61, s66 bitop3:0xa8
	v_cmp_ne_u32 vcc, 0, v254
	v_mfma_f32_32x32x16_bf16 v[176:191], a[44:47], v[52:55], v[176:191]
	s_cbranch_vccnz L_slow23
L_back23:
	v_mfma_f32_32x32x16_bf16 v[160:175], a[48:51], v[56:59], v[160:175]
	buffer_load_dwordx4 v[40:43], v250, s[20:23], s100 offen offset:2048 sc1
	v_mfma_f32_32x32x16_bf16 v[176:191], a[52:55], v[56:59], v[176:191]
	buffer_load_dwordx4 v[44:47], v250, s[20:23], s100 offen offset:3072 sc1
	s_waitcnt vmcnt(11)
	v_bitop3_b32 v64, v64, v251, s66 bitop3:0x78
	s_waitcnt vmcnt(10)
	v_bitop3_b32 v68, v68, v251, s66 bitop3:0x78
	v_bitop3_b32 v65, v65, v252, s66 bitop3:0x78
	v_mfma_f32_32x32x16_bf16 v[160:175], a[56:59], v[60:63], v[160:175]
	v_bitop3_b32 v69, v69, v252, s66 bitop3:0x78
	v_or3_b32 v254, v64, v68, v65
	v_bitop3_b32 v254, v254, v69, s66 bitop3:0xa8
	v_cmp_ne_u32 vcc, 0, v254
	v_mfma_f32_32x32x16_bf16 v[176:191], a[60:63], v[60:63], v[176:191]
	s_cbranch_vccnz L_slow24
L_back24:
	v_mfma_f32_32x32x16_bf16 v[160:175], a[64:67], v[64:67], v[160:175]
	s_add_u32 s100, s72, 12288
	buffer_load_dwordx4 v[48:51], v250, s[20:23], s100 offen offset:0 sc1
	v_mfma_f32_32x32x16_bf16 v[176:191], a[68:71], v[64:67], v[176:191]
	buffer_load_dwordx4 v[52:55], v250, s[20:23], s100 offen offset:1024 sc1
	s_waitcnt vmcnt(11)
	v_bitop3_b32 v72, v72, v251, s66 bitop3:0x78
	s_waitcnt vmcnt(10)
	v_bitop3_b32 v76, v76, v251, s66 bitop3:0x78
	v_bitop3_b32 v73, v73, v252, s66 bitop3:0x78
	v_mfma_f32_32x32x16_bf16 v[160:175], a[72:75], v[68:71], v[160:175]
	v_bitop3_b32 v77, v77, v252, s66 bitop3:0x78
	v_or3_b32 v254, v72, v76, v73
	v_bitop3_b32 v254, v254, v77, s66 bitop3:0xa8
	v_cmp_ne_u32 vcc, 0, v254
	v_mfma_f32_32x32x16_bf16 v[176:191], a[76:79], v[68:71], v[176:191]
	s_cbranch_vccnz L_slow25
L_back25:
	v_mfma_f32_32x32x16_bf16 v[160:175], a[80:83], v[72:75], v[160:175]
	v_cmp_ne_u64_e64 vcc, s[60:61], v[240:241]
	v_cmp_ne_u64 s[84:85], s[60:61], v[244:245]
	s_nop 0
	s_or_b64 vcc, vcc, s[84:85]
	s_nop 0
	s_cbranch_vccnz L_slow26
L_back26:
	buffer_load_dwordx4 v[56:59], v250, s[20:23], s100 offen offset:2048 sc1
	v_mul_f32 v242, v243, v243
	v_mul_f32 v246, v247, v247
	v_mfma_f32_32x32x16_bf16 v[176:191], a[84:87], v[72:75], v[176:191]
	v_xor_b32_e64 v8, 32, v30
	buffer_load_dwordx4 v[60:63], v250, s[20:23], s100 offen offset:3072 sc1
	v_xor_b32_e64 v9, 64, v30
	v_xor_b32 v14, 96, v30
	s_waitcnt vmcnt(11)
	v_bitop3_b32 v80, v80, v251, s66 bitop3:0x78
	s_waitcnt vmcnt(10)
	v_bitop3_b32 v84, v84, v251, s66 bitop3:0x78
	v_bitop3_b32 v81, v81, v252, s66 bitop3:0x78
	v_mfma_f32_32x32x16_bf16 v[160:175], a[88:91], v[76:79], v[160:175]
	s_mov_b32 s82, 0xbfb8aa3b
	v_lshlrev_b32_e64 v240, 16, v24
	v_and_b32 v24, 0xffff0000, v24
	v_bitop3_b32 v85, v85, v252, s66 bitop3:0x78
	v_or3_b32 v254, v80, v84, v81
	v_bitop3_b32 v254, v254, v85, s66 bitop3:0xa8
	v_cmp_ne_u32_e64 vcc, 0, v254
	v_mfma_f32_32x32x16_bf16 v[176:191], a[92:95], v[76:79], v[176:191]
	s_cbranch_vccnz L_slow27
L_back27:
	v_lshlrev_b32 v241, 16, v25
	v_and_b32 v25, 0xffff0000, v25
	v_lshlrev_b32_e64 v244, 16, v26
	v_mfma_f32_32x32x16_bf16 v[192:207], a[0:3], v[80:83], v[192:207]
	s_add_u32 s100, s73, L_end-L_exit-4+0
	buffer_load_dwordx4 v[64:67], v1, s[20:23], s100 offen offset:0 sc1
	v_and_b32 v26, 0xffff0000, v26
	v_mfma_f32_32x32x16_bf16 v[208:223], a[4:7], v[80:83], v[208:223]
	buffer_load_dwordx4 v[68:71], v1, s[20:23], s100 offen offset:1024 sc1
	ds_write_b128 v2, v[160:163] offset:0
	s_waitcnt vmcnt(11)
	v_bitop3_b32 v88, v88, v251, s66 bitop3:0x78
	s_waitcnt vmcnt(10)
	v_bitop3_b32 v92, v92, v251, s66 bitop3:0x78
	v_bitop3_b32 v89, v89, v252, s66 bitop3:0x78
	v_mfma_f32_32x32x16_bf16 v[192:207], a[8:11], v[84:87], v[192:207]
	v_lshlrev_b32_e64 v245, 16, v27
	v_bitop3_b32 v93, v93, v252, s66 bitop3:0x78
	v_or3_b32 v254, v88, v92, v89
	v_bitop3_b32 v254, v254, v93, s66 bitop3:0xa8
	v_cmp_ne_u32 vcc, 0, v254
	v_mfma_f32_32x32x16_bf16 v[208:223], a[12:15], v[84:87], v[208:223]
	s_cbranch_vccnz L_slow28
L_back28:
	ds_write_b128 v3, v[164:167] offset:0
	v_and_b32 v27, 0xffff0000, v27
	v_mfma_f32_32x32x16_bf16 v[192:207], a[16:19], v[88:91], v[192:207]
	buffer_load_dwordx4 v[72:75], v1, s[20:23], s100 offen offset:2048 sc1
	v_mfma_f32_32x32x16_bf16 v[208:223], a[20:23], v[88:91], v[208:223]
	buffer_load_dwordx4 v[76:79], v1, s[20:23], s100 offen offset:3072 sc1
	ds_write_b128 v4, v[168:171] offset:0
	s_waitcnt vmcnt(11)
	v_bitop3_b32 v32, v32, v251, s66 bitop3:0x78
	s_waitcnt vmcnt(10)
	v_bitop3_b32 v36, v36, v251, s66 bitop3:0x78
	v_bitop3_b32 v33, v33, v252, s66 bitop3:0x78
	v_mfma_f32_32x32x16_bf16 v[192:207], a[24:27], v[92:95], v[192:207]
	ds_write_b128 v5, v[172:175] offset:0
	v_bitop3_b32 v37, v37, v252, s66 bitop3:0x78
	v_or3_b32 v254, v32, v36, v33
	v_bitop3_b32 v254, v254, v37, s66 bitop3:0xa8
	v_cmp_ne_u32 vcc, 0, v254
	v_mfma_f32_32x32x16_bf16 v[208:223], a[28:31], v[92:95], v[208:223]
	s_cbranch_vccnz L_slow29
L_back29:
	ds_write_b128 v2, v[176:179] offset:128
	v_mfma_f32_32x32x16_bf16 v[192:207], a[32:35], v[32:35], v[192:207]
	s_add_u32 s100, s73, 4096
	buffer_load_dwordx4 v[80:83], v1, s[20:23], s100 offen offset:0 sc1
	v_mfma_f32_32x32x16_bf16 v[208:223], a[36:39], v[32:35], v[208:223]
	buffer_load_dwordx4 v[84:87], v1, s[20:23], s100 offen offset:1024 sc1
	ds_write_b128 v3, v[180:183] offset:128
	s_waitcnt vmcnt(11)
	v_bitop3_b32 v40, v40, v251, s66 bitop3:0x78
	s_waitcnt vmcnt(10)
	v_bitop3_b32 v44, v44, v251, s66 bitop3:0x78
	v_bitop3_b32 v41, v41, v252, s66 bitop3:0x78
	v_mfma_f32_32x32x16_bf16 v[192:207], a[40:43], v[36:39], v[192:207]
	ds_write_b128 v4, v[184:187] offset:128
	v_bitop3_b32 v45, v45, v252, s66 bitop3:0x78
	v_or3_b32 v254, v40, v44, v41
	v_bitop3_b32 v254, v254, v45, s66 bitop3:0xa8
	v_cmp_ne_u32 vcc, 0, v254
	v_mfma_f32_32x32x16_bf16 v[208:223], a[44:47], v[36:39], v[208:223]
	s_cbranch_vccnz L_slow30
L_back30:
	ds_write_b128 v5, v[188:191] offset:128
	v_mfma_f32_32x32x16_bf16 v[192:207], a[48:51], v[40:43], v[192:207]
	buffer_load_dwordx4 v[88:91], v1, s[20:23], s100 offen offset:2048 sc1
	v_mfma_f32_32x32x16_bf16 v[208:223], a[52:55], v[40:43], v[208:223]
	buffer_load_dwordx4 v[92:95], v1, s[20:23], s100 offen offset:3072 sc1
	s_waitcnt vmcnt(11)
	v_bitop3_b32 v48, v48, v251, s66 bitop3:0x78
	s_waitcnt vmcnt(10)
	v_bitop3_b32 v52, v52, v251, s66 bitop3:0x78
	v_bitop3_b32 v49, v49, v252, s66 bitop3:0x78
	v_mfma_f32_32x32x16_bf16 v[192:207], a[56:59], v[44:47], v[192:207]
	v_bitop3_b32 v53, v53, v252, s66 bitop3:0x78
	v_or3_b32 v254, v48, v52, v49
	v_bitop3_b32 v254, v254, v53, s66 bitop3:0xa8
	v_cmp_ne_u32 vcc, 0, v254
	v_mfma_f32_32x32x16_bf16 v[208:223], a[60:63], v[44:47], v[208:223]
	s_cbranch_vccnz L_slow31
L_back31:
	s_waitcnt lgkmcnt(0)
	s_barrier
	ds_read_b128 v[160:163], v6 offset:0
	ds_read_b128 v[164:167], v6 offset:16384
	ds_read_b128 v[168:171], v6 offset:32768
	ds_read_b128 v[172:175], v6 offset:49152
	ds_read_b128 v[176:179], v7 offset:0
	ds_read_b128 v[180:183], v7 offset:16384
	ds_read_b128 v[184:187], v7 offset:32768
	ds_read_b128 v[188:191], v7 offset:49152
	v_mfma_f32_32x32x16_bf16 v[192:207], a[64:67], v[48:51], v[192:207]
	s_add_u32 s100, s73, 0
	s_waitcnt lgkmcnt(4)
	buffer_load_dwordx4 v[32:35], v250, s[20:23], s100 offen offset:0 sc1
	v_add_f32_e64 v160, v160, v164
	v_mfma_f32_32x32x16_bf16 v[208:223], a[68:71], v[48:51], v[208:223]
	v_add_f32_e64 v161, v161, v165
	buffer_load_dwordx4 v[36:39], v250, s[20:23], s100 offen offset:1024 sc1
	v_add_f32 v162, v162, v166
	v_add_f32 v163, v163, v167
	s_waitcnt vmcnt(11)
	v_bitop3_b32 v56, v56, v251, s66 bitop3:0x78
	s_waitcnt vmcnt(10)
	v_bitop3_b32 v60, v60, v251, s66 bitop3:0x78
	v_bitop3_b32 v57, v57, v252, s66 bitop3:0x78
	v_mfma_f32_32x32x16_bf16 v[192:207], a[72:75], v[52:55], v[192:207]
	v_add_f32 v168, v168, v172
	v_add_f32 v169, v169, v173
	v_bitop3_b32 v61, v61, v252, s66 bitop3:0x78
	v_or3_b32 v254, v56, v60, v57
	v_bitop3_b32 v254, v254, v61, s66 bitop3:0xa8
	v_cmp_ne_u32_e64 vcc, 0, v254
	v_mfma_f32_32x32x16_bf16 v[208:223], a[76:79], v[52:55], v[208:223]
	s_cbranch_vccnz L_slow32
L_back32:
	v_add_f32 v170, v170, v174
	v_add_f32 v171, v171, v175
	v_add_f32 v160, v160, v168
	v_mfma_f32_32x32x16_bf16 v[192:207], a[80:83], v[56:59], v[192:207]
	v_add_f32_e64 v161, v161, v169
	buffer_load_dwordx4 v[40:43], v250, s[20:23], s100 offen offset:2048 sc1
	v_add_f32 v162, v162, v170
	v_add_f32 v163, v163, v171
	v_mfma_f32_32x32x16_bf16 v[208:223], a[84:87], v[56:59], v[208:223]
	v_fma_f32 v160, v160, v242, v240
	buffer_load_dwordx4 v[44:47], v250, s[20:23], s100 offen offset:3072 sc1
	v_fma_f32 v161, v161, v242, v24
	v_fma_f32 v162, v162, v242, v241
	s_waitcnt vmcnt(11)
	v_bitop3_b32 v64, v64, v251, s63 bitop3:0x78
	s_waitcnt vmcnt(10)
	v_bitop3_b32 v68, v68, v251, s63 bitop3:0x78
	v_bitop3_b32 v65, v65, v252, s63 bitop3:0x78
	v_mfma_f32_32x32x16_bf16 v[192:207], a[88:91], v[60:63], v[192:207]
	v_fma_f32 v163, v163, v242, v25
	v_mul_f32 v164, s82, v160
	v_mul_f32 v165, s82, v161
	v_bitop3_b32 v69, v69, v252, s63 bitop3:0x78
	v_or3_b32 v254, v64, v68, v65
	v_bitop3_b32 v254, v254, v69, s63 bitop3:0xa8
	v_cmp_ne_u32_e64 vcc, 0, v254
	v_mfma_f32_32x32x16_bf16 v[208:223], a[92:95], v[60:63], v[208:223]
	s_cbranch_vccnz L_slow33
L_back33:
	v_mul_f32 v166, s82, v162
	v_mul_f32 v167, s82, v163
	v_exp_f32 v164, v164
	v_exp_f32_e64 v165, v165
	v_mfma_f32_32x32x16_bf16 v[96:111], a[96:99], v[64:67], 0
	s_add_u32 s100, s73, 4096
	v_exp_f32_e64 v166, v166
	buffer_load_dwordx4 v[48:51], v250, s[20:23], s100 offen offset:0 sc1
	v_exp_f32 v167, v167
	v_add_f32 v164, 1.0, v164
	v_mfma_f32_32x32x16_bf16 v[112:127], a[100:103], v[64:67], 0
	v_add_f32_e64 v165, 1.0, v165
	ds_write_b128 v2, v[192:195] offset:8192
	buffer_load_dwordx4 v[52:55], v250, s[20:23], s100 offen offset:1024 sc1
	v_add_f32 v166, 1.0, v166
	v_add_f32 v167, 1.0, v167
	s_waitcnt vmcnt(11)
	v_bitop3_b32 v72, v72, v251, s63 bitop3:0x78
	s_waitcnt vmcnt(10)
	v_bitop3_b32 v76, v76, v251, s63 bitop3:0x78
	v_bitop3_b32 v73, v73, v252, s63 bitop3:0x78
	v_mfma_f32_32x32x16_bf16 v[96:111], a[104:107], v[68:71], v[96:111]
	v_rcp_f32 v164, v164
	v_rcp_f32 v165, v165
	ds_write_b128 v3, v[196:199] offset:8192
	v_rcp_f32_e64 v166, v166
	v_bitop3_b32 v77, v77, v252, s63 bitop3:0x78
	v_or3_b32 v254, v72, v76, v73
	v_bitop3_b32 v254, v254, v77, s63 bitop3:0xa8
	v_cmp_ne_u32_e64 vcc, 0, v254
	v_mfma_f32_32x32x16_bf16 v[112:127], a[108:111], v[68:71], v[112:127]
	s_cbranch_vccnz L_slow34
L_back34:
	v_rcp_f32 v167, v167
	v_mul_f32 v224, v160, v164
	v_mul_f32 v225, v161, v165
	v_mul_f32_e64 v226, v162, v166
	v_mfma_f32_32x32x16_bf16 v[96:111], a[112:115], v[72:75], v[96:111]
	v_mul_f32 v227, v163, v167
	s_waitcnt lgkmcnt(2)
	buffer_load_dwordx4 v[56:59], v250, s[20:23], s100 offen offset:2048 sc1
	v_add_f32_e64 v176, v176, v180
	ds_write_b128 v4, v[200:203] offset:8192
	v_mfma_f32_32x32x16_bf16 v[112:127], a[116:119], v[72:75], v[112:127]
	v_add_f32 v177, v177, v181
	v_add_f32 v178, v178, v182
	buffer_load_dwordx4 v[60:63], v250, s[20:23], s100 offen offset:3072 sc1
	v_add_f32_e64 v179, v179, v183
	ds_write_b128 v5, v[204:207] offset:8192
	s_waitcnt vmcnt(11)
	v_bitop3_b32 v80, v80, v251, s63 bitop3:0x78
	s_waitcnt vmcnt(10)
	v_bitop3_b32 v84, v84, v251, s63 bitop3:0x78
	v_bitop3_b32 v81, v81, v252, s63 bitop3:0x78
	v_mfma_f32_32x32x16_bf16 v[96:111], a[120:123], v[76:79], v[96:111]
	v_add_f32 v184, v184, v188
	v_add_f32 v185, v185, v189
	v_add_f32_e64 v186, v186, v190
	ds_write_b128 v2, v[208:211] offset:8320
	v_bitop3_b32 v85, v85, v252, s63 bitop3:0x78
	v_or3_b32 v254, v80, v84, v81
	v_bitop3_b32 v254, v254, v85, s63 bitop3:0xa8
	v_cmp_ne_u32_e64 vcc, 0, v254
	v_mfma_f32_32x32x16_bf16 v[112:127], a[124:127], v[76:79], v[112:127]
	s_cbranch_vccnz L_slow35
L_back35:
	v_add_f32 v187, v187, v191
	v_add_f32 v176, v176, v184
	v_add_f32 v177, v177, v185
	v_add_f32_e64 v178, v178, v186
	v_mfma_f32_32x32x16_bf16 v[96:111], a[128:131], v[80:83], v[96:111]
	v_add_f32_e64 v179, v179, v187
	v_fma_f32 v176, v176, v242, v244
	v_fma_f32 v177, v177, v242, v26
	ds_write_b128 v3, v[212:215] offset:8320
	v_mfma_f32_32x32x16_bf16 v[112:127], a[132:135], v[80:83], v[112:127]
	v_fma_f32 v178, v178, v242, v245
	v_fma_f32 v179, v179, v242, v27
	v_mul_f32_e64 v180, s82, v176
	ds_write_b128 v4, v[216:219] offset:8320
	s_waitcnt vmcnt(9)
	v_bitop3_b32 v88, v88, v251, s63 bitop3:0x78
	s_waitcnt vmcnt(8)
	v_bitop3_b32 v92, v92, v251, s63 bitop3:0x78
	v_bitop3_b32 v89, v89, v252, s63 bitop3:0x78
	v_mfma_f32_32x32x16_bf16 v[96:111], a[136:139], v[84:87], v[96:111]
	v_mul_f32 v181, s82, v177
	v_mul_f32 v182, s82, v178
	v_mul_f32_e64 v183, s82, v179
	ds_write_b128 v5, v[220:223] offset:8320
	v_bitop3_b32 v93, v93, v252, s63 bitop3:0x78
	v_or3_b32 v254, v88, v92, v89
	v_bitop3_b32 v254, v254, v93, s63 bitop3:0xa8
	v_cmp_ne_u32_e64 vcc, 0, v254
	v_mfma_f32_32x32x16_bf16 v[112:127], a[140:143], v[84:87], v[112:127]
	s_cbranch_vccnz L_slow36
L_back36:
	v_exp_f32 v180, v180
	v_exp_f32 v181, v181
	v_exp_f32 v182, v182
	v_exp_f32_e64 v183, v183
	v_mfma_f32_32x32x16_bf16 v[96:111], a[144:147], v[88:91], v[96:111]
	v_add_f32 v180, 1.0, v180
	v_add_f32 v181, 1.0, v181
	v_add_f32_e64 v182, 1.0, v182
	v_mfma_f32_32x32x16_bf16 v[112:127], a[148:151], v[88:91], v[112:127]
	v_add_f32 v183, 1.0, v183
	v_rcp_f32 v180, v180
	v_rcp_f32_e64 v181, v181
	s_waitcnt vmcnt(7)
	v_bitop3_b32 v32, v32, v251, s63 bitop3:0x78
	s_waitcnt vmcnt(6)
	v_bitop3_b32 v36, v36, v251, s63 bitop3:0x78
	v_bitop3_b32 v33, v33, v252, s63 bitop3:0x78
	v_mfma_f32_32x32x16_bf16 v[96:111], a[152:155], v[92:95], v[96:111]
	v_rcp_f32 v182, v182
	v_rcp_f32 v183, v183
	v_mul_f32_e64 v228, v176, v180
	v_bitop3_b32 v37, v37, v252, s63 bitop3:0x78
	v_or3_b32 v254, v32, v36, v33
	v_bitop3_b32 v254, v254, v37, s63 bitop3:0xa8
	v_cmp_ne_u32_e64 vcc, 0, v254
	v_mfma_f32_32x32x16_bf16 v[112:127], a[156:159], v[92:95], v[112:127]
	s_cbranch_vccnz L_slow37
L_back37:
	v_mul_f32 v229, v177, v181
	v_mul_f32 v230, v178, v182
	v_mul_f32 v231, v179, v183
	s_waitcnt lgkmcnt(0)
	s_barrier
	ds_read_b128 v[192:195], v6 offset:8192
	ds_read_b128 v[196:199], v6 offset:24576
	ds_read_b128 v[200:203], v6 offset:40960
	ds_read_b128 v[204:207], v6 offset:57344
	ds_read_b128 v[208:211], v7 offset:8192
	ds_read_b128 v[212:215], v7 offset:24576
	ds_read_b128 v[216:219], v7 offset:40960
	ds_read_b128 v[220:223], v7 offset:57344
	v_mfma_f32_32x32x16_bf16 v[128:143], a[96:99], v[32:35], 0
	ds_write_b128 v30, v[96:99] offset:0
	ds_write_b128 v8, v[100:103] offset:0
	s_waitcnt lgkmcnt(6)
	v_add_f32 v192, v192, v196
	v_add_f32_e64 v193, v193, v197
	v_mfma_f32_32x32x16_bf16 v[144:159], a[100:103], v[32:35], 0
	v_add_f32 v194, v194, v198
	v_add_f32 v195, v195, v199
	v_add_f32 v200, v200, v204
	v_add_f32 v201, v201, v205
	v_add_f32_e64 v202, v202, v206
	s_waitcnt vmcnt(5)
	v_bitop3_b32 v40, v40, v251, s63 bitop3:0x78
	s_waitcnt vmcnt(4)
	v_bitop3_b32 v44, v44, v251, s63 bitop3:0x78
	v_bitop3_b32 v41, v41, v252, s63 bitop3:0x78
	v_mfma_f32_32x32x16_bf16 v[128:143], a[104:107], v[36:39], v[128:143]
	v_add_f32 v203, v203, v207
	v_add_f32 v192, v192, v200
	v_add_f32 v193, v193, v201
	v_add_f32 v194, v194, v202
	v_add_f32_e64 v195, v195, v203
	v_bitop3_b32 v45, v45, v252, s63 bitop3:0x78
	v_or3_b32 v254, v40, v44, v41
	v_bitop3_b32 v254, v254, v45, s63 bitop3:0xa8
	v_cmp_ne_u32 vcc, 0, v254
	v_mfma_f32_32x32x16_bf16 v[144:159], a[108:111], v[36:39], v[144:159]
	s_cbranch_vccnz L_slow38
L_back38:
	v_fma_f32 v192, v192, v246, v240
	v_fma_f32 v193, v193, v246, v24
	v_fma_f32 v194, v194, v246, v241
	v_fma_f32 v195, v195, v246, v25
	v_mul_f32 v196, s82, v192
	v_mul_f32 v197, s82, v193
	v_mfma_f32_32x32x16_bf16 v[128:143], a[112:115], v[40:43], v[128:143]
	v_mul_f32 v198, s82, v194
	v_mul_f32 v199, s82, v195
	v_exp_f32 v196, v196
	v_exp_f32 v197, v197
	v_exp_f32_e64 v198, v198
	ds_write_b128 v9, v[104:107] offset:0
	v_mfma_f32_32x32x16_bf16 v[144:159], a[116:119], v[40:43], v[144:159]
	v_exp_f32 v199, v199
	v_add_f32 v196, 1.0, v196
	v_add_f32 v197, 1.0, v197
	v_add_f32 v198, 1.0, v198
	v_add_f32 v199, 1.0, v199
	v_rcp_f32 v196, v196
	s_waitcnt vmcnt(3)
	v_bitop3_b32 v48, v48, v251, s63 bitop3:0x78
	s_waitcnt vmcnt(2)
	v_bitop3_b32 v52, v52, v251, s63 bitop3:0x78
	v_bitop3_b32 v49, v49, v252, s63 bitop3:0x78
	v_mfma_f32_32x32x16_bf16 v[128:143], a[120:123], v[44:47], v[128:143]
	ds_write_b128 v14, v[108:111] offset:0
	v_rcp_f32 v197, v197
	v_rcp_f32 v198, v198
	v_rcp_f32 v199, v199
	v_mul_f32 v232, v192, v196
	v_mul_f32_e64 v233, v193, v197
	v_bitop3_b32 v53, v53, v252, s63 bitop3:0x78
	v_or3_b32 v254, v48, v52, v49
	v_bitop3_b32 v254, v254, v53, s63 bitop3:0xa8
	v_cmp_ne_u32 vcc, 0, v254
	v_mfma_f32_32x32x16_bf16 v[144:159], a[124:127], v[44:47], v[144:159]
	s_cbranch_vccnz L_slow39
L_back39:
	s_waitcnt vmcnt(1)
	v_bitop3_b32 v56, v56, v251, s63 bitop3:0x78
	s_waitcnt vmcnt(0)
	v_bitop3_b32 v60, v60, v251, s63 bitop3:0x78
	v_bitop3_b32 v57, v57, v252, s63 bitop3:0x78
	v_bitop3_b32 v61, v61, v252, s63 bitop3:0x78
	v_or3_b32 v254, v56, v60, v57
	v_bitop3_b32 v254, v254, v61, s63 bitop3:0xa8
	v_cmp_ne_u32_e64 vcc, 0, v254
	s_nop 0
	s_cbranch_vccnz L_slow40
L_back40:
	ds_write_b128 v30, v[112:115] offset:128
	v_mul_f32 v234, v194, v198
	v_mul_f32 v235, v195, v199
	s_waitcnt lgkmcnt(5)
	v_add_f32 v208, v208, v212
	v_add_f32 v209, v209, v213
	v_add_f32 v210, v210, v214
	v_mfma_f32_32x32x16_bf16 v[128:143], a[128:131], v[48:51], v[128:143]
	v_add_f32 v211, v211, v215
	v_add_f32 v216, v216, v220
	v_add_f32 v217, v217, v221
	v_add_f32 v218, v218, v222
	v_add_f32_e64 v219, v219, v223
	ds_write_b128 v8, v[116:119] offset:128
	v_mfma_f32_32x32x16_bf16 v[128:143], a[136:139], v[52:55], v[128:143]
	v_add_f32 v208, v208, v216
	v_add_f32 v209, v209, v217
	v_add_f32 v210, v210, v218
	v_add_f32 v211, v211, v219
	v_fma_f32 v208, v208, v246, v244
	v_fma_f32 v209, v209, v246, v26
	v_mfma_f32_32x32x16_bf16 v[128:143], a[144:147], v[56:59], v[128:143]
	ds_write_b128 v9, v[120:123] offset:128
	v_fma_f32 v210, v210, v246, v245
	v_fma_f32 v211, v211, v246, v27
	v_mul_f32 v212, s82, v208
	v_mul_f32 v213, s82, v209
	v_mul_f32_e64 v214, s82, v210
	v_mfma_f32_32x32x16_bf16 v[128:143], a[152:155], v[60:63], v[128:143]
	ds_write_b128 v14, v[124:127] offset:128
	v_mul_f32 v215, s82, v211
	v_exp_f32 v212, v212
	v_exp_f32 v213, v213
	v_exp_f32 v214, v214
	v_exp_f32 v215, v215
	v_add_f32 v212, 1.0, v212
	v_mfma_f32_32x32x16_bf16 v[144:159], a[132:135], v[48:51], v[144:159]
	v_add_f32 v213, 1.0, v213
	v_add_f32 v214, 1.0, v214
	v_add_f32_e64 v215, 1.0, v215
	v_mfma_f32_32x32x16_bf16 v[144:159], a[140:143], v[52:55], v[144:159]
	v_rcp_f32_e64 v212, v212
	ds_write_b128 v30, v[128:131] offset:8192
	v_rcp_f32 v213, v213
	v_rcp_f32 v214, v214
	v_mfma_f32_32x32x16_bf16 v[144:159], a[148:151], v[56:59], v[144:159]
	ds_write_b128 v8, v[132:135] offset:8192
	v_rcp_f32 v215, v215
	v_mul_f32 v236, v208, v212
	v_mfma_f32_32x32x16_bf16 v[144:159], a[156:159], v[60:63], v[144:159]
	ds_write_b128 v9, v[136:139] offset:8192
	v_mul_f32 v237, v209, v213
	v_mul_f32 v238, v210, v214
	v_mul_f32_e64 v239, v211, v215
	ds_write_b128 v14, v[140:143] offset:8192
	s_waitcnt lgkmcnt(4)
	s_barrier
	ds_read_b128 v[160:163], v28 offset:0
	ds_read_b128 v[164:167], v28 offset:16384
	ds_read_b128 v[168:171], v28 offset:32768
	ds_read_b128 v[172:175], v28 offset:49152
	ds_read_b128 v[176:179], v29 offset:0
	ds_read_b128 v[180:183], v29 offset:16384
	ds_read_b128 v[184:187], v29 offset:32768
	ds_read_b128 v[188:191], v29 offset:49152
	ds_write_b128 v30, v[144:147] offset:8320
	v_lshlrev_b32_e64 v96, 16, v16
	v_and_b32 v97, 0xffff0000, v16
	v_lshlrev_b32_e64 v98, 16, v17
	v_and_b32 v99, 0xffff0000, v17
	v_lshlrev_b32_e64 v100, 16, v18
	v_and_b32 v101, 0xffff0000, v18
	ds_write_b128 v8, v[148:151] offset:8320
	v_lshlrev_b32 v102, 16, v19
	v_and_b32 v103, 0xffff0000, v19
	s_waitcnt lgkmcnt(6)
	v_pk_add_f32 v[160:161], v[160:161], v[164:165]
	v_pk_add_f32 v[162:163], v[162:163], v[166:167]
	v_pk_add_f32 v[168:169], v[168:169], v[172:173]
	ds_write_b128 v9, v[152:155] offset:8320
	v_pk_add_f32 v[170:171], v[170:171], v[174:175]
	v_pk_add_f32 v[160:161], v[160:161], v[168:169]
	v_pk_add_f32 v[162:163], v[162:163], v[170:171]
	v_pk_fma_f32 v[96:97], v[160:161], v[224:225], v[96:97]
	v_pk_fma_f32 v[98:99], v[162:163], v[226:227], v[98:99]
	s_waitcnt lgkmcnt(3)
	s_nop 0
	ds_write_b128 v14, v[156:159] offset:8320
	v_pk_add_f32 v[176:177], v[176:177], v[180:181]
	v_pk_add_f32 v[178:179], v[178:179], v[182:183]
	v_pk_add_f32 v[184:185], v[184:185], v[188:189]
	v_pk_add_f32 v[186:187], v[186:187], v[190:191]
	v_pk_add_f32 v[176:177], v[176:177], v[184:185]
	v_pk_add_f32 v[178:179], v[178:179], v[186:187]
	v_pk_fma_f32 v[100:101], v[176:177], v[228:229], v[100:101]
	v_pk_fma_f32 v[102:103], v[178:179], v[230:231], v[102:103]
	v_cvt_pk_bf16_f32 v104, v96, v97
	v_cvt_pk_bf16_f32 v105, v98, v99
	v_cvt_pk_bf16_f32 v106, v100, v101
	v_cvt_pk_bf16_f32 v107, v102, v103
	buffer_store_dwordx4 v[104:107], v15, s[24:27], s54 offen sc1 nt
	s_waitcnt lgkmcnt(0)
	s_barrier
	ds_read_b128 v[192:195], v28 offset:8192
	ds_read_b128 v[196:199], v28 offset:24576
	ds_read_b128 v[200:203], v28 offset:40960
	ds_read_b128 v[204:207], v28 offset:57344
	ds_read_b128 v[208:211], v29 offset:8192
	ds_read_b128 v[212:215], v29 offset:24576
	ds_read_b128 v[216:219], v29 offset:40960
	ds_read_b128 v[220:223], v29 offset:57344
	v_lshlrev_b32_e64 v112, 16, v20
	v_and_b32 v113, 0xffff0000, v20
	v_lshlrev_b32_e64 v114, 16, v21
	v_and_b32 v115, 0xffff0000, v21
	v_lshlrev_b32_e64 v116, 16, v22
	v_and_b32 v117, 0xffff0000, v22
	v_lshlrev_b32 v118, 16, v23
	v_and_b32 v119, 0xffff0000, v23
	s_waitcnt lgkmcnt(4)
	v_pk_add_f32 v[192:193], v[192:193], v[196:197]
	v_pk_add_f32 v[194:195], v[194:195], v[198:199]
	v_pk_add_f32 v[200:201], v[200:201], v[204:205]
	v_pk_add_f32 v[202:203], v[202:203], v[206:207]
	v_pk_add_f32 v[192:193], v[192:193], v[200:201]
	v_pk_add_f32 v[194:195], v[194:195], v[202:203]
	v_pk_fma_f32 v[112:113], v[192:193], v[232:233], v[112:113]
	v_pk_fma_f32 v[114:115], v[194:195], v[234:235], v[114:115]
	s_waitcnt lgkmcnt(0)
	s_nop 0
	v_pk_add_f32 v[208:209], v[208:209], v[212:213]
	v_pk_add_f32 v[210:211], v[210:211], v[214:215]
	v_pk_add_f32 v[216:217], v[216:217], v[220:221]
	v_pk_add_f32 v[218:219], v[218:219], v[222:223]
	v_pk_add_f32 v[208:209], v[208:209], v[216:217]
	v_pk_add_f32 v[210:211], v[210:211], v[218:219]
	v_pk_fma_f32 v[116:117], v[208:209], v[236:237], v[116:117]
	v_pk_fma_f32 v[118:119], v[210:211], v[238:239], v[118:119]
	v_cvt_pk_bf16_f32 v120, v112, v113
	v_cvt_pk_bf16_f32 v121, v114, v115
	v_cvt_pk_bf16_f32 v122, v116, v117
	v_cvt_pk_bf16_f32 v123, v118, v119
	buffer_store_dwordx4 v[120:123], v15, s[24:27], s53 offen sc1 nt
	s_or_b32 s3, s2, s40
	s_cmp_lg_u32 s3, 0
	s_cbranch_scc1 L_fin
	v_mov_b32 v254, 0
	v_mov_b32 v255, 0
	s_mov_b64 exec, 1
	buffer_store_dwordx2 v[254:255], off, s[36:39], 0 sc1
	s_mov_b64 exec, -1
L_fin:
	s_endpgm
L_typeB:
	v_and_b32 v247, 31, v0
	v_lshlrev_b32 v247, 1, v247
	buffer_load_ushort v240, v247, s[28:31], s93 offen offset:0
	buffer_load_ushort v241, v247, s[28:31], s93 offen offset:64
	buffer_load_ushort v242, v247, s[28:31], s93 offen offset:128
	buffer_load_ushort v243, v247, s[28:31], s93 offen offset:192
	buffer_load_ushort v244, v247, s[28:31], s93 offen offset:256
	buffer_load_ushort v245, v247, s[28:31], s93 offen offset:320
	buffer_load_ushort v246, v247, s[28:31], s99 offen
	v_mov_b32 v216, 0
	v_mov_b32 v217, 0
	v_mov_b32_e64 v218, 0
	v_mov_b32 v219, 0
	v_mov_b32 v220, 0x3f803f80
	s_waitcnt vmcnt(14)
	v_dot2c_f32_bf16 v216, v220, v208
	v_dot2c_f32_bf16 v218, v208, v208
	s_waitcnt vmcnt(13)
	v_dot2c_f32_bf16 v217, v220, v212
	v_dot2c_f32_bf16 v219, v212, v212
	v_dot2c_f32_bf16 v216, v220, v209
	v_dot2c_f32_bf16 v218, v209, v209
	v_dot2c_f32_bf16 v217, v220, v213
	v_dot2c_f32_bf16 v219, v213, v213
	v_dot2c_f32_bf16 v216, v220, v210
	v_dot2c_f32_bf16 v218, v210, v210
	v_dot2c_f32_bf16 v217, v220, v214
	v_dot2c_f32_bf16 v219, v214, v214
	v_dot2c_f32_bf16 v216, v220, v211
	v_dot2c_f32_bf16 v218, v211, v211
	v_dot2c_f32_bf16 v217, v220, v215
	v_dot2c_f32_bf16 v219, v215, v215
	v_add_f32_dpp v216, v216, v216 row_ror:8 row_mask:0xf bank_mask:0xf
	s_nop 0
	v_add_f32_dpp v217, v217, v217 row_ror:8 row_mask:0xf bank_mask:0xf
	v_add_f32_dpp v218, v218, v218 row_ror:8 row_mask:0xf bank_mask:0xf
	v_add_f32_dpp v219, v219, v219 row_ror:8 row_mask:0xf bank_mask:0xf
	v_add_f32_dpp v216, v216, v216 row_ror:4 row_mask:0xf bank_mask:0xf
	v_add_f32_dpp v217, v217, v217 row_ror:4 row_mask:0xf bank_mask:0xf
	v_add_f32_dpp v218, v218, v218 row_ror:4 row_mask:0xf bank_mask:0xf
	v_add_f32_dpp v219, v219, v219 row_ror:4 row_mask:0xf bank_mask:0xf
	v_add_f32_dpp v216, v216, v216 row_ror:2 row_mask:0xf bank_mask:0xf
	v_add_f32_dpp v217, v217, v217 row_ror:2 row_mask:0xf bank_mask:0xf
	v_add_f32_dpp v218, v218, v218 row_ror:2 row_mask:0xf bank_mask:0xf
	v_add_f32_dpp v219, v219, v219 row_ror:2 row_mask:0xf bank_mask:0xf
	v_add_f32_dpp v216, v216, v216 row_ror:1 row_mask:0xf bank_mask:0xf
	v_add_f32_dpp v217, v217, v217 row_ror:1 row_mask:0xf bank_mask:0xf
	v_add_f32_dpp v218, v218, v218 row_ror:1 row_mask:0xf bank_mask:0xf
	v_add_f32_dpp v219, v219, v219 row_ror:1 row_mask:0xf bank_mask:0xf
	v_permlane32_swap_b32 v216, v217
	s_nop 0
	v_permlane32_swap_b32 v218, v219
	v_add_f32 v216, v216, v217
	v_add_f32 v218, v218, v219
	v_mov_b32 v217, v216
	v_mov_b32 v219, v218
	s_nop 0
	v_permlane16_swap_b32 v216, v217
	v_permlane16_swap_b32 v218, v219
	v_add_f32 v216, v216, v217
	v_add_f32 v218, v218, v219
	v_mul_f32 v216, 0x3b000000, v216
	v_mul_f32 v218, 0x3b000000, v218
	v_fma_f32 v218, -v216, v216, v218
	v_max_f32_e64 v218, 0, v218
	v_cvt_pk_bf16_f32 v217, -v216, v218
	v_and_b32 v218, 0xffff0000, v217
	v_lshlrev_b32_e64 v216, 16, v217
	v_add_f32 v218, 0x3727c5ac, v218
	v_cvt_pk_bf16_f32 v218, v218, v218
	v_lshlrev_b32_e64 v218, 16, v218
	v_sqrt_f32 v218, v218
	s_nop 0
	v_cvt_pk_bf16_f32 v202, v218, v216
	v_lshlrev_b32 v218, 16, v202
	v_rcp_f32 v203, v218
	s_add_u32 s56, s43, L_end-L_exit-4+1
	s_and_b32 s56, s56, 7
	s_mul_i32 s57, s56, s51
	s_lshl_b32 s56, s56, 7
	s_add_u32 m0, s52, 4096
	s_add_u32 s58, s56, s47
	s_add_u32 s59, s57, s48
	buffer_load_dwordx4 v2, s[4:7], s58 offen offset:0 lds
	buffer_load_dwordx4 v3, s[4:7], s58 offen offset:1024 lds
	buffer_load_dwordx4 v4, s[4:7], s58 offen offset:2048 lds
	buffer_load_dwordx4 v5, s[4:7], s58 offen offset:3072 lds
	s_add_u32 m0, s53, 16384
	s_nop 0
	buffer_load_dwordx4 v6, s[8:11], s59 offen offset:0 lds
	buffer_load_dwordx4 v7, s[8:11], s59 offen offset:1024 lds
	buffer_load_dwordx4 v8, s[8:11], s59 offen offset:2048 lds
	buffer_load_dwordx4 v9, s[8:11], s59 offen offset:3072 lds
	s_waitcnt vmcnt(17)
	s_barrier
	ds_read_b128 a[0:3], v23 offset:0
	ds_read_b64_tr_b16 v[144:145], v15 offset:0
	ds_read_b64_tr_b16 v[146:147], v15 offset:512
	ds_read_b64_tr_b16 v[148:149], v16 offset:0
	ds_read_b64_tr_b16 v[150:151], v16 offset:512
	ds_read_b64_tr_b16 v[152:153], v15 offset:8192
	ds_read_b64_tr_b16 v[154:155], v15 offset:8704
	ds_read_b64_tr_b16 v[156:157], v16 offset:8192
	ds_read_b64_tr_b16 v[158:159], v16 offset:8704
	s_waitcnt lgkmcnt(0)
	v_mfma_f32_32x32x16_bf16 v[32:47], v[144:147], a[0:3], 0
	ds_read_b128 a[4:7], v24 offset:0
	ds_read_b64_tr_b16 v[160:161], v17 offset:0
	ds_read_b64_tr_b16 v[162:163], v17 offset:512
	v_mfma_f32_16x16x32_bf16 v[224:227], v[176:179], v[144:147], 0
	v_mfma_f32_32x32x16_bf16 v[48:63], v[148:151], a[0:3], 0
	s_add_u32 s56, s43, 2
	s_and_b32 s56, s56, 7
	s_mul_i32 s57, s56, s51
	s_lshl_b32 s56, s56, L_end-L_exit-4+7
	s_add_u32 m0, s52, 8192
	s_add_u32 s58, s56, s47
	s_add_u32 s59, s57, s48
	ds_read_b64_tr_b16 v[164:165], v18 offset:0
	ds_read_b64_tr_b16 v[166:167], v18 offset:512
	ds_read_b64_tr_b16 v[168:169], v17 offset:8192
	v_mfma_f32_16x16x32_bf16 v[228:231], v[176:179], v[148:151], 0
	buffer_load_dwordx4 v2, s[4:7], s58 offen offset:0 lds
	v_mfma_f32_32x32x16_bf16 v[64:79], v[152:155], a[0:3], 0
	ds_read_b64_tr_b16 v[170:171], v17 offset:8704
	ds_read_b64_tr_b16 v[172:173], v18 offset:8192
	ds_read_b64_tr_b16 v[174:175], v18 offset:8704
	v_mfma_f32_16x16x32_bf16 v[232:235], v[176:179], v[152:155], 0
	buffer_load_dwordx4 v3, s[4:7], s58 offen offset:1024 lds
	v_mfma_f32_32x32x16_bf16 v[80:95], v[156:159], a[0:3], 0
	v_mfma_f32_16x16x32_bf16 v[236:239], v[176:179], v[156:159], 0
	s_waitcnt lgkmcnt(0)
	s_nop 0
	v_mfma_f32_32x32x16_bf16 v[32:47], v[160:163], a[4:7], v[32:47]
	ds_read_b128 a[8:11], v25 offset:0
	ds_read_b64_tr_b16 v[144:145], v19 offset:0
	ds_read_b64_tr_b16 v[146:147], v19 offset:512
	v_mfma_f32_32x32x16_bf16 v[48:63], v[164:167], a[4:7], v[48:63]
	ds_read_b64_tr_b16 v[148:149], v20 offset:0
	ds_read_b64_tr_b16 v[150:151], v20 offset:512
	ds_read_b64_tr_b16 v[152:153], v19 offset:8192
	buffer_load_dwordx4 v4, s[4:7], s58 offen offset:2048 lds
	v_mfma_f32_32x32x16_bf16 v[64:79], v[168:171], a[4:7], v[64:79]
	ds_read_b64_tr_b16 v[154:155], v19 offset:8704
	ds_read_b64_tr_b16 v[156:157], v20 offset:8192
	ds_read_b64_tr_b16 v[158:159], v20 offset:8704
	buffer_load_dwordx4 v5, s[4:7], s58 offen offset:3072 lds
	v_mfma_f32_32x32x16_bf16 v[80:95], v[172:175], a[4:7], v[80:95]
	s_add_u32 m0, s53, 32768
	s_nop 0
	buffer_load_dwordx4 v6, s[8:11], s59 offen offset:0 lds
	s_waitcnt lgkmcnt(0)
	v_mfma_f32_32x32x16_bf16 v[32:47], v[144:147], a[8:11], v[32:47]
	ds_read_b128 a[12:15], v26 offset:0
	ds_read_b64_tr_b16 v[160:161], v21 offset:0
	ds_read_b64_tr_b16 v[162:163], v21 offset:512
	v_mfma_f32_32x32x16_bf16 v[48:63], v[148:151], a[8:11], v[48:63]
	ds_read_b64_tr_b16 v[164:165], v22 offset:0
	ds_read_b64_tr_b16 v[166:167], v22 offset:512
	ds_read_b64_tr_b16 v[168:169], v21 offset:8192
	buffer_load_dwordx4 v7, s[8:11], s59 offen offset:1024 lds
	v_mfma_f32_32x32x16_bf16 v[64:79], v[152:155], a[8:11], v[64:79]
	ds_read_b64_tr_b16 v[170:171], v21 offset:8704
	ds_read_b64_tr_b16 v[172:173], v22 offset:8192
	ds_read_b64_tr_b16 v[174:175], v22 offset:8704
	buffer_load_dwordx4 v8, s[8:11], s59 offen offset:2048 lds
	v_mfma_f32_32x32x16_bf16 v[80:95], v[156:159], a[8:11], v[80:95]
	s_waitcnt lgkmcnt(0)
	s_nop 0
	v_mfma_f32_32x32x16_bf16 v[32:47], v[160:163], a[12:15], v[32:47]
	s_waitcnt vmcnt(7)
	s_barrier
	ds_read_b128 a[16:19], v23 offset:4096
	ds_read_b64_tr_b16 v[144:145], v15 offset:16384
	ds_read_b64_tr_b16 v[146:147], v15 offset:16896
	v_mfma_f32_32x32x16_bf16 v[48:63], v[164:167], a[12:15], v[48:63]
	ds_read_b64_tr_b16 v[148:149], v16 offset:16384
	ds_read_b64_tr_b16 v[150:151], v16 offset:16896
	ds_read_b64_tr_b16 v[152:153], v15 offset:24576
	buffer_load_dwordx4 v9, s[8:11], s59 offen offset:3072 lds
	v_mfma_f32_32x32x16_bf16 v[64:79], v[168:171], a[12:15], v[64:79]
	s_add_u32 s56, s43, L_end-L_exit-4+3
	s_and_b32 s56, s56, 7
	s_mul_i32 s57, s56, s51
	s_lshl_b32 s56, s56, 7
	s_add_u32 m0, s52, 12288
	s_add_u32 s58, s56, s47
	s_add_u32 s59, s57, s48
	ds_read_b64_tr_b16 v[154:155], v15 offset:25088
	ds_read_b64_tr_b16 v[156:157], v16 offset:24576
	ds_read_b64_tr_b16 v[158:159], v16 offset:25088
	buffer_load_dwordx4 v2, s[4:7], s58 offen offset:0 lds
	v_mfma_f32_32x32x16_bf16 v[80:95], v[172:175], a[12:15], v[80:95]
	buffer_load_dwordx2 v[254:255], off, s[36:39], 0 sc1
	s_waitcnt lgkmcnt(0)
	v_mfma_f32_32x32x16_bf16 v[32:47], v[144:147], a[16:19], v[32:47]
	ds_read_b128 a[20:23], v24 offset:4096
	ds_read_b64_tr_b16 v[160:161], v17 offset:16384
	ds_read_b64_tr_b16 v[162:163], v17 offset:16896
	v_mfma_f32_16x16x32_bf16 v[224:227], v[176:179], v[144:147], v[224:227]
	v_mfma_f32_32x32x16_bf16 v[48:63], v[148:151], a[16:19], v[48:63]
	ds_read_b64_tr_b16 v[164:165], v18 offset:16384
	ds_read_b64_tr_b16 v[166:167], v18 offset:16896
	ds_read_b64_tr_b16 v[168:169], v17 offset:24576
	v_mfma_f32_16x16x32_bf16 v[228:231], v[176:179], v[148:151], v[228:231]
	buffer_load_dwordx4 v3, s[4:7], s58 offen offset:1024 lds
	v_mfma_f32_32x32x16_bf16 v[64:79], v[152:155], a[16:19], v[64:79]
	ds_read_b64_tr_b16 v[170:171], v17 offset:25088
	ds_read_b64_tr_b16 v[172:173], v18 offset:24576
	ds_read_b64_tr_b16 v[174:175], v18 offset:25088
	v_mfma_f32_16x16x32_bf16 v[232:235], v[176:179], v[152:155], v[232:235]
	buffer_load_dwordx4 v4, s[4:7], s58 offen offset:2048 lds
	v_mfma_f32_32x32x16_bf16 v[80:95], v[156:159], a[16:19], v[80:95]
	v_mfma_f32_16x16x32_bf16 v[236:239], v[176:179], v[156:159], v[236:239]
	s_waitcnt lgkmcnt(0)
	v_mfma_f32_32x32x16_bf16 v[32:47], v[160:163], a[20:23], v[32:47]
	ds_read_b128 a[24:27], v25 offset:4096
	ds_read_b64_tr_b16 v[144:145], v19 offset:16384
	ds_read_b64_tr_b16 v[146:147], v19 offset:16896
	v_mfma_f32_32x32x16_bf16 v[48:63], v[164:167], a[20:23], v[48:63]
	ds_read_b64_tr_b16 v[148:149], v20 offset:16384
	ds_read_b64_tr_b16 v[150:151], v20 offset:16896
	ds_read_b64_tr_b16 v[152:153], v19 offset:24576
	buffer_load_dwordx4 v5, s[4:7], s58 offen offset:3072 lds
	v_mfma_f32_32x32x16_bf16 v[64:79], v[168:171], a[20:23], v[64:79]
	s_add_u32 m0, s53, 49152
	ds_read_b64_tr_b16 v[154:155], v19 offset:25088
	ds_read_b64_tr_b16 v[156:157], v20 offset:24576
	ds_read_b64_tr_b16 v[158:159], v20 offset:25088
	buffer_load_dwordx4 v6, s[8:11], s59 offen offset:0 lds
	v_mfma_f32_32x32x16_bf16 v[80:95], v[172:175], a[20:23], v[80:95]
	buffer_load_dwordx4 v7, s[8:11], s59 offen offset:1024 lds
	s_waitcnt lgkmcnt(0)
	v_mfma_f32_32x32x16_bf16 v[32:47], v[144:147], a[24:27], v[32:47]
	ds_read_b128 a[28:31], v26 offset:4096
	ds_read_b64_tr_b16 v[160:161], v21 offset:16384
	ds_read_b64_tr_b16 v[162:163], v21 offset:16896
	v_mfma_f32_32x32x16_bf16 v[48:63], v[148:151], a[24:27], v[48:63]
	ds_read_b64_tr_b16 v[164:165], v22 offset:16384
	ds_read_b64_tr_b16 v[166:167], v22 offset:16896
	ds_read_b64_tr_b16 v[168:169], v21 offset:24576
	buffer_load_dwordx4 v8, s[8:11], s59 offen offset:2048 lds
	v_mfma_f32_32x32x16_bf16 v[64:79], v[152:155], a[24:27], v[64:79]
	ds_read_b64_tr_b16 v[170:171], v21 offset:25088
	ds_read_b64_tr_b16 v[172:173], v22 offset:24576
	ds_read_b64_tr_b16 v[174:175], v22 offset:25088
	buffer_load_dwordx4 v9, s[8:11], s59 offen offset:3072 lds
	v_mfma_f32_32x32x16_bf16 v[80:95], v[156:159], a[24:27], v[80:95]
	s_waitcnt lgkmcnt(0)
	v_mfma_f32_32x32x16_bf16 v[32:47], v[160:163], a[28:31], v[32:47]
	s_waitcnt vmcnt(9)
	s_barrier
	ds_read_b128 a[32:35], v23 offset:8192
	ds_read_b64_tr_b16 v[144:145], v15 offset:32768
	ds_read_b64_tr_b16 v[146:147], v15 offset:33280
	v_mfma_f32_32x32x16_bf16 v[48:63], v[164:167], a[28:31], v[48:63]
	s_add_u32 s56, s43, 4
	s_and_b32 s56, s56, 7
	s_mul_i32 s57, s56, s51
	s_lshl_b32 s56, s56, 7
	s_add_u32 m0, s52, 0
	s_add_u32 s58, s56, s47
	s_add_u32 s59, s57, s48
	ds_read_b64_tr_b16 v[148:149], v16 offset:32768
	ds_read_b64_tr_b16 v[150:151], v16 offset:33280
	ds_read_b64_tr_b16 v[152:153], v15 offset:40960
	buffer_load_dwordx4 v2, s[4:7], s58 offen offset:0 lds
	v_mfma_f32_32x32x16_bf16 v[64:79], v[168:171], a[28:31], v[64:79]
	ds_read_b64_tr_b16 v[154:155], v15 offset:41472
	ds_read_b64_tr_b16 v[156:157], v16 offset:40960
	ds_read_b64_tr_b16 v[158:159], v16 offset:41472
	buffer_load_dwordx4 v3, s[4:7], s58 offen offset:1024 lds
	v_mfma_f32_32x32x16_bf16 v[80:95], v[172:175], a[28:31], v[80:95]
	buffer_load_dwordx4 v4, s[4:7], s58 offen offset:2048 lds
	s_waitcnt lgkmcnt(0)
	s_nop 0
	v_mfma_f32_32x32x16_bf16 v[32:47], v[144:147], a[32:35], v[32:47]
	ds_read_b128 a[36:39], v24 offset:8192
	ds_read_b64_tr_b16 v[160:161], v17 offset:32768
	ds_read_b64_tr_b16 v[162:163], v17 offset:33280
	v_mfma_f32_16x16x32_bf16 v[224:227], v[176:179], v[144:147], v[224:227]
	v_mfma_f32_32x32x16_bf16 v[48:63], v[148:151], a[32:35], v[48:63]
	ds_read_b64_tr_b16 v[164:165], v18 offset:32768
	ds_read_b64_tr_b16 v[166:167], v18 offset:33280
	ds_read_b64_tr_b16 v[168:169], v17 offset:40960
	v_mfma_f32_16x16x32_bf16 v[228:231], v[176:179], v[148:151], v[228:231]
	buffer_load_dwordx4 v5, s[4:7], s58 offen offset:3072 lds
	v_mfma_f32_32x32x16_bf16 v[64:79], v[152:155], a[32:35], v[64:79]
	s_add_u32 m0, s53, 0
	ds_read_b64_tr_b16 v[170:171], v17 offset:41472
	ds_read_b64_tr_b16 v[172:173], v18 offset:40960
	ds_read_b64_tr_b16 v[174:175], v18 offset:41472
	v_mfma_f32_16x16x32_bf16 v[232:235], v[176:179], v[152:155], v[232:235]
	buffer_load_dwordx4 v6, s[8:11], s59 offen offset:0 lds
	v_mfma_f32_32x32x16_bf16 v[80:95], v[156:159], a[32:35], v[80:95]
	v_mfma_f32_16x16x32_bf16 v[236:239], v[176:179], v[156:159], v[236:239]
	s_waitcnt lgkmcnt(0)
	v_mfma_f32_32x32x16_bf16 v[32:47], v[160:163], a[36:39], v[32:47]
	ds_read_b128 a[40:43], v25 offset:8192
	ds_read_b64_tr_b16 v[144:145], v19 offset:32768
	ds_read_b64_tr_b16 v[146:147], v19 offset:33280
	v_mfma_f32_32x32x16_bf16 v[48:63], v[164:167], a[36:39], v[48:63]
	ds_read_b64_tr_b16 v[148:149], v20 offset:32768
	ds_read_b64_tr_b16 v[150:151], v20 offset:33280
	ds_read_b64_tr_b16 v[152:153], v19 offset:40960
	buffer_load_dwordx4 v7, s[8:11], s59 offen offset:1024 lds
	s_waitcnt vmcnt(13)
	v_cmp_eq_u32 vcc, 0, v255
	s_nop 0
	s_cbranch_vccnz L_slow41
L_back41:
	v_mfma_f32_32x32x16_bf16 v[64:79], v[168:171], a[36:39], v[64:79]
	ds_read_b64_tr_b16 v[154:155], v19 offset:41472
	ds_read_b64_tr_b16 v[156:157], v20 offset:40960
	ds_read_b64_tr_b16 v[158:159], v20 offset:41472
	buffer_load_dwordx4 v8, s[8:11], s59 offen offset:2048 lds
	v_mfma_f32_32x32x16_bf16 v[80:95], v[172:175], a[36:39], v[80:95]
	buffer_load_dwordx4 v9, s[8:11], s59 offen offset:3072 lds
	v_readfirstlane_b32 s60, v254
	v_readfirstlane_b32 s61, v255
	v_and_b32 v253, 15, v0
	v_min_u32 v253, 14, v253
	v_lshl_add_u32 v253, v253, 1, 2
	v_lshrrev_b32 v253, v253, v254
	s_and_b32 s67, s60, 3
	v_and_b32 v253, 3, v253
	s_mul_i32 s3, s67, 0x8001
	s_mov_b32 s63, 0x10001
	s_and_b32 s3, s3, s63
	s_mul_i32 s3, s3, 0x8001
	v_mul_u32_u24 v252, 0x8001, v253
	v_mov_b32_e64 v251, s3
	v_and_b32 v252, s63, v252
	s_bfe_u32 s46, s60, 0x20002
	v_lshl_or_b32 v252, v252, 15, v252
	s_waitcnt lgkmcnt(0)
	v_mfma_f32_32x32x16_bf16 v[32:47], v[144:147], a[40:43], v[32:47]
	ds_read_b128 a[44:47], v26 offset:8192
	ds_read_b64_tr_b16 v[160:161], v21 offset:32768
	ds_read_b64_tr_b16 v[162:163], v21 offset:33280
	v_mov_b32_e64 v200, s60
	v_mfma_f32_32x32x16_bf16 v[48:63], v[148:151], a[40:43], v[48:63]
	s_add_u32 s56, s43, 5
	s_and_b32 s56, s56, 7
	s_mul_i32 s57, s56, s51
	s_lshl_b32 s56, s56, 7
	s_add_u32 m0, s52, 4096
	s_add_u32 s58, s56, s47
	s_add_u32 s59, s57, s48
	ds_read_b64_tr_b16 v[164:165], v22 offset:32768
	ds_read_b64_tr_b16 v[166:167], v22 offset:33280
	ds_read_b64_tr_b16 v[168:169], v21 offset:40960
	v_mov_b32_e64 v201, s61
	buffer_load_dwordx4 v2, s[4:7], s58 offen offset:0 lds
	v_lshrrev_b32_e64 v216, 5, v0
	v_mfma_f32_32x32x16_bf16 v[64:79], v[152:155], a[40:43], v[64:79]
	ds_read_b64_tr_b16 v[170:171], v21 offset:41472
	ds_read_b64_tr_b16 v[172:173], v22 offset:40960
	ds_read_b64_tr_b16 v[174:175], v22 offset:41472
	v_lshlrev_b32_e64 v216, 4, v216
	buffer_load_dwordx4 v3, s[4:7], s58 offen offset:1024 lds
	s_lshl_b32 s3, s98, L_end-L_exit-4+5
	v_mfma_f32_32x32x16_bf16 v[80:95], v[156:159], a[40:43], v[80:95]
	s_add_u32 s3, s3, 10027008
	s_mov_b32 s84, L_end-L_exit-4+1
	s_mov_b32 s85, 1
	s_mov_b64 exec, s[84:85]
	buffer_store_dwordx4 v[200:203], v216, s[20:23], s3 offen sc1
	s_mov_b64 exec, -1
	s_waitcnt lgkmcnt(0)
	v_mfma_f32_32x32x16_bf16 v[32:47], v[160:163], a[44:47], v[32:47]
	s_waitcnt vmcnt(11)
	s_barrier
	ds_read_b128 a[48:51], v23 offset:12288
	ds_read_b64_tr_b16 v[144:145], v15 offset:49152
	ds_read_b64_tr_b16 v[146:147], v15 offset:49664
	v_mfma_f32_32x32x16_bf16 v[48:63], v[164:167], a[44:47], v[48:63]
	ds_read_b64_tr_b16 v[148:149], v16 offset:49152
	ds_read_b64_tr_b16 v[150:151], v16 offset:49664
	ds_read_b64_tr_b16 v[152:153], v15 offset:57344
	buffer_load_dwordx4 v4, s[4:7], s58 offen offset:2048 lds
	v_mfma_f32_32x32x16_bf16 v[64:79], v[168:171], a[44:47], v[64:79]
	ds_read_b64_tr_b16 v[154:155], v15 offset:57856
	ds_read_b64_tr_b16 v[156:157], v16 offset:57344
	ds_read_b64_tr_b16 v[158:159], v16 offset:57856
	buffer_load_dwordx4 v5, s[4:7], s58 offen offset:3072 lds
	v_mfma_f32_32x32x16_bf16 v[80:95], v[172:175], a[44:47], v[80:95]
	s_add_u32 m0, s53, 16384
	s_nop 0
	buffer_load_dwordx4 v6, s[8:11], s59 offen offset:0 lds
	s_waitcnt lgkmcnt(0)
	v_mfma_f32_32x32x16_bf16 v[32:47], v[144:147], a[48:51], v[32:47]
	ds_read_b128 a[52:55], v24 offset:12288
	ds_read_b64_tr_b16 v[160:161], v17 offset:49152
	ds_read_b64_tr_b16 v[162:163], v17 offset:49664
	v_mfma_f32_16x16x32_bf16 v[224:227], v[176:179], v[144:147], v[224:227]
	v_mfma_f32_32x32x16_bf16 v[48:63], v[148:151], a[48:51], v[48:63]
	ds_read_b64_tr_b16 v[164:165], v18 offset:49152
	ds_read_b64_tr_b16 v[166:167], v18 offset:49664
	ds_read_b64_tr_b16 v[168:169], v17 offset:57344
	v_mfma_f32_16x16x32_bf16 v[228:231], v[176:179], v[148:151], v[228:231]
	buffer_load_dwordx4 v7, s[8:11], s59 offen offset:1024 lds
	v_mfma_f32_32x32x16_bf16 v[64:79], v[152:155], a[48:51], v[64:79]
	ds_read_b64_tr_b16 v[170:171], v17 offset:57856
	ds_read_b64_tr_b16 v[172:173], v18 offset:57344
	ds_read_b64_tr_b16 v[174:175], v18 offset:57856
	v_mfma_f32_16x16x32_bf16 v[232:235], v[176:179], v[152:155], v[232:235]
	buffer_load_dwordx4 v8, s[8:11], s59 offen offset:2048 lds
	v_mfma_f32_32x32x16_bf16 v[80:95], v[156:159], a[48:51], v[80:95]
	v_mfma_f32_16x16x32_bf16 v[236:239], v[176:179], v[156:159], v[236:239]
	s_waitcnt lgkmcnt(0)
	s_nop 0
	v_mfma_f32_32x32x16_bf16 v[32:47], v[160:163], a[52:55], v[32:47]
	ds_read_b128 a[56:59], v25 offset:12288
	ds_read_b64_tr_b16 v[144:145], v19 offset:49152
	ds_read_b64_tr_b16 v[146:147], v19 offset:49664
	v_mfma_f32_32x32x16_bf16 v[48:63], v[164:167], a[52:55], v[48:63]
	ds_read_b64_tr_b16 v[148:149], v20 offset:49152
	ds_read_b64_tr_b16 v[150:151], v20 offset:49664
	ds_read_b64_tr_b16 v[152:153], v19 offset:57344
	buffer_load_dwordx4 v9, s[8:11], s59 offen offset:3072 lds
	v_mfma_f32_32x32x16_bf16 v[64:79], v[168:171], a[52:55], v[64:79]
	s_add_u32 s56, s43, 6
	s_and_b32 s56, s56, 7
	s_mul_i32 s57, s56, s51
	s_lshl_b32 s56, s56, 7
	s_add_u32 m0, s52, 8192
	s_add_u32 s58, s56, s47
	s_add_u32 s59, s57, s48
	ds_read_b64_tr_b16 v[154:155], v19 offset:57856
	ds_read_b64_tr_b16 v[156:157], v20 offset:57344
	ds_read_b64_tr_b16 v[158:159], v20 offset:57856
	buffer_load_dwordx4 v2, s[4:7], s58 offen offset:0 lds
	v_mfma_f32_32x32x16_bf16 v[80:95], v[172:175], a[52:55], v[80:95]
	buffer_load_dwordx4 v3, s[4:7], s58 offen offset:1024 lds
	s_waitcnt lgkmcnt(0)
	v_mfma_f32_32x32x16_bf16 v[32:47], v[144:147], a[56:59], v[32:47]
	ds_read_b128 a[60:63], v26 offset:12288
	ds_read_b64_tr_b16 v[160:161], v21 offset:49152
	ds_read_b64_tr_b16 v[162:163], v21 offset:49664
	v_mfma_f32_32x32x16_bf16 v[48:63], v[148:151], a[56:59], v[48:63]
	ds_read_b64_tr_b16 v[164:165], v22 offset:49152
	ds_read_b64_tr_b16 v[166:167], v22 offset:49664
	ds_read_b64_tr_b16 v[168:169], v21 offset:57344
	buffer_load_dwordx4 v4, s[4:7], s58 offen offset:2048 lds
	v_mfma_f32_32x32x16_bf16 v[64:79], v[152:155], a[56:59], v[64:79]
	ds_read_b64_tr_b16 v[170:171], v21 offset:57856
	ds_read_b64_tr_b16 v[172:173], v22 offset:57344
	ds_read_b64_tr_b16 v[174:175], v22 offset:57856
	buffer_load_dwordx4 v5, s[4:7], s58 offen offset:3072 lds
	v_mfma_f32_32x32x16_bf16 v[80:95], v[156:159], a[56:59], v[80:95]
	s_waitcnt lgkmcnt(0)
	v_mfma_f32_32x32x16_bf16 v[32:47], v[160:163], a[60:63], v[32:47]
	s_waitcnt vmcnt(13)
	s_barrier
	ds_read_b128 a[64:67], v23 offset:0
	ds_read_b64_tr_b16 v[144:145], v15 offset:0
	ds_read_b64_tr_b16 v[146:147], v15 offset:512
	v_mfma_f32_32x32x16_bf16 v[48:63], v[164:167], a[60:63], v[48:63]
	s_add_u32 m0, s53, 32768
	ds_read_b64_tr_b16 v[148:149], v16 offset:0
	ds_read_b64_tr_b16 v[150:151], v16 offset:512
	ds_read_b64_tr_b16 v[152:153], v15 offset:8192
	buffer_load_dwordx4 v6, s[8:11], s59 offen offset:0 lds
	v_mfma_f32_32x32x16_bf16 v[64:79], v[168:171], a[60:63], v[64:79]
	ds_read_b64_tr_b16 v[154:155], v15 offset:8704
	ds_read_b64_tr_b16 v[156:157], v16 offset:8192
	ds_read_b64_tr_b16 v[158:159], v16 offset:8704
	buffer_load_dwordx4 v7, s[8:11], s59 offen offset:1024 lds
	v_mfma_f32_32x32x16_bf16 v[80:95], v[172:175], a[60:63], v[80:95]
	buffer_load_dwordx4 v8, s[8:11], s59 offen offset:2048 lds
	s_waitcnt lgkmcnt(0)
	s_nop 0
	v_mfma_f32_32x32x16_bf16 v[32:47], v[144:147], a[64:67], v[32:47]
	ds_read_b128 a[68:71], v24 offset:0
	ds_read_b64_tr_b16 v[160:161], v17 offset:0
	ds_read_b64_tr_b16 v[162:163], v17 offset:512
	v_mfma_f32_16x16x32_bf16 v[224:227], v[176:179], v[144:147], v[224:227]
	v_mfma_f32_32x32x16_bf16 v[48:63], v[148:151], a[64:67], v[48:63]
	ds_read_b64_tr_b16 v[164:165], v18 offset:0
	ds_read_b64_tr_b16 v[166:167], v18 offset:512
	ds_read_b64_tr_b16 v[168:169], v17 offset:8192
	v_mfma_f32_16x16x32_bf16 v[228:231], v[176:179], v[148:151], v[228:231]
	buffer_load_dwordx4 v9, s[8:11], s59 offen offset:3072 lds
	v_mfma_f32_32x32x16_bf16 v[64:79], v[152:155], a[64:67], v[64:79]
	s_add_u32 s56, s43, L_end-L_exit-4+7
	s_and_b32 s56, s56, 7
	s_mul_i32 s57, s56, s51
	s_lshl_b32 s56, s56, 7
	s_add_u32 m0, s52, 12288
	s_add_u32 s58, s56, s47
	s_add_u32 s59, s57, s48
	ds_read_b64_tr_b16 v[170:171], v17 offset:8704
	ds_read_b64_tr_b16 v[172:173], v18 offset:8192
	ds_read_b64_tr_b16 v[174:175], v18 offset:8704
	v_mfma_f32_16x16x32_bf16 v[232:235], v[176:179], v[152:155], v[232:235]
	buffer_load_dwordx4 v2, s[4:7], s58 offen offset:0 lds
	v_mfma_f32_32x32x16_bf16 v[80:95], v[156:159], a[64:67], v[80:95]
	v_mfma_f32_16x16x32_bf16 v[236:239], v[176:179], v[156:159], v[236:239]
	s_waitcnt lgkmcnt(0)
	v_mfma_f32_32x32x16_bf16 v[32:47], v[160:163], a[68:71], v[32:47]
	ds_read_b128 a[72:75], v25 offset:0
	ds_read_b64_tr_b16 v[144:145], v19 offset:0
	ds_read_b64_tr_b16 v[146:147], v19 offset:512
	v_mfma_f32_32x32x16_bf16 v[48:63], v[164:167], a[68:71], v[48:63]
	ds_read_b64_tr_b16 v[148:149], v20 offset:0
	ds_read_b64_tr_b16 v[150:151], v20 offset:512
	ds_read_b64_tr_b16 v[152:153], v19 offset:8192
	buffer_load_dwordx4 v3, s[4:7], s58 offen offset:1024 lds
	v_mfma_f32_32x32x16_bf16 v[64:79], v[168:171], a[68:71], v[64:79]
	ds_read_b64_tr_b16 v[154:155], v19 offset:8704
	ds_read_b64_tr_b16 v[156:157], v20 offset:8192
	ds_read_b64_tr_b16 v[158:159], v20 offset:8704
	buffer_load_dwordx4 v4, s[4:7], s58 offen offset:2048 lds
	v_mfma_f32_32x32x16_bf16 v[80:95], v[172:175], a[68:71], v[80:95]
	buffer_load_dwordx4 v5, s[4:7], s58 offen offset:3072 lds
	s_waitcnt lgkmcnt(0)
	v_mfma_f32_32x32x16_bf16 v[32:47], v[144:147], a[72:75], v[32:47]
	ds_read_b128 a[76:79], v26 offset:0
	ds_read_b64_tr_b16 v[160:161], v21 offset:0
	ds_read_b64_tr_b16 v[162:163], v21 offset:512
	v_mfma_f32_32x32x16_bf16 v[48:63], v[148:151], a[72:75], v[48:63]
	s_add_u32 m0, s53, 49152
	ds_read_b64_tr_b16 v[164:165], v22 offset:0
	ds_read_b64_tr_b16 v[166:167], v22 offset:512
	ds_read_b64_tr_b16 v[168:169], v21 offset:8192
	buffer_load_dwordx4 v6, s[8:11], s59 offen offset:0 lds
	v_mfma_f32_32x32x16_bf16 v[64:79], v[152:155], a[72:75], v[64:79]
	ds_read_b64_tr_b16 v[170:171], v21 offset:8704
	ds_read_b64_tr_b16 v[172:173], v22 offset:8192
	ds_read_b64_tr_b16 v[174:175], v22 offset:8704
	buffer_load_dwordx4 v7, s[8:11], s59 offen offset:1024 lds
	v_mfma_f32_32x32x16_bf16 v[80:95], v[156:159], a[72:75], v[80:95]
	s_waitcnt lgkmcnt(0)
	v_mfma_f32_32x32x16_bf16 v[32:47], v[160:163], a[76:79], v[32:47]
	s_waitcnt vmcnt(14)
	s_barrier
	ds_read_b128 a[80:83], v23 offset:4096
	ds_read_b64_tr_b16 v[144:145], v15 offset:16384
	ds_read_b64_tr_b16 v[146:147], v15 offset:16896
	v_mfma_f32_32x32x16_bf16 v[48:63], v[164:167], a[76:79], v[48:63]
	ds_read_b64_tr_b16 v[148:149], v16 offset:16384
	ds_read_b64_tr_b16 v[150:151], v16 offset:16896
	ds_read_b64_tr_b16 v[152:153], v15 offset:24576
	buffer_load_dwordx4 v8, s[8:11], s59 offen offset:2048 lds
	v_mfma_f32_32x32x16_bf16 v[64:79], v[168:171], a[76:79], v[64:79]
	ds_read_b64_tr_b16 v[154:155], v15 offset:25088
	ds_read_b64_tr_b16 v[156:157], v16 offset:24576
	ds_read_b64_tr_b16 v[158:159], v16 offset:25088
	buffer_load_dwordx4 v9, s[8:11], s59 offen offset:3072 lds
	v_mfma_f32_32x32x16_bf16 v[80:95], v[172:175], a[76:79], v[80:95]
	s_add_u32 s56, s43, 0
	s_and_b32 s56, s56, 7
	s_mul_i32 s57, s56, s51
	s_add_u32 m0, s54, 0
	s_add_u32 s57, s57, s49
	buffer_load_dwordx4 v6, s[8:11], s57 offen lds
	s_waitcnt lgkmcnt(0)
	v_mfma_f32_32x32x16_bf16 v[32:47], v[144:147], a[80:83], v[32:47]
	ds_read_b128 a[84:87], v24 offset:4096
	ds_read_b64_tr_b16 v[160:161], v17 offset:16384
	ds_read_b64_tr_b16 v[162:163], v17 offset:16896
	v_mfma_f32_16x16x32_bf16 v[224:227], v[176:179], v[144:147], v[224:227]
	v_mfma_f32_32x32x16_bf16 v[48:63], v[148:151], a[80:83], v[48:63]
	ds_read_b64_tr_b16 v[164:165], v18 offset:16384
	ds_read_b64_tr_b16 v[166:167], v18 offset:16896
	ds_read_b64_tr_b16 v[168:169], v17 offset:24576
	v_mfma_f32_16x16x32_bf16 v[228:231], v[176:179], v[148:151], v[228:231]
	buffer_load_dwordx4 v7, s[8:11], s57 offen offset:1024 lds
	v_mfma_f32_32x32x16_bf16 v[64:79], v[152:155], a[80:83], v[64:79]
	s_add_u32 s56, s43, L_end-L_exit-4+1
	s_and_b32 s56, s56, 7
	s_mul_i32 s57, s56, s51
	s_add_u32 m0, s54, 8192
	s_add_u32 s57, s57, s49
	ds_read_b64_tr_b16 v[170:171], v17 offset:25088
	ds_read_b64_tr_b16 v[172:173], v18 offset:24576
	ds_read_b64_tr_b16 v[174:175], v18 offset:25088
	v_mfma_f32_16x16x32_bf16 v[232:235], v[176:179], v[152:155], v[232:235]
	buffer_load_dwordx4 v6, s[8:11], s57 offen lds
	v_mfma_f32_32x32x16_bf16 v[80:95], v[156:159], a[80:83], v[80:95]
	v_mfma_f32_16x16x32_bf16 v[236:239], v[176:179], v[156:159], v[236:239]
	s_waitcnt lgkmcnt(0)
	v_mfma_f32_32x32x16_bf16 v[32:47], v[160:163], a[84:87], v[32:47]
	ds_read_b128 a[88:91], v25 offset:4096
	ds_read_b64_tr_b16 v[144:145], v19 offset:16384
	ds_read_b64_tr_b16 v[146:147], v19 offset:16896
	v_mfma_f32_32x32x16_bf16 v[48:63], v[164:167], a[84:87], v[48:63]
	ds_read_b64_tr_b16 v[148:149], v20 offset:16384
	ds_read_b64_tr_b16 v[150:151], v20 offset:16896
	ds_read_b64_tr_b16 v[152:153], v19 offset:24576
	buffer_load_dwordx4 v7, s[8:11], s57 offen offset:1024 lds
	v_mfma_f32_32x32x16_bf16 v[64:79], v[168:171], a[84:87], v[64:79]
	v_and_b32 v191, 31, v0
	v_lshlrev_b32 v191, 4, v191
	s_lshl_b32 s98, s74, L_end-L_exit-4+9
	s_add_u32 s98, s98, 10027008
	ds_read_b64_tr_b16 v[154:155], v19 offset:25088
	ds_read_b64_tr_b16 v[156:157], v20 offset:24576
	ds_read_b64_tr_b16 v[158:159], v20 offset:25088
	buffer_load_dwordx4 v[204:207], v191, s[20:23], s98 offen sc1
	v_mfma_f32_32x32x16_bf16 v[80:95], v[172:175], a[84:87], v[80:95]
	v_mul_u32_u24 v197, 3584, v0
	s_and_b32 s56, s42, 1
	s_lshl3_add_u32 s56, s41, s56
	s_lshl_b32 s57, s40, 1
	s_sub_u32 s56, s56, s57
	s_mul_i32 s56, s56, 14336
	s_add_u32 s56, s56, s50
	s_mov_b64 exec, 15
	buffer_load_dword v196, v197, s[8:11], s56 offen
	s_mov_b64 exec, -1
	s_waitcnt lgkmcnt(0)
	v_mfma_f32_32x32x16_bf16 v[32:47], v[144:147], a[88:91], v[32:47]
	ds_read_b128 a[92:95], v26 offset:4096
	ds_read_b64_tr_b16 v[160:161], v21 offset:16384
	ds_read_b64_tr_b16 v[162:163], v21 offset:16896
	v_mfma_f32_32x32x16_bf16 v[48:63], v[148:151], a[88:91], v[48:63]
	s_lshl2_add_u32 s56, s2, s40
	s_lshr_b32 s57, s2, 3
	s_lshl2_add_u32 s57, s57, s40
	v_and_b32 v198, 15, v0
	v_min_u32 v199, 13, v198
	v_min_u32 v198, 3, v198
	v_cmp_gt_u32 vcc, 16, v0
	s_mul_i32 s58, s56, 14
	v_add_lshl_u32 v197, v199, s58, 7
	s_mul_i32 s58, s57, L_end-L_exit-4+14
	v_add_lshl_u32 v199, v199, s58, 10
	v_add_u32 v199, 384, v199
	v_cndmask_b32 v199, v199, v197, vcc
	s_mul_i32 s58, s56, 4
	v_add_lshl_u32 v197, v198, s58, 7
	s_mul_i32 s58, s57, L_end-L_exit-4+4
	v_add_lshl_u32 v198, v198, s58, 10
	v_add_u32 v198, 384, v198
	v_cndmask_b32_e64 v198, v198, v197, vcc
	ds_read_b64_tr_b16 v[164:165], v22 offset:16384
	ds_read_b64_tr_b16 v[166:167], v22 offset:16896
	ds_read_b64_tr_b16 v[168:169], v21 offset:24576
	s_mov_b64 exec, s[86:87]
	buffer_load_dword v199, v199, s[12:15], 0 offen
	s_mov_b64 exec, -1
	v_mfma_f32_32x32x16_bf16 v[64:79], v[152:155], a[88:91], v[64:79]
	ds_read_b64_tr_b16 v[170:171], v21 offset:25088
	ds_read_b64_tr_b16 v[172:173], v22 offset:24576
	ds_read_b64_tr_b16 v[174:175], v22 offset:25088
	v_mfma_f32_32x32x16_bf16 v[80:95], v[156:159], a[88:91], v[80:95]
	s_waitcnt lgkmcnt(0)
	v_mfma_f32_32x32x16_bf16 v[32:47], v[160:163], a[92:95], v[32:47]
	s_waitcnt vmcnt(15)
	s_barrier
	ds_read_b128 a[96:99], v23 offset:8192
	ds_read_b64_tr_b16 v[144:145], v15 offset:32768
	ds_read_b64_tr_b16 v[146:147], v15 offset:33280
	v_mfma_f32_32x32x16_bf16 v[48:63], v[164:167], a[92:95], v[48:63]
	ds_read_b64_tr_b16 v[148:149], v16 offset:32768
	ds_read_b64_tr_b16 v[150:151], v16 offset:33280
	ds_read_b64_tr_b16 v[152:153], v15 offset:40960
	s_mov_b64 exec, s[86:87]
	buffer_load_dword v198, v198, s[16:19], 0 offen
	s_mov_b64 exec, -1
	v_mfma_f32_32x32x16_bf16 v[64:79], v[168:171], a[92:95], v[64:79]
	ds_read_b64_tr_b16 v[154:155], v15 offset:41472
	ds_read_b64_tr_b16 v[156:157], v16 offset:40960
	ds_read_b64_tr_b16 v[158:159], v16 offset:41472
	v_mfma_f32_32x32x16_bf16 v[80:95], v[172:175], a[92:95], v[80:95]
	s_waitcnt lgkmcnt(0)
	v_mfma_f32_32x32x16_bf16 v[32:47], v[144:147], a[96:99], v[32:47]
	ds_read_b128 a[100:103], v24 offset:8192
	ds_read_b64_tr_b16 v[160:161], v17 offset:32768
	ds_read_b64_tr_b16 v[162:163], v17 offset:33280
	v_mfma_f32_16x16x32_bf16 v[224:227], v[176:179], v[144:147], v[224:227]
	v_mfma_f32_32x32x16_bf16 v[48:63], v[148:151], a[96:99], v[48:63]
	s_add_u32 m0, s52, 0
	s_add_u32 s58, s70, 0
	ds_read_b64_tr_b16 v[164:165], v18 offset:32768
	ds_read_b64_tr_b16 v[166:167], v18 offset:33280
	ds_read_b64_tr_b16 v[168:169], v17 offset:40960
	v_mfma_f32_16x16x32_bf16 v[228:231], v[176:179], v[148:151], v[228:231]
	buffer_load_dwordx4 v10, s[12:15], s58 offen offset:0 lds
	v_mfma_f32_32x32x16_bf16 v[64:79], v[152:155], a[96:99], v[64:79]
	ds_read_b64_tr_b16 v[170:171], v17 offset:41472
	ds_read_b64_tr_b16 v[172:173], v18 offset:40960
	ds_read_b64_tr_b16 v[174:175], v18 offset:41472
	v_mfma_f32_16x16x32_bf16 v[232:235], v[176:179], v[152:155], v[232:235]
	v_mfma_f32_32x32x16_bf16 v[80:95], v[156:159], a[96:99], v[80:95]
	v_mfma_f32_16x16x32_bf16 v[236:239], v[176:179], v[156:159], v[236:239]
	s_waitcnt lgkmcnt(0)
	v_mfma_f32_32x32x16_bf16 v[32:47], v[160:163], a[100:103], v[32:47]
	ds_read_b128 a[104:107], v25 offset:8192
	ds_read_b64_tr_b16 v[144:145], v19 offset:32768
	ds_read_b64_tr_b16 v[146:147], v19 offset:33280
	v_mfma_f32_32x32x16_bf16 v[48:63], v[164:167], a[100:103], v[48:63]
	ds_read_b64_tr_b16 v[148:149], v20 offset:32768
	ds_read_b64_tr_b16 v[150:151], v20 offset:33280
	ds_read_b64_tr_b16 v[152:153], v19 offset:40960
	buffer_load_dwordx4 v11, s[12:15], s58 offen offset:1024 lds
	v_mfma_f32_32x32x16_bf16 v[64:79], v[168:171], a[100:103], v[64:79]
	ds_read_b64_tr_b16 v[154:155], v19 offset:41472
	ds_read_b64_tr_b16 v[156:157], v20 offset:40960
	ds_read_b64_tr_b16 v[158:159], v20 offset:41472
	v_mfma_f32_32x32x16_bf16 v[80:95], v[172:175], a[100:103], v[80:95]
	s_waitcnt lgkmcnt(0)
	v_mfma_f32_32x32x16_bf16 v[32:47], v[144:147], a[104:107], v[32:47]
	ds_read_b128 a[108:111], v26 offset:8192
	ds_read_b64_tr_b16 v[160:161], v21 offset:32768
	ds_read_b64_tr_b16 v[162:163], v21 offset:33280
	v_mfma_f32_32x32x16_bf16 v[48:63], v[148:151], a[104:107], v[48:63]
	ds_read_b64_tr_b16 v[164:165], v22 offset:32768
	ds_read_b64_tr_b16 v[166:167], v22 offset:33280
	ds_read_b64_tr_b16 v[168:169], v21 offset:40960
	buffer_load_dwordx4 v12, s[12:15], s58 offen offset:2048 lds
	v_mfma_f32_32x32x16_bf16 v[64:79], v[152:155], a[104:107], v[64:79]
	ds_read_b64_tr_b16 v[170:171], v21 offset:41472
	ds_read_b64_tr_b16 v[172:173], v22 offset:40960
	ds_read_b64_tr_b16 v[174:175], v22 offset:41472
	v_mfma_f32_32x32x16_bf16 v[80:95], v[156:159], a[104:107], v[80:95]
	s_waitcnt lgkmcnt(0)
	v_mfma_f32_32x32x16_bf16 v[32:47], v[160:163], a[108:111], v[32:47]
	s_waitcnt vmcnt(11)
	s_barrier
	ds_read_b128 a[112:115], v23 offset:12288
	ds_read_b64_tr_b16 v[144:145], v15 offset:49152
	ds_read_b64_tr_b16 v[146:147], v15 offset:49664
	v_mfma_f32_32x32x16_bf16 v[48:63], v[164:167], a[108:111], v[48:63]
	ds_read_b64_tr_b16 v[148:149], v16 offset:49152
	ds_read_b64_tr_b16 v[150:151], v16 offset:49664
	ds_read_b64_tr_b16 v[152:153], v15 offset:57344
	buffer_load_dwordx4 v13, s[12:15], s58 offen offset:3072 lds
	v_mfma_f32_32x32x16_bf16 v[64:79], v[168:171], a[108:111], v[64:79]
	ds_read_b64_tr_b16 v[154:155], v15 offset:57856
	ds_read_b64_tr_b16 v[156:157], v16 offset:57344
	ds_read_b64_tr_b16 v[158:159], v16 offset:57856
	v_mfma_f32_32x32x16_bf16 v[80:95], v[172:175], a[108:111], v[80:95]
	s_waitcnt lgkmcnt(0)
	v_mfma_f32_32x32x16_bf16 v[32:47], v[144:147], a[112:115], v[32:47]
	ds_read_b128 a[116:119], v24 offset:12288
	ds_read_b64_tr_b16 v[160:161], v17 offset:49152
	ds_read_b64_tr_b16 v[162:163], v17 offset:49664
	v_mfma_f32_16x16x32_bf16 v[224:227], v[176:179], v[144:147], v[224:227]
	v_mfma_f32_32x32x16_bf16 v[48:63], v[148:151], a[112:115], v[48:63]
	s_add_u32 s56, s43, 2
	s_and_b32 s56, s56, 7
	s_mul_i32 s57, s56, s51
	s_add_u32 m0, s54, 16384
	s_add_u32 s57, s57, s49
	ds_read_b64_tr_b16 v[164:165], v18 offset:49152
	ds_read_b64_tr_b16 v[166:167], v18 offset:49664
	ds_read_b64_tr_b16 v[168:169], v17 offset:57344
	v_mfma_f32_16x16x32_bf16 v[228:231], v[176:179], v[148:151], v[228:231]
	buffer_load_dwordx4 v6, s[8:11], s57 offen lds
	v_mfma_f32_32x32x16_bf16 v[64:79], v[152:155], a[112:115], v[64:79]
	ds_read_b64_tr_b16 v[170:171], v17 offset:57856
	ds_read_b64_tr_b16 v[172:173], v18 offset:57344
	ds_read_b64_tr_b16 v[174:175], v18 offset:57856
	v_mfma_f32_16x16x32_bf16 v[232:235], v[176:179], v[152:155], v[232:235]
	v_mfma_f32_32x32x16_bf16 v[80:95], v[156:159], a[112:115], v[80:95]
	v_mfma_f32_16x16x32_bf16 v[236:239], v[176:179], v[156:159], v[236:239]
	s_waitcnt lgkmcnt(0)
	v_mfma_f32_32x32x16_bf16 v[32:47], v[160:163], a[116:119], v[32:47]
	ds_read_b128 a[120:123], v25 offset:12288
	ds_read_b64_tr_b16 v[144:145], v19 offset:49152
	ds_read_b64_tr_b16 v[146:147], v19 offset:49664
	v_mfma_f32_32x32x16_bf16 v[48:63], v[164:167], a[116:119], v[48:63]
	ds_read_b64_tr_b16 v[148:149], v20 offset:49152
	ds_read_b64_tr_b16 v[150:151], v20 offset:49664
	ds_read_b64_tr_b16 v[152:153], v19 offset:57344
	buffer_load_dwordx4 v7, s[8:11], s57 offen offset:1024 lds
	v_mfma_f32_32x32x16_bf16 v[64:79], v[168:171], a[116:119], v[64:79]
	ds_read_b64_tr_b16 v[154:155], v19 offset:57856
	ds_read_b64_tr_b16 v[156:157], v20 offset:57344
	ds_read_b64_tr_b16 v[158:159], v20 offset:57856
	v_mfma_f32_32x32x16_bf16 v[80:95], v[172:175], a[116:119], v[80:95]
	s_waitcnt lgkmcnt(0)
	v_mfma_f32_32x32x16_bf16 v[32:47], v[144:147], a[120:123], v[32:47]
	ds_read_b128 a[124:127], v26 offset:12288
	ds_read_b64_tr_b16 v[160:161], v21 offset:49152
	ds_read_b64_tr_b16 v[162:163], v21 offset:49664
	v_mfma_f32_32x32x16_bf16 v[48:63], v[148:151], a[120:123], v[48:63]
	s_add_u32 s56, s43, 3
	s_and_b32 s56, s56, 7
	s_mul_i32 s57, s56, s51
	s_add_u32 m0, s54, 24576
	s_add_u32 s57, s57, s49
	ds_read_b64_tr_b16 v[164:165], v22 offset:49152
	ds_read_b64_tr_b16 v[166:167], v22 offset:49664
	ds_read_b64_tr_b16 v[168:169], v21 offset:57344
	buffer_load_dwordx4 v6, s[8:11], s57 offen lds
	v_mfma_f32_32x32x16_bf16 v[64:79], v[152:155], a[120:123], v[64:79]
	ds_read_b64_tr_b16 v[170:171], v21 offset:57856
	ds_read_b64_tr_b16 v[172:173], v22 offset:57344
	ds_read_b64_tr_b16 v[174:175], v22 offset:57856
	v_mfma_f32_32x32x16_bf16 v[80:95], v[156:159], a[120:123], v[80:95]
	s_lshl_b32 s3, s40, L_end-L_exit-4+10
	s_add_u32 s3, s3, 131072
	v_add_u32 v247, s3, v1
	v_mov_b32 v225, v228
	v_mov_b32 v226, v232
	v_mov_b32 v227, v236
	ds_write_b128 v247, v[224:227]
	s_waitcnt lgkmcnt(1)
	v_mfma_f32_32x32x16_bf16 v[32:47], v[160:163], a[124:127], v[32:47]
	s_waitcnt vmcnt(11)
	s_waitcnt lgkmcnt(0)
	s_barrier
	ds_read_b64_tr_b16 v[144:145], v15 offset:0
	ds_read_b64_tr_b16 v[146:147], v15 offset:512
	ds_read_b64_tr_b16 v[148:149], v16 offset:0
	ds_read_b64_tr_b16 v[150:151], v16 offset:512
	v_mfma_f32_32x32x16_bf16 v[48:63], v[164:167], a[124:127], v[48:63]
	buffer_load_dwordx4 v7, s[8:11], s57 offen offset:1024 lds
	v_mfma_f32_32x32x16_bf16 v[64:79], v[168:171], a[124:127], v[64:79]
	v_mfma_f32_32x32x16_bf16 v[80:95], v[172:175], a[124:127], v[80:95]
	ds_read_b64_tr_b16 v[152:153], v17 offset:0
	ds_read_b64_tr_b16 v[154:155], v17 offset:512
	ds_read_b64_tr_b16 v[156:157], v18 offset:0
	ds_read_b64_tr_b16 v[158:159], v18 offset:512
L_midB:
	s_waitcnt lgkmcnt(4)
	s_nop 0
	v_mfma_f32_32x32x16_bf16 v[96:111], v[144:147], a[0:3], 0
	s_add_u32 m0, s52, 4096
	s_add_u32 s58, s70, 32768
	ds_read_b64_tr_b16 v[160:161], v19 offset:0
	ds_read_b64_tr_b16 v[162:163], v19 offset:512
	ds_read_b64_tr_b16 v[164:165], v20 offset:0
	ds_read_b64_tr_b16 v[166:167], v20 offset:512
	v_add_u32 v247, 131072, v1
	ds_read_b128 v[208:211], v247 offset:0
	v_mfma_f32_16x16x32_bf16 v[180:183], v[176:179], v[144:147], 0
	buffer_load_dwordx4 v10, s[12:15], s58 offen offset:0 lds
	ds_read_b128 v[212:215], v247 offset:1024
	ds_read_b128 v[216:219], v247 offset:2048
	v_mfma_f32_32x32x16_bf16 v[112:127], v[148:151], a[0:3], 0
	ds_read_b128 v[220:223], v247 offset:3072
	s_waitcnt vmcnt(12)
	v_mfma_f32_16x16x32_bf16 v[184:187], v[176:179], v[148:151], 0
	buffer_load_dwordx4 v11, s[12:15], s58 offen offset:1024 lds
	v_cmp_ne_u64 vcc, s[60:61], v[204:205]
	s_nop 0
	s_cbranch_vccnz L_slow42
L_back42:
	v_cndmask_b32 v225, 0, v206, s[86:87]
	v_mov_b32 v228, v207
	s_waitcnt lgkmcnt(8)
	v_mfma_f32_32x32x16_bf16 v[96:111], v[152:155], a[4:7], v[96:111]
	ds_read_b64_tr_b16 v[168:169], v21 offset:0
	ds_read_b64_tr_b16 v[170:171], v21 offset:512
	ds_read_b64_tr_b16 v[172:173], v22 offset:0
	ds_read_b64_tr_b16 v[174:175], v22 offset:512
	v_lshrrev_b32 v224, 16, v225
	v_mov_b32 v226, 0
	buffer_load_dwordx4 v12, s[12:15], s58 offen offset:2048 lds
	v_mov_b32_e64 v227, 0
	v_lshl_or_b32 v224, v224, 16, v224
	v_mfma_f32_32x32x16_bf16 v[112:127], v[156:159], a[4:7], v[112:127]
	s_waitcnt lgkmcnt(6)
	v_add_f32 v208, v208, v212
	s_waitcnt lgkmcnt(4)
	v_add_f32 v216, v216, v220
	buffer_load_dwordx4 v13, s[12:15], s58 offen offset:3072 lds
	v_add_f32 v209, v209, v213
	v_add_f32 v217, v217, v221
	v_add_f32_e64 v210, v210, v214
	v_mfma_f32_32x32x16_bf16 v[96:111], v[160:163], a[8:11], v[96:111]
	s_add_u32 s56, s43, L_end-L_exit-4+4
	s_and_b32 s56, s56, 7
	s_mul_i32 s57, s56, s51
	s_add_u32 m0, s54, 32768
	s_add_u32 s57, s57, s49
	ds_read_b64_tr_b16 v[144:145], v15 offset:8192
	ds_read_b64_tr_b16 v[146:147], v15 offset:8704
	ds_read_b64_tr_b16 v[148:149], v16 offset:8192
	ds_read_b64_tr_b16 v[150:151], v16 offset:8704
	s_waitcnt vmcnt(8)
	ds_read_b64_tr_b16 a[128:129], v248 offset:0
	ds_read_b64_tr_b16 a[130:131], v248 offset:1024
	ds_read_b64_tr_b16 a[132:133], v249 offset:0
	buffer_load_dwordx4 v6, s[8:11], s57 offen lds
	ds_read_b64_tr_b16 a[134:135], v249 offset:1024
	ds_read_b64_tr_b16 a[136:137], v248 offset:2048
	ds_read_b64_tr_b16 a[138:139], v248 offset:3072
	ds_read_b64_tr_b16 a[140:141], v249 offset:2048
	ds_read_b64_tr_b16 a[142:143], v249 offset:3072
	v_mfma_f32_32x32x16_bf16 v[112:127], v[164:167], a[8:11], v[112:127]
	v_add_f32 v218, v218, v222
	v_add_f32 v211, v211, v215
	v_add_f32 v219, v219, v223
	v_add_f32 v232, v208, v216
	buffer_load_dwordx4 v7, s[8:11], s57 offen offset:1024 lds
	v_add_f32 v233, v209, v217
	v_add_f32 v234, v210, v218
	v_add_f32_e64 v235, v211, v219
	v_cvt_pk_bf16_f32 v194, v232, v232
	v_cvt_pk_bf16_f32 v198, v233, v233
	s_waitcnt lgkmcnt(12)
	v_mfma_f32_32x32x16_bf16 v[96:111], v[168:171], a[12:15], v[96:111]
	s_add_u32 s56, s43, 5
	s_and_b32 s56, s56, L_end-L_exit-4+7
	s_mul_i32 s57, s56, s51
	s_add_u32 m0, s54, 40960
	s_add_u32 s57, s57, s49
	ds_read_b64_tr_b16 v[152:153], v17 offset:8192
	ds_read_b64_tr_b16 v[154:155], v17 offset:8704
	ds_read_b64_tr_b16 v[156:157], v18 offset:8192
	ds_read_b64_tr_b16 v[158:159], v18 offset:8704
	v_lshlrev_b32 v194, 16, v194
	v_lshlrev_b32 v198, 16, v198
	buffer_load_dwordx4 v6, s[8:11], s57 offen lds
	v_sub_f32 v194, v232, v194
	v_sub_f32 v198, v233, v198
	v_mfma_f32_32x32x16_bf16 v[112:127], v[172:175], a[12:15], v[112:127]
	v_cvt_pk_bf16_f32 v192, v232, v194
	v_cvt_pk_bf16_f32 v196, v233, v198
	buffer_load_dwordx4 v7, s[8:11], s57 offen offset:1024 lds
	v_and_b32 v195, 0xffff0000, v192
	v_and_b32 v199, 0xffff0000, v196
	v_sub_f32 v194, v194, v195
	s_waitcnt lgkmcnt(12)
	v_mfma_f32_32x32x16_bf16 v[96:111], v[144:147], a[16:19], v[96:111]
	s_add_u32 m0, s52, 8192
	s_add_u32 s58, s70, 65536
	ds_read_b64_tr_b16 v[160:161], v19 offset:8192
	ds_read_b64_tr_b16 v[162:163], v19 offset:8704
	ds_read_b64_tr_b16 v[164:165], v20 offset:8192
	ds_read_b64_tr_b16 v[166:167], v20 offset:8704
	v_sub_f32 v198, v198, v199
	v_lshlrev_b32 v195, 16, v240
	v_mfma_f32_16x16x32_bf16 v[180:183], v[176:179], v[144:147], v[180:183]
	buffer_load_dwordx4 v10, s[12:15], s58 offen offset:0 lds
	v_lshlrev_b32_e64 v199, 16, v241
	v_cvt_pk_bf16_f32 v193, v195, v194
	v_mfma_f32_32x32x16_bf16 v[112:127], v[148:151], a[16:19], v[112:127]
	v_cvt_pk_bf16_f32 v197, v199, v198
	v_mov_b32_e64 v194, 0
	v_mfma_f32_16x16x32_bf16 v[184:187], v[176:179], v[148:151], v[184:187]
	buffer_load_dwordx4 v11, s[12:15], s58 offen offset:1024 lds
	v_mov_b32 v198, 0
	v_mov_b32 v195, 0
	v_mov_b32 v199, 0
	s_waitcnt lgkmcnt(4)
	v_mfma_f32_32x32x16_bf16 v[96:111], v[152:155], a[20:23], v[96:111]
	ds_read_b64_tr_b16 v[168:169], v21 offset:8192
	ds_read_b64_tr_b16 v[170:171], v21 offset:8704
	ds_read_b64_tr_b16 v[172:173], v22 offset:8192
	ds_read_b64_tr_b16 v[174:175], v22 offset:8704
	v_mfma_f32_32x32x16_bf16 v[32:47], v[192:195], v[224:227], v[32:47]
	v_mfma_f32_32x32x16_bf16 v[48:63], v[196:199], v[224:227], v[48:63]
	buffer_load_dwordx4 v12, s[12:15], s58 offen offset:2048 lds
	v_cvt_pk_bf16_f32 v202, v234, v234
	v_cvt_pk_bf16_f32 v206, v235, v235
	v_mfma_f32_32x32x16_bf16 v[112:127], v[156:159], a[20:23], v[112:127]
	v_lshlrev_b32 v202, 16, v202
	v_lshlrev_b32 v206, 16, v206
	buffer_load_dwordx4 v13, s[12:15], s58 offen offset:3072 lds
	v_sub_f32 v202, v234, v202
	v_sub_f32 v206, v235, v206
	v_cvt_pk_bf16_f32 v200, v234, v202
	s_waitcnt lgkmcnt(4)
	v_mfma_f32_32x32x16_bf16 v[96:111], v[160:163], a[24:27], v[96:111]
	s_waitcnt vmcnt(12)
	s_waitcnt lgkmcnt(0)
	s_barrier
	s_add_u32 s56, s43, L_end-L_exit-4+6
	s_and_b32 s56, s56, 7
	s_mul_i32 s57, s56, s51
	s_add_u32 m0, s54, 49152
	s_add_u32 s57, s57, s49
	ds_read_b64_tr_b16 v[144:145], v15 offset:16384
	ds_read_b64_tr_b16 v[146:147], v15 offset:16896
	ds_read_b64_tr_b16 v[148:149], v16 offset:16384
	ds_read_b64_tr_b16 v[150:151], v16 offset:16896
	s_waitcnt vmcnt(8)
	ds_read_b64_tr_b16 a[144:145], v248 offset:4096
	ds_read_b64_tr_b16 a[146:147], v248 offset:5120
	ds_read_b64_tr_b16 a[148:149], v249 offset:4096
	buffer_load_dwordx4 v6, s[8:11], s57 offen lds
	ds_read_b64_tr_b16 a[150:151], v249 offset:5120
	ds_read_b64_tr_b16 a[152:153], v248 offset:6144
	ds_read_b64_tr_b16 a[154:155], v248 offset:7168
	ds_read_b64_tr_b16 a[156:157], v249 offset:6144
	ds_read_b64_tr_b16 a[158:159], v249 offset:7168
	v_mfma_f32_32x32x16_bf16 v[112:127], v[164:167], a[24:27], v[112:127]
	v_cvt_pk_bf16_f32 v204, v235, v206
	v_and_b32 v203, 0xffff0000, v200
	v_and_b32 v207, 0xffff0000, v204
	v_sub_f32_e64 v202, v202, v203
	buffer_load_dwordx4 v7, s[8:11], s57 offen offset:1024 lds
	v_sub_f32 v206, v206, v207
	v_lshlrev_b32 v203, 16, v242
	v_lshlrev_b32_e64 v207, 16, v243
	v_cvt_pk_bf16_f32 v201, v203, v202
	v_cvt_pk_bf16_f32 v205, v207, v206
	v_mfma_f32_32x32x16_bf16 v[96:111], v[168:171], a[28:31], v[96:111]
	s_add_u32 s56, s43, 7
	s_and_b32 s56, s56, 7
	s_mul_i32 s57, s56, s51
	s_add_u32 m0, s54, 57344
	s_add_u32 s57, s57, s49
	ds_read_b64_tr_b16 v[152:153], v17 offset:16384
	ds_read_b64_tr_b16 v[154:155], v17 offset:16896
	ds_read_b64_tr_b16 v[156:157], v18 offset:16384
	ds_read_b64_tr_b16 v[158:159], v18 offset:16896
	v_mov_b32 v202, 0
	v_mov_b32 v206, 0
	buffer_load_dwordx4 v6, s[8:11], s57 offen lds
	v_mov_b32 v203, 0
	v_mov_b32 v207, 0
	v_mfma_f32_32x32x16_bf16 v[112:127], v[172:175], a[28:31], v[112:127]
	v_mfma_f32_32x32x16_bf16 v[64:79], v[200:203], v[224:227], v[64:79]
	v_mfma_f32_32x32x16_bf16 v[80:95], v[204:207], v[224:227], v[80:95]
	buffer_load_dwordx4 v7, s[8:11], s57 offen offset:1024 lds
	v_mul_f32_e64 v32, v32, abs(v32)
	v_mul_f32_e64 v33, v33, abs(v33)
	v_mul_f32_e64 v34, v34, abs(v34)
	s_waitcnt lgkmcnt(12)
	s_nop 0
	v_mfma_f32_32x32x16_bf16 v[96:111], v[144:147], a[32:35], v[96:111]
	s_add_u32 m0, s52, 12288
	s_add_u32 s58, s70, 98304
	ds_read_b64_tr_b16 v[160:161], v19 offset:16384
	ds_read_b64_tr_b16 v[162:163], v19 offset:16896
	ds_read_b64_tr_b16 v[164:165], v20 offset:16384
	ds_read_b64_tr_b16 v[166:167], v20 offset:16896
	v_mul_f32_e64 v35, v35, abs(v35)
	v_cvt_pk_bf16_f32 v216, v32, v33
	v_mfma_f32_16x16x32_bf16 v[180:183], v[176:179], v[144:147], v[180:183]
	buffer_load_dwordx4 v10, s[12:15], s58 offen offset:0 lds
	v_cvt_pk_bf16_f32 v217, v34, v35
	v_pk_max_i16 v216, v216, 0
	v_mfma_f32_32x32x16_bf16 v[112:127], v[148:151], a[32:35], v[112:127]
	v_pk_max_i16 v217, v217, 0
	v_mul_f32_e64 v36, v36, abs(v36)
	v_mfma_f32_16x16x32_bf16 v[184:187], v[176:179], v[148:151], v[184:187]
	buffer_load_dwordx4 v11, s[12:15], s58 offen offset:1024 lds
	v_mul_f32_e64 v37, v37, abs(v37)
	v_mul_f32_e64 v38, v38, abs(v38)
	v_mul_f32_e64 v39, v39, abs(v39)
	s_waitcnt lgkmcnt(4)
	s_nop 0
	v_mfma_f32_32x32x16_bf16 v[96:111], v[152:155], a[36:39], v[96:111]
	ds_read_b64_tr_b16 v[168:169], v21 offset:16384
	ds_read_b64_tr_b16 v[170:171], v21 offset:16896
	ds_read_b64_tr_b16 v[172:173], v22 offset:16384
	ds_read_b64_tr_b16 v[174:175], v22 offset:16896
	v_cvt_pk_bf16_f32 v218, v36, v37
	v_cvt_pk_bf16_f32 v219, v38, v39
	buffer_load_dwordx4 v12, s[12:15], s58 offen offset:2048 lds
	v_pk_max_i16 v218, v218, 0
	v_pk_max_i16 v219, v219, 0
	v_mfma_f32_32x32x16_bf16 v[112:127], v[156:159], a[36:39], v[112:127]
	v_and_or_b32 v216, v251, s66, v216
	v_and_or_b32 v217, v252, s66, v217
	buffer_store_dwordx4 v[216:219], v1, s[20:23], s76 offen offset:0 sc1
	v_mul_f32_e64 v40, v40, abs(v40)
	v_mul_f32_e64 v41, v41, abs(v41)
	s_waitcnt lgkmcnt(4)
	v_mfma_f32_32x32x16_bf16 v[96:111], v[160:163], a[40:43], v[96:111]
	ds_read_b64_tr_b16 v[144:145], v15 offset:24576
	ds_read_b64_tr_b16 v[146:147], v15 offset:25088
	ds_read_b64_tr_b16 v[148:149], v16 offset:24576
	ds_read_b64_tr_b16 v[150:151], v16 offset:25088
	s_waitcnt vmcnt(8)
	ds_read_b64_tr_b16 a[160:161], v248 offset:8192
	ds_read_b64_tr_b16 a[162:163], v248 offset:9216
	ds_read_b64_tr_b16 a[164:165], v249 offset:8192
	buffer_load_dwordx4 v13, s[12:15], s58 offen offset:3072 lds
	ds_read_b64_tr_b16 a[166:167], v249 offset:9216
	ds_read_b64_tr_b16 a[168:169], v248 offset:10240
	ds_read_b64_tr_b16 a[170:171], v248 offset:11264
	ds_read_b64_tr_b16 a[172:173], v249 offset:10240
	ds_read_b64_tr_b16 a[174:175], v249 offset:11264
	v_mfma_f32_32x32x16_bf16 v[112:127], v[164:167], a[40:43], v[112:127]
	s_add_u32 m0, s52, L_end-L_exit-4+0
	s_add_u32 s58, s70, 262144
	v_mul_f32_e64 v42, v42, abs(v42)
	v_mul_f32_e64 v43, v43, abs(v43)
	v_cvt_pk_bf16_f32 v220, v40, v41
	v_cvt_pk_bf16_f32 v221, v42, v43
	buffer_load_dwordx4 v10, s[12:15], s58 offen offset:0 lds
	v_pk_max_i16 v220, v220, 0
	v_pk_max_i16 v221, v221, 0
	v_mul_f32_e64 v44, v44, abs(v44)
	v_mul_f32_e64 v45, v45, abs(v45)
	v_mul_f32_e64 v46, v46, abs(v46)
	s_waitcnt lgkmcnt(12)
	s_nop 0
	v_mfma_f32_32x32x16_bf16 v[96:111], v[168:171], a[44:47], v[96:111]
	ds_read_b64_tr_b16 v[152:153], v17 offset:24576
	ds_read_b64_tr_b16 v[154:155], v17 offset:25088
	ds_read_b64_tr_b16 v[156:157], v18 offset:24576
	ds_read_b64_tr_b16 v[158:159], v18 offset:25088
	v_mul_f32_e64 v47, v47, abs(v47)
	v_cvt_pk_bf16_f32 v222, v44, v45
	buffer_load_dwordx4 v11, s[12:15], s58 offen offset:1024 lds
	v_cvt_pk_bf16_f32 v223, v46, v47
	v_pk_max_i16 v222, v222, 0
	v_mfma_f32_32x32x16_bf16 v[112:127], v[172:175], a[44:47], v[112:127]
	v_pk_max_i16 v223, v223, 0
	v_and_or_b32 v220, v251, s66, v220
	v_and_or_b32 v221, v252, s66, v221
	buffer_store_dwordx4 v[220:223], v1, s[20:23], s76 offen offset:1024 sc1
	v_mul_f32_e64 v48, v48, abs(v48)
	s_waitcnt lgkmcnt(12)
	s_nop 0
	v_mfma_f32_32x32x16_bf16 v[96:111], v[144:147], a[48:51], v[96:111]
	ds_read_b64_tr_b16 v[160:161], v19 offset:24576
	ds_read_b64_tr_b16 v[162:163], v19 offset:25088
	ds_read_b64_tr_b16 v[164:165], v20 offset:24576
	ds_read_b64_tr_b16 v[166:167], v20 offset:25088
	v_mul_f32_e64 v49, v49, abs(v49)
	v_mul_f32_e64 v50, v50, abs(v50)
	v_mfma_f32_16x16x32_bf16 v[180:183], v[176:179], v[144:147], v[180:183]
	buffer_load_dwordx4 v12, s[12:15], s58 offen offset:2048 lds
	v_mul_f32_e64 v51, v51, abs(v51)
	v_cvt_pk_bf16_f32 v208, v48, v49
	v_mfma_f32_32x32x16_bf16 v[112:127], v[148:151], a[48:51], v[112:127]
	v_cvt_pk_bf16_f32 v209, v50, v51
	v_pk_max_i16 v208, v208, 0
	v_mfma_f32_16x16x32_bf16 v[184:187], v[176:179], v[148:151], v[184:187]
	buffer_load_dwordx4 v13, s[12:15], s58 offen offset:3072 lds
	v_pk_max_i16 v209, v209, 0
	v_mul_f32_e64 v52, v52, abs(v52)
	v_mul_f32_e64 v53, v53, abs(v53)
	s_waitcnt lgkmcnt(4)
	s_nop 0
	v_mfma_f32_32x32x16_bf16 v[96:111], v[152:155], a[52:55], v[96:111]
	s_add_u32 m0, s52, 4096
	s_add_u32 s58, s70, 294912
	ds_read_b64_tr_b16 v[168:169], v21 offset:24576
	ds_read_b64_tr_b16 v[170:171], v21 offset:25088
	ds_read_b64_tr_b16 v[172:173], v22 offset:24576
	ds_read_b64_tr_b16 v[174:175], v22 offset:25088
	v_mul_f32_e64 v54, v54, abs(v54)
	v_mul_f32_e64 v55, v55, abs(v55)
	buffer_load_dwordx4 v10, s[12:15], s58 offen offset:0 lds
	v_cvt_pk_bf16_f32 v210, v52, v53
	v_cvt_pk_bf16_f32 v211, v54, v55
	v_mfma_f32_32x32x16_bf16 v[112:127], v[156:159], a[52:55], v[112:127]
	v_pk_max_i16 v210, v210, 0
	v_pk_max_i16 v211, v211, 0
	v_and_or_b32 v208, v251, s66, v208
	v_and_or_b32 v209, v252, s66, v209
	buffer_store_dwordx4 v[208:211], v1, s[20:23], s76 offen offset:2048 sc1
	s_waitcnt lgkmcnt(4)
	s_nop 0
	v_mfma_f32_32x32x16_bf16 v[96:111], v[160:163], a[56:59], v[96:111]
	s_waitcnt lgkmcnt(0)
	s_barrier
	ds_read_b64_tr_b16 v[144:145], v15 offset:32768
	ds_read_b64_tr_b16 v[146:147], v15 offset:33280
	ds_read_b64_tr_b16 v[148:149], v16 offset:32768
	ds_read_b64_tr_b16 v[150:151], v16 offset:33280
	v_mul_f32_e64 v56, v56, abs(v56)
	v_mul_f32_e64 v57, v57, abs(v57)
	buffer_load_dwordx4 v11, s[12:15], s58 offen offset:1024 lds
	v_mul_f32_e64 v58, v58, abs(v58)
	v_mul_f32_e64 v59, v59, abs(v59)
	v_mfma_f32_32x32x16_bf16 v[112:127], v[164:167], a[56:59], v[112:127]
	v_cvt_pk_bf16_f32 v212, v56, v57
	v_cvt_pk_bf16_f32 v213, v58, v59
	buffer_load_dwordx4 v12, s[12:15], s58 offen offset:2048 lds
	v_pk_max_i16 v212, v212, 0
	v_pk_max_i16 v213, v213, 0
	v_mul_f32_e64 v60, v60, abs(v60)
	v_mfma_f32_32x32x16_bf16 v[96:111], v[168:171], a[60:63], v[96:111]
	ds_read_b64_tr_b16 v[152:153], v17 offset:32768
	ds_read_b64_tr_b16 v[154:155], v17 offset:33280
	ds_read_b64_tr_b16 v[156:157], v18 offset:32768
	ds_read_b64_tr_b16 v[158:159], v18 offset:33280
	s_waitcnt vmcnt(9)
	s_nop 0
	ds_read_b64_tr_b16 a[176:177], v248 offset:12288
	ds_read_b64_tr_b16 a[178:179], v248 offset:13312
	ds_read_b64_tr_b16 a[180:181], v249 offset:12288
	buffer_load_dwordx4 v13, s[12:15], s58 offen offset:3072 lds
	ds_read_b64_tr_b16 a[182:183], v249 offset:13312
	ds_read_b64_tr_b16 a[184:185], v248 offset:14336
	ds_read_b64_tr_b16 a[186:187], v248 offset:15360
	ds_read_b64_tr_b16 a[188:189], v249 offset:14336
	ds_read_b64_tr_b16 a[190:191], v249 offset:15360
	v_mfma_f32_32x32x16_bf16 v[112:127], v[172:175], a[60:63], v[112:127]
	s_add_u32 s56, s43, L_end-L_exit-4+0
	s_and_b32 s56, s56, 7
	s_mul_i32 s57, s56, s51
	s_add_u32 m0, s55, 0
	s_add_u32 s57, s57, s50
	v_mul_f32_e64 v61, v61, abs(v61)
	v_mul_f32_e64 v62, v62, abs(v62)
	v_mul_f32_e64 v63, v63, abs(v63)
	v_cvt_pk_bf16_f32 v214, v60, v61
	buffer_load_dwordx4 v14, s[8:11], s57 offen lds
	v_cvt_pk_bf16_f32 v215, v62, v63
	v_pk_max_i16 v214, v214, 0
	v_pk_max_i16 v215, v215, 0
	v_and_or_b32 v212, v251, s66, v212
	v_and_or_b32 v213, v252, s66, v213
	s_waitcnt lgkmcnt(12)
	s_nop 0
	v_mfma_f32_32x32x16_bf16 v[96:111], v[144:147], a[64:67], v[96:111]
	ds_read_b64_tr_b16 v[160:161], v19 offset:32768
	ds_read_b64_tr_b16 v[162:163], v19 offset:33280
	ds_read_b64_tr_b16 v[164:165], v20 offset:32768
	ds_read_b64_tr_b16 v[166:167], v20 offset:33280
	buffer_store_dwordx4 v[212:215], v1, s[20:23], s76 offen offset:3072 sc1
	v_mul_f32_e64 v64, v64, abs(v64)
	v_mul_f32_e64 v65, v65, abs(v65)
	v_mul_f32_e64 v66, v66, abs(v66)
	v_mfma_f32_16x16x32_bf16 v[180:183], v[176:179], v[144:147], v[180:183]
	v_mfma_f32_32x32x16_bf16 v[112:127], v[148:151], a[64:67], v[112:127]
	s_add_u32 s56, s43, 1
	s_and_b32 s56, s56, 7
	s_mul_i32 s57, s56, s51
	s_add_u32 m0, s55, 4096
	s_add_u32 s57, s57, s50
	v_mul_f32_e64 v67, v67, abs(v67)
	v_cvt_pk_bf16_f32 v216, v64, v65
	v_mfma_f32_16x16x32_bf16 v[184:187], v[176:179], v[148:151], v[184:187]
	buffer_load_dwordx4 v14, s[8:11], s57 offen lds
	v_cvt_pk_bf16_f32 v217, v66, v67
	v_pk_max_i16 v216, v216, 0
	v_pk_max_i16 v217, v217, 0
	s_waitcnt lgkmcnt(12)
	v_mfma_f32_32x32x16_bf16 v[96:111], v[152:155], a[68:71], v[96:111]
	s_add_u32 s56, s43, 2
	s_and_b32 s56, s56, 7
	s_mul_i32 s57, s56, s51
	s_add_u32 m0, s55, 8192
	s_add_u32 s57, s57, s50
	ds_read_b64_tr_b16 v[168:169], v21 offset:32768
	ds_read_b64_tr_b16 v[170:171], v21 offset:33280
	ds_read_b64_tr_b16 v[172:173], v22 offset:32768
	ds_read_b64_tr_b16 v[174:175], v22 offset:33280
	s_waitcnt vmcnt(8)
	ds_read_b64_tr_b16 a[192:193], v248 offset:0
	ds_read_b64_tr_b16 a[194:195], v248 offset:1024
	ds_read_b64_tr_b16 a[196:197], v249 offset:0
	buffer_load_dwordx4 v14, s[8:11], s57 offen lds
	ds_read_b64_tr_b16 a[198:199], v249 offset:1024
	ds_read_b64_tr_b16 a[200:201], v248 offset:2048
	ds_read_b64_tr_b16 a[202:203], v248 offset:3072
	ds_read_b64_tr_b16 a[204:205], v249 offset:2048
	ds_read_b64_tr_b16 a[206:207], v249 offset:3072
	v_mfma_f32_32x32x16_bf16 v[112:127], v[156:159], a[68:71], v[112:127]
	s_add_u32 s56, s43, 3
	s_and_b32 s56, s56, 7
	s_mul_i32 s57, s56, s51
	s_add_u32 m0, s55, 12288
	s_add_u32 s57, s57, s50
	v_mul_f32_e64 v68, v68, abs(v68)
	v_mul_f32_e64 v69, v69, abs(v69)
	v_mul_f32_e64 v70, v70, abs(v70)
	v_mul_f32_e64 v71, v71, abs(v71)
	buffer_load_dwordx4 v14, s[8:11], s57 offen lds
	v_cvt_pk_bf16_f32 v218, v68, v69
	v_cvt_pk_bf16_f32 v219, v70, v71
	v_pk_max_i16 v218, v218, 0
	v_pk_max_i16 v219, v219, 0
	v_and_or_b32 v216, v251, s66, v216
	s_waitcnt lgkmcnt(12)
	s_nop 0
	v_mfma_f32_32x32x16_bf16 v[96:111], v[160:163], a[72:75], v[96:111]
	ds_read_b64_tr_b16 v[144:145], v15 offset:40960
	ds_read_b64_tr_b16 v[146:147], v15 offset:41472
	ds_read_b64_tr_b16 v[148:149], v16 offset:40960
	ds_read_b64_tr_b16 v[150:151], v16 offset:41472
	v_and_or_b32 v217, v252, s66, v217
	buffer_store_dwordx4 v[216:219], v1, s[20:23], s77 offen offset:0 sc1
	v_mul_f32_e64 v72, v72, abs(v72)
	v_mul_f32_e64 v73, v73, abs(v73)
	v_mfma_f32_32x32x16_bf16 v[112:127], v[164:167], a[72:75], v[112:127]
	s_add_u32 m0, s52, 8192
	s_add_u32 s58, s70, 327680
	v_mul_f32_e64 v74, v74, abs(v74)
	v_mul_f32_e64 v75, v75, abs(v75)
	buffer_load_dwordx4 v10, s[12:15], s58 offen offset:0 lds
	v_cvt_pk_bf16_f32 v220, v72, v73
	v_cvt_pk_bf16_f32 v221, v74, v75
	v_pk_max_i16 v220, v220, 0
	s_waitcnt lgkmcnt(12)
	s_nop 0
	v_mfma_f32_32x32x16_bf16 v[96:111], v[168:171], a[76:79], v[96:111]
	ds_read_b64_tr_b16 v[152:153], v17 offset:40960
	ds_read_b64_tr_b16 v[154:155], v17 offset:41472
	ds_read_b64_tr_b16 v[156:157], v18 offset:40960
	ds_read_b64_tr_b16 v[158:159], v18 offset:41472
	v_pk_max_i16 v221, v221, 0
	v_mul_f32_e64 v76, v76, abs(v76)
	buffer_load_dwordx4 v11, s[12:15], s58 offen offset:1024 lds
	v_mul_f32_e64 v77, v77, abs(v77)
	v_mul_f32_e64 v78, v78, abs(v78)
	v_mfma_f32_32x32x16_bf16 v[112:127], v[172:175], a[76:79], v[112:127]
	v_mul_f32_e64 v79, v79, abs(v79)
	v_cvt_pk_bf16_f32 v222, v76, v77
	buffer_load_dwordx4 v12, s[12:15], s58 offen offset:2048 lds
	v_cvt_pk_bf16_f32 v223, v78, v79
	v_pk_max_i16 v222, v222, 0
	v_pk_max_i16 v223, v223, 0
	s_waitcnt lgkmcnt(4)
	v_mfma_f32_32x32x16_bf16 v[96:111], v[144:147], a[80:83], v[96:111]
	ds_read_b64_tr_b16 v[160:161], v19 offset:40960
	ds_read_b64_tr_b16 v[162:163], v19 offset:41472
	ds_read_b64_tr_b16 v[164:165], v20 offset:40960
	ds_read_b64_tr_b16 v[166:167], v20 offset:41472
	s_waitcnt vmcnt(9)
	ds_read_b64_tr_b16 a[208:209], v248 offset:4096
	ds_read_b64_tr_b16 a[210:211], v248 offset:5120
	ds_read_b64_tr_b16 a[212:213], v249 offset:4096
	v_mfma_f32_16x16x32_bf16 v[180:183], v[176:179], v[144:147], v[180:183]
	buffer_load_dwordx4 v13, s[12:15], s58 offen offset:3072 lds
	ds_read_b64_tr_b16 a[214:215], v249 offset:5120
	ds_read_b64_tr_b16 a[216:217], v248 offset:6144
	ds_read_b64_tr_b16 a[218:219], v248 offset:7168
	ds_read_b64_tr_b16 a[220:221], v249 offset:6144
	ds_read_b64_tr_b16 a[222:223], v249 offset:7168
	v_mfma_f32_32x32x16_bf16 v[112:127], v[148:151], a[80:83], v[112:127]
	v_and_or_b32 v220, v251, s66, v220
	v_and_or_b32 v221, v252, s66, v221
	buffer_store_dwordx4 v[220:223], v1, s[20:23], s77 offen offset:1024 sc1
	v_mul_f32_e64 v80, v80, abs(v80)
	v_mul_f32_e64 v81, v81, abs(v81)
	v_mul_f32_e64 v82, v82, abs(v82)
	v_mul_f32_e64 v83, v83, abs(v83)
	v_cvt_pk_bf16_f32 v208, v80, v81
	v_cvt_pk_bf16_f32 v209, v82, v83
	v_mfma_f32_16x16x32_bf16 v[184:187], v[176:179], v[148:151], v[184:187]
	s_waitcnt lgkmcnt(12)
	s_nop 0
	v_mfma_f32_32x32x16_bf16 v[96:111], v[152:155], a[84:87], v[96:111]
	s_add_u32 m0, s52, 12288
	s_add_u32 s58, s70, 360448
	ds_read_b64_tr_b16 v[168:169], v21 offset:40960
	ds_read_b64_tr_b16 v[170:171], v21 offset:41472
	ds_read_b64_tr_b16 v[172:173], v22 offset:40960
	ds_read_b64_tr_b16 v[174:175], v22 offset:41472
	v_pk_max_i16 v208, v208, 0
	v_pk_max_i16 v209, v209, 0
	buffer_load_dwordx4 v10, s[12:15], s58 offen offset:0 lds
	v_mul_f32_e64 v84, v84, abs(v84)
	v_mul_f32_e64 v85, v85, abs(v85)
	v_mfma_f32_32x32x16_bf16 v[112:127], v[156:159], a[84:87], v[112:127]
	v_mul_f32_e64 v86, v86, abs(v86)
	v_mul_f32_e64 v87, v87, abs(v87)
	buffer_load_dwordx4 v11, s[12:15], s58 offen offset:1024 lds
	v_cvt_pk_bf16_f32 v210, v84, v85
	v_cvt_pk_bf16_f32 v211, v86, v87
	v_pk_max_i16 v210, v210, 0
	s_waitcnt lgkmcnt(12)
	s_nop 0
	v_mfma_f32_32x32x16_bf16 v[96:111], v[160:163], a[88:91], v[96:111]
	s_waitcnt lgkmcnt(0)
	s_barrier
	ds_read_b64_tr_b16 v[144:145], v15 offset:49152
	ds_read_b64_tr_b16 v[146:147], v15 offset:49664
	ds_read_b64_tr_b16 v[148:149], v16 offset:49152
	ds_read_b64_tr_b16 v[150:151], v16 offset:49664
	v_pk_max_i16 v211, v211, 0
	v_and_or_b32 v208, v251, s66, v208
	v_and_or_b32 v209, v252, s66, v209
	buffer_store_dwordx4 v[208:211], v1, s[20:23], s77 offen offset:2048 sc1
	v_mfma_f32_32x32x16_bf16 v[112:127], v[164:167], a[88:91], v[112:127]
	v_mul_f32_e64 v88, v88, abs(v88)
	v_mul_f32_e64 v89, v89, abs(v89)
	buffer_load_dwordx4 v12, s[12:15], s58 offen offset:2048 lds
	v_mul_f32_e64 v90, v90, abs(v90)
	v_mul_f32_e64 v91, v91, abs(v91)
	v_cvt_pk_bf16_f32 v212, v88, v89
	v_mfma_f32_32x32x16_bf16 v[96:111], v[168:171], a[92:95], v[96:111]
	ds_read_b64_tr_b16 v[152:153], v17 offset:49152
	ds_read_b64_tr_b16 v[154:155], v17 offset:49664
	ds_read_b64_tr_b16 v[156:157], v18 offset:49152
	ds_read_b64_tr_b16 v[158:159], v18 offset:49664
	v_cvt_pk_bf16_f32 v213, v90, v91
	v_pk_max_i16 v212, v212, 0
	buffer_load_dwordx4 v13, s[12:15], s58 offen offset:3072 lds
	v_pk_max_i16 v213, v213, 0
	v_mul_f32_e64 v92, v92, abs(v92)
	v_mfma_f32_32x32x16_bf16 v[112:127], v[172:175], a[92:95], v[112:127]
	s_add_u32 m0, s52, L_end-L_exit-4+0
	s_add_u32 s58, s70, 131072
	v_mul_f32_e64 v93, v93, abs(v93)
	v_mul_f32_e64 v94, v94, abs(v94)
	buffer_load_dwordx4 v10, s[12:15], s58 offen offset:0 lds
	v_mul_f32_e64 v95, v95, abs(v95)
	v_cvt_pk_bf16_f32 v214, v92, v93
	v_cvt_pk_bf16_f32 v215, v94, v95
	s_waitcnt lgkmcnt(4)
	s_nop 0
	v_mfma_f32_32x32x16_bf16 v[96:111], v[144:147], a[96:99], v[96:111]
	ds_read_b64_tr_b16 v[160:161], v19 offset:49152
	ds_read_b64_tr_b16 v[162:163], v19 offset:49664
	ds_read_b64_tr_b16 v[164:165], v20 offset:49152
	ds_read_b64_tr_b16 v[166:167], v20 offset:49664
	v_pk_max_i16 v214, v214, 0
	v_mfma_f32_16x16x32_bf16 v[180:183], v[176:179], v[144:147], v[180:183]
	buffer_load_dwordx4 v11, s[12:15], s58 offen offset:1024 lds
	v_pk_max_i16 v215, v215, 0
	v_mfma_f32_32x32x16_bf16 v[112:127], v[148:151], a[96:99], v[112:127]
	v_and_or_b32 v212, v251, s66, v212
	v_and_or_b32 v213, v252, s66, v213
	buffer_store_dwordx4 v[212:215], v1, s[20:23], s77 offen offset:3072 sc1
	v_mfma_f32_16x16x32_bf16 v[184:187], v[176:179], v[148:151], v[184:187]
	s_waitcnt lgkmcnt(4)
	v_mfma_f32_32x32x16_bf16 v[96:111], v[152:155], a[100:103], v[96:111]
	ds_read_b64_tr_b16 v[168:169], v21 offset:49152
	ds_read_b64_tr_b16 v[170:171], v21 offset:49664
	ds_read_b64_tr_b16 v[172:173], v22 offset:49152
	ds_read_b64_tr_b16 v[174:175], v22 offset:49664
	s_waitcnt vmcnt(9)
	ds_read_b64_tr_b16 a[224:225], v248 offset:8192
	buffer_load_dwordx4 v12, s[12:15], s58 offen offset:2048 lds
	ds_read_b64_tr_b16 a[226:227], v248 offset:9216
	ds_read_b64_tr_b16 a[228:229], v249 offset:8192
	ds_read_b64_tr_b16 a[230:231], v249 offset:9216
	v_mfma_f32_32x32x16_bf16 v[112:127], v[156:159], a[100:103], v[112:127]
	ds_read_b64_tr_b16 a[232:233], v248 offset:10240
	ds_read_b64_tr_b16 a[234:235], v248 offset:11264
	buffer_load_dwordx4 v13, s[12:15], s58 offen offset:3072 lds
	ds_read_b64_tr_b16 a[236:237], v249 offset:10240
	ds_read_b64_tr_b16 a[238:239], v249 offset:11264
	s_waitcnt lgkmcnt(12)
	v_mfma_f32_32x32x16_bf16 v[96:111], v[160:163], a[104:107], v[96:111]
	s_add_u32 s56, s43, 4
	s_and_b32 s56, s56, L_end-L_exit-4+7
	s_mul_i32 s57, s56, s51
	s_add_u32 m0, s55, 16384
	s_add_u32 s57, s57, s50
	ds_read_b64_tr_b16 v[144:145], v15 offset:57344
	ds_read_b64_tr_b16 v[146:147], v15 offset:57856
	ds_read_b64_tr_b16 v[148:149], v16 offset:57344
	ds_read_b64_tr_b16 v[150:151], v16 offset:57856
	buffer_load_dwordx4 v14, s[8:11], s57 offen lds
	v_mfma_f32_32x32x16_bf16 v[112:127], v[164:167], a[104:107], v[112:127]
	s_add_u32 s56, s43, L_end-L_exit-4+5
	s_and_b32 s56, s56, 7
	s_mul_i32 s57, s56, s51
	s_add_u32 m0, s55, 20480
	s_add_u32 s57, s57, s50
	buffer_load_dwordx4 v14, s[8:11], s57 offen lds
	s_waitcnt lgkmcnt(12)
	v_mfma_f32_32x32x16_bf16 v[96:111], v[168:171], a[108:111], v[96:111]
	s_add_u32 s56, s43, 6
	s_and_b32 s56, s56, 7
	s_mul_i32 s57, s56, s51
	s_add_u32 m0, s55, 24576
	s_add_u32 s57, s57, s50
	ds_read_b64_tr_b16 v[152:153], v17 offset:57344
	ds_read_b64_tr_b16 v[154:155], v17 offset:57856
	ds_read_b64_tr_b16 v[156:157], v18 offset:57344
	ds_read_b64_tr_b16 v[158:159], v18 offset:57856
	buffer_load_dwordx4 v14, s[8:11], s57 offen lds
	v_mfma_f32_32x32x16_bf16 v[112:127], v[172:175], a[108:111], v[112:127]
	s_add_u32 s56, s43, L_end-L_exit-4+7
	s_and_b32 s56, s56, 7
	s_mul_i32 s57, s56, s51
	s_add_u32 m0, s55, 28672
	s_add_u32 s57, s57, s50
	buffer_load_dwordx4 v14, s[8:11], s57 offen lds
	s_waitcnt lgkmcnt(4)
	v_mfma_f32_32x32x16_bf16 v[96:111], v[144:147], a[112:115], v[96:111]
	s_add_u32 m0, s52, 4096
	s_add_u32 s58, s70, 163840
	ds_read_b64_tr_b16 v[160:161], v19 offset:57344
	ds_read_b64_tr_b16 v[162:163], v19 offset:57856
	ds_read_b64_tr_b16 v[164:165], v20 offset:57344
	ds_read_b64_tr_b16 v[166:167], v20 offset:57856
	s_waitcnt vmcnt(9)
	ds_read_b64_tr_b16 a[240:241], v248 offset:12288
	v_mfma_f32_16x16x32_bf16 v[180:183], v[176:179], v[144:147], v[180:183]
	buffer_load_dwordx4 v10, s[12:15], s58 offen offset:0 lds
	ds_read_b64_tr_b16 a[242:243], v248 offset:13312
	ds_read_b64_tr_b16 a[244:245], v249 offset:12288
	ds_read_b64_tr_b16 a[246:247], v249 offset:13312
	v_mfma_f32_32x32x16_bf16 v[112:127], v[148:151], a[112:115], v[112:127]
	ds_read_b64_tr_b16 a[248:249], v248 offset:14336
	ds_read_b64_tr_b16 a[250:251], v248 offset:15360
	v_mfma_f32_16x16x32_bf16 v[184:187], v[176:179], v[148:151], v[184:187]
	buffer_load_dwordx4 v11, s[12:15], s58 offen offset:1024 lds
	ds_read_b64_tr_b16 a[252:253], v249 offset:14336
	ds_read_b64_tr_b16 a[254:255], v249 offset:15360
	s_waitcnt lgkmcnt(12)
	v_mfma_f32_32x32x16_bf16 v[96:111], v[152:155], a[116:119], v[96:111]
	ds_read_b64_tr_b16 v[168:169], v21 offset:57344
	ds_read_b64_tr_b16 v[170:171], v21 offset:57856
	ds_read_b64_tr_b16 v[172:173], v22 offset:57344
	ds_read_b64_tr_b16 v[174:175], v22 offset:57856
	buffer_load_dwordx4 v12, s[12:15], s58 offen offset:2048 lds
	v_mfma_f32_32x32x16_bf16 v[112:127], v[156:159], a[116:119], v[112:127]
	buffer_load_dwordx4 v13, s[12:15], s58 offen offset:3072 lds
	s_lshl_b32 s3, s40, L_end-L_exit-4+10
	s_add_u32 s3, s3, 135168
	v_add_u32 v247, s3, v1
	v_mov_b32 v181, v184
	ds_write_b128 v247, v[180:183]
	s_waitcnt lgkmcnt(13)
	v_mfma_f32_32x32x16_bf16 v[96:111], v[160:163], a[120:123], v[96:111]
	s_waitcnt vmcnt(4)
	s_waitcnt lgkmcnt(0)
	s_barrier
	s_add_u32 m0, s52, 8192
	s_add_u32 s58, s70, 393216
	ds_read_b64_tr_b16 v[144:145], v27 offset:0
	ds_read_b64_tr_b16 v[146:147], v27 offset:256
	ds_read_b64_tr_b16 v[148:149], v28 offset:0
	ds_read_b64_tr_b16 v[150:151], v28 offset:256
	buffer_load_dwordx4 v10, s[12:15], s58 offen offset:0 lds
	v_mfma_f32_32x32x16_bf16 v[112:127], v[164:167], a[120:123], v[112:127]
	buffer_load_dwordx4 v11, s[12:15], s58 offen offset:1024 lds
	v_mfma_f32_32x32x16_bf16 v[96:111], v[168:171], a[124:127], v[96:111]
	ds_read_b64_tr_b16 v[152:153], v29 offset:0
	ds_read_b64_tr_b16 v[154:155], v29 offset:256
	ds_read_b64_tr_b16 v[156:157], v30 offset:0
	ds_read_b64_tr_b16 v[158:159], v30 offset:256
	buffer_load_dwordx4 v12, s[12:15], s58 offen offset:2048 lds
	v_mfma_f32_32x32x16_bf16 v[112:127], v[172:175], a[124:127], v[112:127]
	buffer_load_dwordx4 v13, s[12:15], s58 offen offset:3072 lds
	s_waitcnt lgkmcnt(4)
	s_nop 0
	v_mfma_f32_32x32x16_bf16 v[128:143], v[144:147], a[0:3], 0
	s_add_u32 m0, s52, 12288
	s_add_u32 s58, s70, 425984
	ds_read_b64_tr_b16 v[160:161], v27 offset:4096
	ds_read_b64_tr_b16 v[162:163], v27 offset:4352
	ds_read_b64_tr_b16 v[164:165], v28 offset:4096
	ds_read_b64_tr_b16 v[166:167], v28 offset:4352
	v_add_u32 v247, 135168, v1
	ds_read_b128 v[208:211], v247 offset:0
	ds_read_b128 v[212:215], v247 offset:1024
	buffer_load_dwordx4 v10, s[12:15], s58 offen offset:0 lds
	ds_read_b128 v[216:219], v247 offset:2048
	ds_read_b128 v[220:223], v247 offset:3072
	s_waitcnt lgkmcnt(2)
	v_add_f32 v208, v208, v212
	v_mfma_f32_32x32x16_bf16 v[128:143], v[148:151], a[4:7], v[128:143]
	s_waitcnt lgkmcnt(0)
	v_add_f32 v216, v216, v220
	v_add_f32 v209, v209, v213
	v_add_f32 v217, v217, v221
	v_mfma_f32_16x16x32_bf16 v[188:191], v[176:179], v[144:147], 0
	buffer_load_dwordx4 v11, s[12:15], s58 offen offset:1024 lds
	v_add_f32 v232, v208, v216
	v_add_f32 v233, v209, v217
	v_cvt_pk_bf16_f32 v194, v232, v232
	v_mfma_f32_32x32x16_bf16 v[128:143], v[152:155], a[8:11], v[128:143]
	ds_read_b64_tr_b16 v[168:169], v29 offset:4096
	ds_read_b64_tr_b16 v[170:171], v29 offset:4352
	ds_read_b64_tr_b16 v[172:173], v30 offset:4096
	ds_read_b64_tr_b16 v[174:175], v30 offset:4352
	v_cvt_pk_bf16_f32 v198, v233, v233
	v_lshlrev_b32 v194, 16, v194
	v_lshlrev_b32 v198, 16, v198
	buffer_load_dwordx4 v12, s[12:15], s58 offen offset:2048 lds
	v_sub_f32 v194, v232, v194
	v_sub_f32 v198, v233, v198
	v_cvt_pk_bf16_f32 v192, v232, v194
	v_mfma_f32_32x32x16_bf16 v[128:143], v[156:159], a[12:15], v[128:143]
	v_cvt_pk_bf16_f32 v196, v233, v198
	v_and_b32 v195, 0xffff0000, v192
	v_and_b32 v199, 0xffff0000, v196
	buffer_load_dwordx4 v13, s[12:15], s58 offen offset:3072 lds
	v_sub_f32 v194, v194, v195
	v_sub_f32 v198, v198, v199
	v_lshlrev_b32_e64 v195, 16, v244
	v_mfma_f32_32x32x16_bf16 v[128:143], v[160:163], a[16:19], v[128:143]
	s_add_u32 s100, s72, L_end-L_exit-4+0
	ds_read_b64_tr_b16 v[144:145], v27 offset:8192
	ds_read_b64_tr_b16 v[146:147], v27 offset:8448
	ds_read_b64_tr_b16 v[148:149], v28 offset:8192
	ds_read_b64_tr_b16 v[150:151], v28 offset:8448
	ds_read_b64_tr_b16 a[0:1], v248 offset:0
	ds_read_b64_tr_b16 a[2:3], v248 offset:1024
	ds_read_b64_tr_b16 a[4:5], v249 offset:0
	ds_read_b64_tr_b16 a[6:7], v249 offset:1024
	buffer_load_dwordx4 v[32:35], v1, s[20:23], s100 offen offset:0 sc1
	ds_read_b64_tr_b16 a[8:9], v248 offset:2048
	ds_read_b64_tr_b16 a[10:11], v248 offset:3072
	ds_read_b64_tr_b16 a[12:13], v249 offset:2048
	ds_read_b64_tr_b16 a[14:15], v249 offset:3072
	v_lshlrev_b32_e64 v199, 16, v245
	v_mfma_f32_32x32x16_bf16 v[128:143], v[164:167], a[20:23], v[128:143]
	v_cvt_pk_bf16_f32 v193, v195, v194
	v_cvt_pk_bf16_f32 v197, v199, v198
	v_mov_b32 v194, 0
	v_mov_b32 v198, 0
	v_mov_b32_e64 v195, 0
	v_mfma_f32_16x16x32_bf16 v[188:191], v[176:179], v[160:163], v[188:191]
	buffer_load_dwordx4 v[36:39], v250, s[20:23], s100 offen offset:0 sc1
	v_mov_b32 v199, 0
	v_mfma_f32_32x32x16_bf16 v[96:111], v[192:195], v[224:227], v[96:111]
	s_nop 0
	v_mfma_f32_32x32x16_bf16 v[112:127], v[196:199], v[224:227], v[112:127]
	s_nop 9
	v_mul_f32_e64 v96, v96, abs(v96)
	v_mul_f32_e64 v97, v97, abs(v97)
	v_mul_f32_e64 v98, v98, abs(v98)
	s_waitcnt lgkmcnt(12)
	v_mfma_f32_32x32x16_bf16 v[128:143], v[168:171], a[24:27], v[128:143]
	ds_read_b64_tr_b16 v[152:153], v29 offset:8192
	ds_read_b64_tr_b16 v[154:155], v29 offset:8448
	ds_read_b64_tr_b16 v[156:157], v30 offset:8192
	ds_read_b64_tr_b16 v[158:159], v30 offset:8448
	v_mul_f32_e64 v99, v99, abs(v99)
	v_cvt_pk_bf16_f32 v208, v96, v97
	v_cvt_pk_bf16_f32 v209, v98, v99
	buffer_load_dwordx4 v[40:43], v1, s[20:23], s100 offen offset:1024 sc1
	v_pk_max_i16 v208, v208, 0
	v_pk_max_i16 v209, v209, 0
	v_mul_f32_e64 v100, v100, abs(v100)
	v_mfma_f32_32x32x16_bf16 v[128:143], v[172:175], a[28:31], v[128:143]
	v_mul_f32_e64 v101, v101, abs(v101)
	v_mul_f32_e64 v102, v102, abs(v102)
	v_mul_f32_e64 v103, v103, abs(v103)
	buffer_load_dwordx4 v[44:47], v250, s[20:23], s100 offen offset:1024 sc1
	v_cvt_pk_bf16_f32 v210, v100, v101
	v_cvt_pk_bf16_f32 v211, v102, v103
	v_pk_max_i16 v210, v210, 0
	s_waitcnt lgkmcnt(12)
	v_mfma_f32_32x32x16_bf16 v[128:143], v[144:147], a[32:35], v[128:143]
	ds_read_b64_tr_b16 v[160:161], v27 offset:12288
	ds_read_b64_tr_b16 v[162:163], v27 offset:12544
	ds_read_b64_tr_b16 v[164:165], v28 offset:12288
	ds_read_b64_tr_b16 v[166:167], v28 offset:12544
	s_waitcnt vmcnt(12)
	ds_read_b64_tr_b16 a[16:17], v248 offset:4096
	ds_read_b64_tr_b16 a[18:19], v248 offset:5120
	ds_read_b64_tr_b16 a[20:21], v249 offset:4096
	ds_read_b64_tr_b16 a[22:23], v249 offset:5120
	buffer_load_dwordx4 v[48:51], v1, s[20:23], s100 offen offset:2048 sc1
	ds_read_b64_tr_b16 a[24:25], v248 offset:6144
	ds_read_b64_tr_b16 a[26:27], v248 offset:7168
	ds_read_b64_tr_b16 a[28:29], v249 offset:6144
	ds_read_b64_tr_b16 a[30:31], v249 offset:7168
	v_pk_max_i16 v211, v211, 0
	v_mfma_f32_32x32x16_bf16 v[128:143], v[148:151], a[36:39], v[128:143]
	v_and_or_b32 v208, v251, s66, v208
	v_and_or_b32 v209, v252, s66, v209
	buffer_store_dwordx4 v[208:211], v1, s[20:23], s78 offen offset:0 sc1
	v_mul_f32_e64 v104, v104, abs(v104)
	v_mul_f32_e64 v105, v105, abs(v105)
	v_mul_f32_e64 v106, v106, abs(v106)
	v_mul_f32_e64 v107, v107, abs(v107)
	v_cvt_pk_bf16_f32 v212, v104, v105
	v_cvt_pk_bf16_f32 v213, v106, v107
	v_pk_max_i16 v212, v212, 0
	v_pk_max_i16 v213, v213, 0
	v_mfma_f32_16x16x32_bf16 v[188:191], v[176:179], v[144:147], v[188:191]
	s_waitcnt lgkmcnt(12)
	s_nop 0
	v_mfma_f32_32x32x16_bf16 v[128:143], v[152:155], a[40:43], v[128:143]
	ds_read_b64_tr_b16 v[168:169], v29 offset:12288
	ds_read_b64_tr_b16 v[170:171], v29 offset:12544
	ds_read_b64_tr_b16 v[172:173], v30 offset:12288
	ds_read_b64_tr_b16 v[174:175], v30 offset:12544
	v_mul_f32_e64 v108, v108, abs(v108)
	v_mul_f32_e64 v109, v109, abs(v109)
	v_mul_f32_e64 v110, v110, abs(v110)
	buffer_load_dwordx4 v[52:55], v250, s[20:23], s100 offen offset:2048 sc1
	v_mul_f32_e64 v111, v111, abs(v111)
	v_cvt_pk_bf16_f32 v214, v108, v109
	v_cvt_pk_bf16_f32 v215, v110, v111
	v_mfma_f32_32x32x16_bf16 v[128:143], v[156:159], a[44:47], v[128:143]
	v_pk_max_i16 v214, v214, 0
	v_pk_max_i16 v215, v215, 0
	v_and_or_b32 v212, v251, s66, v212
	v_and_or_b32 v213, v252, s66, v213
	buffer_store_dwordx4 v[212:215], v1, s[20:23], s78 offen offset:1024 sc1
	v_mul_f32_e64 v112, v112, abs(v112)
	s_waitcnt lgkmcnt(12)
	v_mfma_f32_32x32x16_bf16 v[128:143], v[160:163], a[48:51], v[128:143]
	ds_read_b64_tr_b16 v[144:145], v27 offset:16384
	ds_read_b64_tr_b16 v[146:147], v27 offset:16640
	ds_read_b64_tr_b16 v[148:149], v28 offset:16384
	ds_read_b64_tr_b16 v[150:151], v28 offset:16640
	s_waitcnt vmcnt(12)
	ds_read_b64_tr_b16 a[32:33], v248 offset:8192
	ds_read_b64_tr_b16 a[34:35], v248 offset:9216
	ds_read_b64_tr_b16 a[36:37], v249 offset:8192
	ds_read_b64_tr_b16 a[38:39], v249 offset:9216
	buffer_load_dwordx4 v[56:59], v1, s[20:23], s100 offen offset:3072 sc1
	ds_read_b64_tr_b16 a[40:41], v248 offset:10240
	ds_read_b64_tr_b16 a[42:43], v248 offset:11264
	ds_read_b64_tr_b16 a[44:45], v249 offset:10240
	ds_read_b64_tr_b16 a[46:47], v249 offset:11264
	v_mul_f32_e64 v113, v113, abs(v113)
	v_mfma_f32_32x32x16_bf16 v[128:143], v[164:167], a[52:55], v[128:143]
	v_mul_f32_e64 v114, v114, abs(v114)
	v_mul_f32_e64 v115, v115, abs(v115)
	v_cvt_pk_bf16_f32 v216, v112, v113
	v_cvt_pk_bf16_f32 v217, v114, v115
	v_pk_max_i16 v216, v216, 0
	v_mfma_f32_16x16x32_bf16 v[188:191], v[176:179], v[160:163], v[188:191]
	buffer_load_dwordx4 v[60:63], v250, s[20:23], s100 offen offset:3072 sc1
	v_pk_max_i16 v217, v217, 0
	v_mul_f32_e64 v116, v116, abs(v116)
	v_mul_f32_e64 v117, v117, abs(v117)
	v_mul_f32_e64 v118, v118, abs(v118)
	v_mul_f32_e64 v119, v119, abs(v119)
	v_cvt_pk_bf16_f32 v218, v116, v117
	s_waitcnt lgkmcnt(12)
	s_nop 0
	v_mfma_f32_32x32x16_bf16 v[128:143], v[168:171], a[56:59], v[128:143]
	ds_read_b64_tr_b16 v[152:153], v29 offset:16384
	ds_read_b64_tr_b16 v[154:155], v29 offset:16640
	ds_read_b64_tr_b16 v[156:157], v30 offset:16384
	ds_read_b64_tr_b16 v[158:159], v30 offset:16640
	v_cvt_pk_bf16_f32 v219, v118, v119
	v_pk_max_i16 v218, v218, 0
	v_pk_max_i16 v219, v219, 0
	v_and_or_b32 v216, v251, s66, v216
	v_and_or_b32 v217, v252, s66, v217
	buffer_store_dwordx4 v[216:219], v1, s[20:23], s78 offen offset:2048 sc1
	v_mfma_f32_32x32x16_bf16 v[128:143], v[172:175], a[60:63], v[128:143]
	s_add_u32 s100, s72, 4096
	v_mul_f32_e64 v120, v120, abs(v120)
	v_mul_f32_e64 v121, v121, abs(v121)
	v_mul_f32_e64 v122, v122, abs(v122)
	buffer_load_dwordx4 v[64:67], v1, s[20:23], s100 offen offset:0 sc1
	v_mul_f32_e64 v123, v123, abs(v123)
	v_cvt_pk_bf16_f32 v220, v120, v121
	v_cvt_pk_bf16_f32 v221, v122, v123
	s_waitcnt lgkmcnt(12)
	v_mfma_f32_32x32x16_bf16 v[128:143], v[144:147], a[64:67], v[128:143]
	ds_read_b64_tr_b16 v[160:161], v27 offset:20480
	ds_read_b64_tr_b16 v[162:163], v27 offset:20736
	ds_read_b64_tr_b16 v[164:165], v28 offset:20480
	ds_read_b64_tr_b16 v[166:167], v28 offset:20736
	s_waitcnt vmcnt(12)
	ds_read_b64_tr_b16 a[48:49], v248 offset:12288
	ds_read_b64_tr_b16 a[50:51], v248 offset:13312
	ds_read_b64_tr_b16 a[52:53], v249 offset:12288
	ds_read_b64_tr_b16 a[54:55], v249 offset:13312
	buffer_load_dwordx4 v[68:71], v250, s[20:23], s100 offen offset:0 sc1
	ds_read_b64_tr_b16 a[56:57], v248 offset:14336
	ds_read_b64_tr_b16 a[58:59], v248 offset:15360
	ds_read_b64_tr_b16 a[60:61], v249 offset:14336
	ds_read_b64_tr_b16 a[62:63], v249 offset:15360
	v_pk_max_i16 v220, v220, 0
	v_mfma_f32_32x32x16_bf16 v[128:143], v[148:151], a[68:71], v[128:143]
	v_pk_max_i16 v221, v221, 0
	v_mul_f32_e64 v124, v124, abs(v124)
	v_mul_f32_e64 v125, v125, abs(v125)
	v_mul_f32_e64 v126, v126, abs(v126)
	v_mul_f32_e64 v127, v127, abs(v127)
	v_mfma_f32_16x16x32_bf16 v[188:191], v[176:179], v[144:147], v[188:191]
	buffer_load_dwordx4 v[72:75], v1, s[20:23], s100 offen offset:1024 sc1
	v_cvt_pk_bf16_f32 v222, v124, v125
	v_cvt_pk_bf16_f32 v223, v126, v127
	v_pk_max_i16 v222, v222, 0
	v_pk_max_i16 v223, v223, 0
	v_and_or_b32 v220, v251, s66, v220
	v_and_or_b32 v221, v252, s66, v221
	s_waitcnt lgkmcnt(12)
	v_mfma_f32_32x32x16_bf16 v[128:143], v[152:155], a[72:75], v[128:143]
	ds_read_b64_tr_b16 v[168:169], v29 offset:20480
	ds_read_b64_tr_b16 v[170:171], v29 offset:20736
	ds_read_b64_tr_b16 v[172:173], v30 offset:20480
	ds_read_b64_tr_b16 v[174:175], v30 offset:20736
	buffer_load_dwordx4 v[76:79], v250, s[20:23], s100 offen offset:1024 sc1
	v_mfma_f32_32x32x16_bf16 v[128:143], v[156:159], a[76:79], v[128:143]
	buffer_store_dwordx4 v[220:223], v1, s[20:23], s78 offen offset:3072 sc1
	s_waitcnt lgkmcnt(12)
	v_mfma_f32_32x32x16_bf16 v[128:143], v[160:163], a[80:83], v[128:143]
	ds_read_b64_tr_b16 v[144:145], v27 offset:24576
	ds_read_b64_tr_b16 v[146:147], v27 offset:24832
	ds_read_b64_tr_b16 v[148:149], v28 offset:24576
	ds_read_b64_tr_b16 v[150:151], v28 offset:24832
	buffer_load_dwordx4 v[80:83], v1, s[20:23], s100 offen offset:2048 sc1
	v_mfma_f32_32x32x16_bf16 v[128:143], v[164:167], a[84:87], v[128:143]
	v_mfma_f32_16x16x32_bf16 v[188:191], v[176:179], v[160:163], v[188:191]
	buffer_load_dwordx4 v[84:87], v250, s[20:23], s100 offen offset:2048 sc1
	s_waitcnt lgkmcnt(4)
	v_mfma_f32_32x32x16_bf16 v[128:143], v[168:171], a[88:91], v[128:143]
	s_add_u32 m0, s52, 0
	s_add_u32 s58, s70, 196608
	ds_read_b64_tr_b16 v[152:153], v29 offset:24576
	ds_read_b64_tr_b16 v[154:155], v29 offset:24832
	ds_read_b64_tr_b16 v[156:157], v30 offset:24576
	ds_read_b64_tr_b16 v[158:159], v30 offset:24832
	buffer_load_dwordx4 v10, s[12:15], s58 offen offset:0 lds
	v_mfma_f32_32x32x16_bf16 v[128:143], v[172:175], a[92:95], v[128:143]
	buffer_load_dwordx4 v11, s[12:15], s58 offen offset:1024 lds
	s_waitcnt lgkmcnt(4)
	v_mfma_f32_32x32x16_bf16 v[128:143], v[144:147], a[96:99], v[128:143]
	ds_read_b64_tr_b16 v[160:161], v27 offset:28672
	ds_read_b64_tr_b16 v[162:163], v27 offset:28928
	ds_read_b64_tr_b16 v[164:165], v28 offset:28672
	ds_read_b64_tr_b16 v[166:167], v28 offset:28928
	buffer_load_dwordx4 v12, s[12:15], s58 offen offset:2048 lds
	v_mfma_f32_32x32x16_bf16 v[128:143], v[148:151], a[100:103], v[128:143]
	v_mfma_f32_16x16x32_bf16 v[188:191], v[176:179], v[144:147], v[188:191]
	buffer_load_dwordx4 v13, s[12:15], s58 offen offset:3072 lds
	s_waitcnt lgkmcnt(4)
	v_mfma_f32_32x32x16_bf16 v[128:143], v[152:155], a[104:107], v[128:143]
	ds_read_b64_tr_b16 v[168:169], v29 offset:28672
	ds_read_b64_tr_b16 v[170:171], v29 offset:28928
	ds_read_b64_tr_b16 v[172:173], v30 offset:28672
	ds_read_b64_tr_b16 v[174:175], v30 offset:28928
	v_mfma_f32_32x32x16_bf16 v[128:143], v[156:159], a[108:111], v[128:143]
	s_waitcnt lgkmcnt(4)
	v_mfma_f32_32x32x16_bf16 v[128:143], v[160:163], a[112:115], v[128:143]
	v_mfma_f32_32x32x16_bf16 v[128:143], v[164:167], a[116:119], v[128:143]
	v_mfma_f32_16x16x32_bf16 v[188:191], v[176:179], v[160:163], v[188:191]
	s_waitcnt lgkmcnt(0)
	v_mfma_f32_32x32x16_bf16 v[128:143], v[168:171], a[120:123], v[128:143]
	v_mfma_f32_32x32x16_bf16 v[128:143], v[172:175], a[124:127], v[128:143]
	s_lshl_b32 s3, s40, L_end-L_exit-4+10
	s_add_u32 s3, s3, 139264
	v_add_u32 v247, s3, v1
	s_nop 1
	ds_write_b128 v247, v[188:191]
L_p2B:
	s_waitcnt lgkmcnt(0)
	s_barrier
	v_add_u32 v247, 139264, v1
	ds_read_b128 v[96:99], v247 offset:0
	ds_read_b128 v[100:103], v247 offset:1024
	ds_read_b128 v[104:107], v247 offset:2048
	ds_read_b128 v[108:111], v247 offset:3072
	s_waitcnt vmcnt(21)
	v_bitop3_b32 v32, v32, v251, s66 bitop3:0x78
	s_waitcnt vmcnt(20)
	v_bitop3_b32 v36, v36, v251, s66 bitop3:0x78
	v_bitop3_b32 v33, v33, v252, s66 bitop3:0x78
	v_bitop3_b32 v37, v37, v252, s66 bitop3:0x78
	v_or3_b32 v254, v32, v36, v33
	v_bitop3_b32 v254, v254, v37, s66 bitop3:0xa8
	v_cmp_ne_u32_e64 vcc, 0, v254
	s_nop 0
	s_cbranch_vccnz L_slow43
L_back43:
	v_mfma_f32_32x32x16_bf16 v[160:175], a[128:131], v[32:35], 0
	s_waitcnt lgkmcnt(2)
	v_add_f32 v96, v96, v100
	s_waitcnt lgkmcnt(0)
	v_add_f32 v104, v104, v108
	v_add_f32_e64 v232, v96, v104
	v_cvt_pk_bf16_f32 v114, v232, v232
	v_lshlrev_b32 v114, 16, v114
	v_sub_f32 v114, v232, v114
	v_mfma_f32_32x32x16_bf16 v[176:191], a[132:135], v[32:35], 0
	v_cvt_pk_bf16_f32 v112, v232, v114
	v_and_b32 v115, 0xffff0000, v112
	v_sub_f32 v114, v114, v115
	v_lshlrev_b32 v115, 16, v246
	v_cvt_pk_bf16_f32 v113, v115, v114
	v_mov_b32_e64 v114, 0
	s_waitcnt vmcnt(19)
	v_bitop3_b32 v40, v40, v251, s66 bitop3:0x78
	s_waitcnt vmcnt(18)
	v_bitop3_b32 v44, v44, v251, s66 bitop3:0x78
	v_bitop3_b32 v41, v41, v252, s66 bitop3:0x78
	v_mfma_f32_32x32x16_bf16 v[192:207], a[128:131], v[36:39], 0
	v_mov_b32_e64 v115, 0
	s_nop 1
	v_mfma_f32_32x32x16_bf16 v[128:143], v[112:115], v[224:227], v[128:143]
	s_nop 11
	v_mul_f32_e64 v128, v128, abs(v128)
	v_mul_f32_e64 v129, v129, abs(v129)
	v_mul_f32_e64 v130, v130, abs(v130)
	v_mul_f32_e64 v131, v131, abs(v131)
	v_bitop3_b32 v45, v45, v252, s66 bitop3:0x78
	v_or3_b32 v254, v40, v44, v41
	v_bitop3_b32 v254, v254, v45, s66 bitop3:0xa8
	v_cmp_ne_u32 vcc, 0, v254
	v_mfma_f32_32x32x16_bf16 v[208:223], a[132:135], v[36:39], 0
	s_cbranch_vccnz L_slow44
L_back44:
	v_cvt_pk_bf16_f32 v116, v128, v129
	v_cvt_pk_bf16_f32 v117, v130, v131
	v_pk_max_i16 v116, v116, 0
	v_pk_max_i16 v117, v117, 0
	v_mul_f32_e64 v132, v132, abs(v132)
	v_mul_f32_e64 v133, v133, abs(v133)
	v_mfma_f32_32x32x16_bf16 v[160:175], a[136:139], v[40:43], v[160:175]
	v_mul_f32_e64 v134, v134, abs(v134)
	v_mul_f32_e64 v135, v135, abs(v135)
	v_cvt_pk_bf16_f32 v118, v132, v133
	buffer_load_dwordx4 v[88:91], v1, s[20:23], s100 offen offset:3072 sc1
	v_cvt_pk_bf16_f32 v119, v134, v135
	v_pk_max_i16 v118, v118, 0
	v_pk_max_i16 v119, v119, 0
	v_mfma_f32_32x32x16_bf16 v[176:191], a[140:143], v[40:43], v[176:191]
	v_and_or_b32 v116, v251, s66, v116
	v_and_or_b32 v117, v252, s66, v117
	buffer_store_dwordx4 v[116:119], v1, s[20:23], s79 offen offset:0 sc1
	v_mul_f32_e64 v136, v136, abs(v136)
	v_mul_f32_e64 v137, v137, abs(v137)
	v_mul_f32_e64 v138, v138, abs(v138)
	s_waitcnt vmcnt(19)
	v_bitop3_b32 v48, v48, v251, s66 bitop3:0x78
	s_waitcnt vmcnt(17)
	v_bitop3_b32 v52, v52, v251, s66 bitop3:0x78
	v_bitop3_b32 v49, v49, v252, s66 bitop3:0x78
	v_mfma_f32_32x32x16_bf16 v[192:207], a[136:139], v[44:47], v[192:207]
	v_mul_f32_e64 v139, v139, abs(v139)
	v_cvt_pk_bf16_f32 v120, v136, v137
	v_cvt_pk_bf16_f32 v121, v138, v139
	buffer_load_dwordx4 v[92:95], v250, s[20:23], s100 offen offset:3072 sc1
	v_pk_max_i16 v120, v120, 0
	v_pk_max_i16 v121, v121, 0
	v_mul_f32_e64 v140, v140, abs(v140)
	v_bitop3_b32 v53, v53, v252, s66 bitop3:0x78
	v_or3_b32 v254, v48, v52, v49
	v_bitop3_b32 v254, v254, v53, s66 bitop3:0xa8
	v_cmp_ne_u32 vcc, 0, v254
	v_mfma_f32_32x32x16_bf16 v[208:223], a[140:143], v[44:47], v[208:223]
	s_cbranch_vccnz L_slow45
L_back45:
	v_mul_f32_e64 v141, v141, abs(v141)
	v_mul_f32_e64 v142, v142, abs(v142)
	v_mul_f32_e64 v143, v143, abs(v143)
	v_cvt_pk_bf16_f32 v122, v140, v141
	v_cvt_pk_bf16_f32 v123, v142, v143
	v_pk_max_i16 v122, v122, 0
	v_mfma_f32_32x32x16_bf16 v[160:175], a[144:147], v[48:51], v[160:175]
	s_add_u32 s100, s72, 16384
	v_pk_max_i16 v123, v123, 0
	v_and_or_b32 v120, v251, s66, v120
	v_and_or_b32 v121, v252, s66, v121
	buffer_load_dwordx4 v[32:35], v1, s[20:23], s100 offen offset:0 sc1
	buffer_store_dwordx4 v[120:123], v1, s[20:23], s79 offen offset:1024 sc1
	v_and_b32 v8, 31, v0
	v_lshrrev_b32 v9, 5, v0
	v_mfma_f32_32x32x16_bf16 v[176:191], a[148:151], v[48:51], v[176:191]
	v_and_b32 v14, 7, v0
	v_xor_b32 v9, v9, v14
	v_lshlrev_b32_e64 v9, 4, v9
	buffer_load_dwordx4 v[36:39], v250, s[20:23], s100 offen offset:0 sc1
	v_lshl_add_u32 v9, v8, 8, v9
	s_lshl_b32 s80, s40, 14
	v_add_u32 v2, s80, v9
	s_waitcnt vmcnt(19)
	v_bitop3_b32 v56, v56, v251, s66 bitop3:0x78
	s_waitcnt vmcnt(18)
	v_bitop3_b32 v60, v60, v251, s66 bitop3:0x78
	v_bitop3_b32 v57, v57, v252, s66 bitop3:0x78
	v_mfma_f32_32x32x16_bf16 v[192:207], a[144:147], v[52:55], v[192:207]
	s_add_u32 m0, s52, 4096
	s_add_u32 s58, s70, 229376
	v_xor_b32 v3, 32, v2
	v_xor_b32 v4, 64, v2
	v_xor_b32 v5, 96, v2
	buffer_load_dwordx4 v10, s[12:15], s58 offen offset:0 lds
	v_lshrrev_b32 v8, 3, v0
	v_lshlrev_b32 v9, 1, v14
	v_xor_b32_e64 v9, v9, v8
	v_bitop3_b32 v61, v61, v252, s66 bitop3:0x78
	v_or3_b32 v254, v56, v60, v57
	v_bitop3_b32 v254, v254, v61, s66 bitop3:0xa8
	v_cmp_ne_u32_e64 vcc, 0, v254
	v_mfma_f32_32x32x16_bf16 v[208:223], a[148:151], v[52:55], v[208:223]
	s_cbranch_vccnz L_slow46
L_back46:
	v_lshlrev_b32 v9, 4, v9
	v_lshl_add_u32 v9, v8, 8, v9
	s_lshl_b32 s80, s40, L_end-L_exit-4+11
	buffer_load_dwordx4 v11, s[12:15], s58 offen offset:1024 lds
	v_add_u32_e64 v6, s80, v9
	v_xor_b32 v7, 16, v6
	v_add_u32 v28, 65536, v6
	v_mfma_f32_32x32x16_bf16 v[160:175], a[152:155], v[56:59], v[160:175]
	s_waitcnt vmcnt(8)
	ds_read_b64_tr_b16 a[64:65], v248 offset:0
	buffer_load_dwordx4 v12, s[12:15], s58 offen offset:2048 lds
	ds_read_b64_tr_b16 a[66:67], v248 offset:1024
	ds_read_b64_tr_b16 a[68:69], v249 offset:0
	ds_read_b64_tr_b16 a[70:71], v249 offset:1024
	v_mfma_f32_32x32x16_bf16 v[176:191], a[156:159], v[56:59], v[176:191]
	ds_read_b64_tr_b16 a[72:73], v248 offset:2048
	ds_read_b64_tr_b16 a[74:75], v248 offset:3072
	buffer_load_dwordx4 v13, s[12:15], s58 offen offset:3072 lds
	ds_read_b64_tr_b16 a[76:77], v249 offset:2048
	ds_read_b64_tr_b16 a[78:79], v249 offset:3072
	v_bitop3_b32 v64, v64, v251, s66 bitop3:0x78
	v_bitop3_b32 v68, v68, v251, s66 bitop3:0x78
	v_bitop3_b32 v65, v65, v252, s66 bitop3:0x78
	v_mfma_f32_32x32x16_bf16 v[192:207], a[152:155], v[60:63], v[192:207]
	v_add_u32 v29, 65536, v7
	v_add_u32 v30, 65536, v2
	buffer_load_dwordx4 v[40:43], v1, s[20:23], s100 offen offset:1024 sc1
	v_lshlrev_b32_e64 v9, 4, v14
	v_lshl_add_u32 v15, v8, 10, v9
	v_lshlrev_b32_e64 v14, 4, v8
	v_bitop3_b32 v69, v69, v252, s66 bitop3:0x78
	v_or3_b32 v254, v64, v68, v65
	v_bitop3_b32 v254, v254, v69, s66 bitop3:0xa8
	v_cmp_ne_u32_e64 vcc, 0, v254
	v_mfma_f32_32x32x16_bf16 v[208:223], a[156:159], v[60:63], v[208:223]
	s_cbranch_vccnz L_slow47
L_back47:
	s_lshl3_add_u32 s80, s44, s40
	s_lshl_b32 s81, s80, 13
	s_add_u32 s54, s81, s68
	buffer_load_dwordx4 v[44:47], v250, s[20:23], s100 offen offset:1024 sc1
	s_add_u32 s53, s54, 32768
	s_lshl_b32 s80, s80, L_end-L_exit-4+7
	s_add_u32 s47, s80, 10027008
	v_mfma_f32_32x32x16_bf16 v[160:175], a[160:163], v[64:67], v[160:175]
	buffer_load_dwordx4 v[48:51], v1, s[20:23], s100 offen offset:2048 sc1
	v_mfma_f32_32x32x16_bf16 v[176:191], a[164:167], v[64:67], v[176:191]
	buffer_load_dwordx4 v[52:55], v250, s[20:23], s100 offen offset:2048 sc1
	v_bitop3_b32 v72, v72, v251, s66 bitop3:0x78
	v_bitop3_b32 v76, v76, v251, s66 bitop3:0x78
	v_bitop3_b32 v73, v73, v252, s66 bitop3:0x78
	v_mfma_f32_32x32x16_bf16 v[192:207], a[160:163], v[68:71], v[192:207]
	v_bitop3_b32 v77, v77, v252, s66 bitop3:0x78
	v_or3_b32 v254, v72, v76, v73
	v_bitop3_b32 v254, v254, v77, s66 bitop3:0xa8
	v_cmp_ne_u32 vcc, 0, v254
	v_mfma_f32_32x32x16_bf16 v[208:223], a[164:167], v[68:71], v[208:223]
	s_cbranch_vccnz L_slow48
L_back48:
	v_mfma_f32_32x32x16_bf16 v[160:175], a[168:171], v[72:75], v[160:175]
	buffer_load_dwordx4 v[56:59], v1, s[20:23], s100 offen offset:3072 sc1
	v_mfma_f32_32x32x16_bf16 v[176:191], a[172:175], v[72:75], v[176:191]
	buffer_load_dwordx4 v[60:63], v250, s[20:23], s100 offen offset:3072 sc1
	v_bitop3_b32 v80, v80, v251, s66 bitop3:0x78
	v_bitop3_b32 v84, v84, v251, s66 bitop3:0x78
	v_bitop3_b32 v81, v81, v252, s66 bitop3:0x78
	v_mfma_f32_32x32x16_bf16 v[192:207], a[168:171], v[76:79], v[192:207]
	v_bitop3_b32 v85, v85, v252, s66 bitop3:0x78
	v_or3_b32 v254, v80, v84, v81
	v_bitop3_b32 v254, v254, v85, s66 bitop3:0xa8
	v_cmp_ne_u32 vcc, 0, v254
	v_mfma_f32_32x32x16_bf16 v[208:223], a[172:175], v[76:79], v[208:223]
	s_cbranch_vccnz L_slow49
L_back49:
	v_mfma_f32_32x32x16_bf16 v[160:175], a[176:179], v[80:83], v[160:175]
	s_add_u32 s100, s72, 20480
	buffer_load_dwordx4 v[64:67], v1, s[20:23], s100 offen offset:0 sc1
	v_mfma_f32_32x32x16_bf16 v[176:191], a[180:183], v[80:83], v[176:191]
	buffer_load_dwordx4 v[68:71], v250, s[20:23], s100 offen offset:0 sc1
	s_waitcnt vmcnt(17)
	v_bitop3_b32 v88, v88, v251, s66 bitop3:0x78
	s_waitcnt vmcnt(15)
	v_bitop3_b32 v92, v92, v251, s66 bitop3:0x78
	v_bitop3_b32 v89, v89, v252, s66 bitop3:0x78
	v_mfma_f32_32x32x16_bf16 v[192:207], a[176:179], v[84:87], v[192:207]
	v_bitop3_b32 v93, v93, v252, s66 bitop3:0x78
	v_or3_b32 v254, v88, v92, v89
	v_bitop3_b32 v254, v254, v93, s66 bitop3:0xa8
	v_cmp_ne_u32 vcc, 0, v254
	v_mfma_f32_32x32x16_bf16 v[208:223], a[180:183], v[84:87], v[208:223]
	s_cbranch_vccnz L_slow50
L_back50:
	v_mfma_f32_32x32x16_bf16 v[160:175], a[184:187], v[88:91], v[160:175]
	buffer_load_dwordx4 v[72:75], v1, s[20:23], s100 offen offset:1024 sc1
	v_mfma_f32_32x32x16_bf16 v[176:191], a[188:191], v[88:91], v[176:191]
	buffer_load_dwordx4 v[76:79], v250, s[20:23], s100 offen offset:1024 sc1
	s_waitcnt vmcnt(16)
	v_bitop3_b32 v32, v32, v251, s66 bitop3:0x78
	s_waitcnt vmcnt(14)
	v_bitop3_b32 v36, v36, v251, s66 bitop3:0x78
	v_bitop3_b32 v33, v33, v252, s66 bitop3:0x78
	v_mfma_f32_32x32x16_bf16 v[192:207], a[184:187], v[92:95], v[192:207]
	buffer_load_dwordx4 v[16:19], v15, s[4:7], s54 offen
	v_bitop3_b32 v37, v37, v252, s66 bitop3:0x78
	v_or3_b32 v254, v32, v36, v33
	v_bitop3_b32 v254, v254, v37, s66 bitop3:0xa8
	v_cmp_ne_u32 vcc, 0, v254
	v_mfma_f32_32x32x16_bf16 v[208:223], a[188:191], v[92:95], v[208:223]
	s_cbranch_vccnz L_slow51
L_back51:
	v_mfma_f32_32x32x16_bf16 v[160:175], a[192:195], v[32:35], v[160:175]
	buffer_load_dwordx4 v[80:83], v1, s[20:23], s100 offen offset:2048 sc1
	buffer_load_dwordx4 v[84:87], v250, s[20:23], s100 offen offset:2048 sc1
	v_mfma_f32_32x32x16_bf16 v[176:191], a[196:199], v[32:35], v[176:191]
	s_add_u32 m0, s52, 8192
	s_add_u32 s58, s71, L_end-L_exit-4+0
	buffer_load_dwordx4 v10, s[16:19], s58 offen offset:0 lds
	s_waitcnt vmcnt(13)
	v_bitop3_b32 v40, v40, v251, s66 bitop3:0x78
	s_waitcnt vmcnt(12)
	v_bitop3_b32 v44, v44, v251, s66 bitop3:0x78
	v_bitop3_b32 v41, v41, v252, s66 bitop3:0x78
	v_mfma_f32_32x32x16_bf16 v[192:207], a[192:195], v[36:39], v[192:207]
	buffer_load_dwordx4 v11, s[16:19], s58 offen offset:1024 lds
	v_bitop3_b32 v45, v45, v252, s66 bitop3:0x78
	v_or3_b32 v254, v40, v44, v41
	v_bitop3_b32 v254, v254, v45, s66 bitop3:0xa8
	v_cmp_ne_u32 vcc, 0, v254
	v_mfma_f32_32x32x16_bf16 v[208:223], a[196:199], v[36:39], v[208:223]
	s_cbranch_vccnz L_slow52
L_back52:
	buffer_load_dwordx4 v12, s[16:19], s58 offen offset:2048 lds
	v_mfma_f32_32x32x16_bf16 v[160:175], a[200:203], v[40:43], v[160:175]
	buffer_load_dwordx4 v13, s[16:19], s58 offen offset:3072 lds
	ds_read_b64_tr_b16 a[80:81], v248 offset:4096
	v_mfma_f32_32x32x16_bf16 v[176:191], a[204:207], v[40:43], v[176:191]
	ds_read_b64_tr_b16 a[82:83], v248 offset:5120
	buffer_load_dwordx4 v[20:23], v15, s[4:7], s53 offen
	ds_read_b64_tr_b16 a[84:85], v249 offset:4096
	ds_read_b64_tr_b16 a[86:87], v249 offset:5120
	s_waitcnt vmcnt(15)
	v_bitop3_b32 v48, v48, v251, s66 bitop3:0x78
	s_waitcnt vmcnt(14)
	v_bitop3_b32 v52, v52, v251, s66 bitop3:0x78
	v_bitop3_b32 v49, v49, v252, s66 bitop3:0x78
	v_mfma_f32_32x32x16_bf16 v[192:207], a[200:203], v[44:47], v[192:207]
	ds_read_b64_tr_b16 a[88:89], v248 offset:6144
	buffer_load_dwordx4 v[88:91], v1, s[20:23], s100 offen offset:3072 sc1
	ds_read_b64_tr_b16 a[90:91], v248 offset:7168
	v_bitop3_b32 v53, v53, v252, s66 bitop3:0x78
	v_or3_b32 v254, v48, v52, v49
	v_bitop3_b32 v254, v254, v53, s66 bitop3:0xa8
	v_cmp_ne_u32 vcc, 0, v254
	v_mfma_f32_32x32x16_bf16 v[208:223], a[204:207], v[44:47], v[208:223]
	s_cbranch_vccnz L_slow53
L_back53:
	ds_read_b64_tr_b16 a[92:93], v249 offset:6144
	buffer_load_dwordx4 v[92:95], v250, s[20:23], s100 offen offset:3072 sc1
	ds_read_b64_tr_b16 a[94:95], v249 offset:7168
	v_mfma_f32_32x32x16_bf16 v[160:175], a[208:211], v[48:51], v[160:175]
	buffer_load_dwordx4 v[24:27], v9, s[32:35], s68 offen
	v_mfma_f32_32x32x16_bf16 v[176:191], a[212:215], v[48:51], v[176:191]
	s_add_u32 s100, s72, 8192
	buffer_load_dwordx4 v[32:35], v1, s[20:23], s100 offen offset:0 sc1
	s_waitcnt vmcnt(17)
	v_bitop3_b32 v56, v56, v251, s66 bitop3:0x78
	s_waitcnt vmcnt(16)
	v_bitop3_b32 v60, v60, v251, s66 bitop3:0x78
	v_bitop3_b32 v57, v57, v252, s66 bitop3:0x78
	v_mfma_f32_32x32x16_bf16 v[192:207], a[208:211], v[52:55], v[192:207]
	buffer_load_dwordx4 v[36:39], v1, s[20:23], s100 offen offset:1024 sc1
	v_bitop3_b32 v61, v61, v252, s66 bitop3:0x78
	v_or3_b32 v254, v56, v60, v57
	v_bitop3_b32 v254, v254, v61, s66 bitop3:0xa8
	v_cmp_ne_u32 vcc, 0, v254
	v_mfma_f32_32x32x16_bf16 v[208:223], a[212:215], v[52:55], v[208:223]
	s_cbranch_vccnz L_slow54
L_back54:
	buffer_load_dwordx4 v[240:243], v14, s[20:23], s47 offen sc1
	v_mfma_f32_32x32x16_bf16 v[160:175], a[216:219], v[56:59], v[160:175]
	buffer_load_dwordx4 v[40:43], v1, s[20:23], s100 offen offset:2048 sc1
	buffer_load_dwordx4 v[44:47], v1, s[20:23], s100 offen offset:3072 sc1
	v_mfma_f32_32x32x16_bf16 v[176:191], a[220:223], v[56:59], v[176:191]
	s_add_u32 m0, s52, 12288
	s_add_u32 s58, s71, 32768
	buffer_load_dwordx4 v10, s[16:19], s58 offen offset:0 lds
	s_waitcnt vmcnt(20)
	v_bitop3_b32 v64, v64, v251, s66 bitop3:0x78
	s_waitcnt vmcnt(19)
	v_bitop3_b32 v68, v68, v251, s66 bitop3:0x78
	v_bitop3_b32 v65, v65, v252, s66 bitop3:0x78
	v_mfma_f32_32x32x16_bf16 v[192:207], a[216:219], v[60:63], v[192:207]
	buffer_load_dwordx4 v11, s[16:19], s58 offen offset:1024 lds
	v_bitop3_b32 v69, v69, v252, s66 bitop3:0x78
	v_or3_b32 v254, v64, v68, v65
	v_bitop3_b32 v254, v254, v69, s66 bitop3:0xa8
	v_cmp_ne_u32 vcc, 0, v254
	v_mfma_f32_32x32x16_bf16 v[208:223], a[220:223], v[60:63], v[208:223]
	s_cbranch_vccnz L_slow55
L_back55:
	buffer_load_dwordx4 v12, s[16:19], s58 offen offset:2048 lds
	v_mfma_f32_32x32x16_bf16 v[160:175], a[224:227], v[64:67], v[160:175]
	buffer_load_dwordx4 v13, s[16:19], s58 offen offset:3072 lds
	v_mfma_f32_32x32x16_bf16 v[176:191], a[228:231], v[64:67], v[176:191]
	buffer_load_dwordx4 v[244:247], v14, s[20:23], s47 offen offset:512 sc1
	s_waitcnt vmcnt(22)
	v_bitop3_b32 v72, v72, v251, s66 bitop3:0x78
	s_waitcnt vmcnt(21)
	v_bitop3_b32 v76, v76, v251, s66 bitop3:0x78
	v_bitop3_b32 v73, v73, v252, s66 bitop3:0x78
	v_mfma_f32_32x32x16_bf16 v[192:207], a[224:227], v[68:71], v[192:207]
	s_add_u32 s100, s72, 24576
	buffer_load_dwordx4 v[48:51], v1, s[20:23], s100 offen offset:0 sc1
	v_bitop3_b32 v77, v77, v252, s66 bitop3:0x78
	v_or3_b32 v254, v72, v76, v73
	v_bitop3_b32 v254, v254, v77, s66 bitop3:0xa8
	v_cmp_ne_u32 vcc, 0, v254
	v_mfma_f32_32x32x16_bf16 v[208:223], a[228:231], v[68:71], v[208:223]
	s_cbranch_vccnz L_slow56
L_back56:
	buffer_load_dwordx4 v[52:55], v1, s[20:23], s100 offen offset:1024 sc1
	v_mfma_f32_32x32x16_bf16 v[160:175], a[232:235], v[72:75], v[160:175]
	buffer_load_dwordx4 v[56:59], v1, s[20:23], s100 offen offset:2048 sc1
	v_mfma_f32_32x32x16_bf16 v[176:191], a[236:239], v[72:75], v[176:191]
	buffer_load_dwordx4 v[60:63], v1, s[20:23], s100 offen offset:3072 sc1
	s_waitcnt vmcnt(23)
	v_bitop3_b32 v80, v80, v251, s66 bitop3:0x78
	s_waitcnt vmcnt(22)
	v_bitop3_b32 v84, v84, v251, s66 bitop3:0x78
	v_bitop3_b32 v81, v81, v252, s66 bitop3:0x78
	v_mfma_f32_32x32x16_bf16 v[192:207], a[232:235], v[76:79], v[192:207]
	v_bitop3_b32 v85, v85, v252, s66 bitop3:0x78
	v_or3_b32 v254, v80, v84, v81
	v_bitop3_b32 v254, v254, v85, s66 bitop3:0xa8
	v_cmp_ne_u32 vcc, 0, v254
	v_mfma_f32_32x32x16_bf16 v[208:223], a[236:239], v[76:79], v[208:223]
	s_cbranch_vccnz L_slow57
L_back57:
	v_mfma_f32_32x32x16_bf16 v[160:175], a[240:243], v[80:83], v[160:175]
	s_add_u32 s100, s72, 12288
	buffer_load_dwordx4 v[64:67], v1, s[20:23], s100 offen offset:0 sc1
	buffer_load_dwordx4 v[68:71], v1, s[20:23], s100 offen offset:1024 sc1
	v_mfma_f32_32x32x16_bf16 v[176:191], a[244:247], v[80:83], v[176:191]
	s_waitcnt lgkmcnt(8)
	s_add_u32 m0, s52, 0
	s_add_u32 s58, s71, 65536
	buffer_load_dwordx4 v10, s[16:19], s58 offen offset:0 lds
	s_waitcnt vmcnt(19)
	v_bitop3_b32 v88, v88, v251, s66 bitop3:0x78
	s_waitcnt vmcnt(18)
	v_bitop3_b32 v92, v92, v251, s66 bitop3:0x78
	v_bitop3_b32 v89, v89, v252, s66 bitop3:0x78
	v_mfma_f32_32x32x16_bf16 v[192:207], a[240:243], v[84:87], v[192:207]
	buffer_load_dwordx4 v11, s[16:19], s58 offen offset:1024 lds
	v_bitop3_b32 v93, v93, v252, s66 bitop3:0x78
	v_or3_b32 v254, v88, v92, v89
	v_bitop3_b32 v254, v254, v93, s66 bitop3:0xa8
	v_cmp_ne_u32 vcc, 0, v254
	v_mfma_f32_32x32x16_bf16 v[208:223], a[244:247], v[84:87], v[208:223]
	s_cbranch_vccnz L_slow58
L_back58:
	buffer_load_dwordx4 v12, s[16:19], s58 offen offset:2048 lds
	v_mfma_f32_32x32x16_bf16 v[160:175], a[248:251], v[88:91], v[160:175]
	buffer_load_dwordx4 v13, s[16:19], s58 offen offset:3072 lds
	ds_read_b64_tr_b16 a[96:97], v248 offset:8192
	v_mfma_f32_32x32x16_bf16 v[176:191], a[252:255], v[88:91], v[176:191]
	ds_read_b64_tr_b16 a[98:99], v248 offset:9216
	buffer_load_dwordx4 v[72:75], v1, s[20:23], s100 offen offset:2048 sc1
	ds_read_b64_tr_b16 a[100:101], v249 offset:8192
	ds_read_b64_tr_b16 a[102:103], v249 offset:9216
	s_waitcnt vmcnt(20)
	v_bitop3_b32 v32, v32, v251, s66 bitop3:0x78
	s_waitcnt vmcnt(19)
	v_bitop3_b32 v36, v36, v251, s66 bitop3:0x78
	v_bitop3_b32 v33, v33, v252, s66 bitop3:0x78
	v_mfma_f32_32x32x16_bf16 v[192:207], a[248:251], v[92:95], v[192:207]
	ds_read_b64_tr_b16 a[104:105], v248 offset:10240
	buffer_load_dwordx4 v[76:79], v1, s[20:23], s100 offen offset:3072 sc1
	ds_read_b64_tr_b16 a[106:107], v248 offset:11264
	v_bitop3_b32 v37, v37, v252, s66 bitop3:0x78
	v_or3_b32 v254, v32, v36, v33
	v_bitop3_b32 v254, v254, v37, s66 bitop3:0xa8
	v_cmp_ne_u32 vcc, 0, v254
	v_mfma_f32_32x32x16_bf16 v[208:223], a[252:255], v[92:95], v[208:223]
	s_cbranch_vccnz L_slow59
L_back59:
	ds_read_b64_tr_b16 a[108:109], v249 offset:10240
	ds_read_b64_tr_b16 a[110:111], v249 offset:11264
	v_mfma_f32_32x32x16_bf16 v[160:175], a[0:3], v[32:35], v[160:175]
	s_add_u32 s100, s72, 8192
	buffer_load_dwordx4 v[80:83], v250, s[20:23], s100 offen offset:0 sc1
	v_mfma_f32_32x32x16_bf16 v[176:191], a[4:7], v[32:35], v[176:191]
	buffer_load_dwordx4 v[84:87], v250, s[20:23], s100 offen offset:1024 sc1
	s_waitcnt vmcnt(20)
	v_bitop3_b32 v40, v40, v251, s66 bitop3:0x78
	s_waitcnt vmcnt(19)
	v_bitop3_b32 v44, v44, v251, s66 bitop3:0x78
	v_bitop3_b32 v41, v41, v252, s66 bitop3:0x78
	v_mfma_f32_32x32x16_bf16 v[160:175], a[8:11], v[36:39], v[160:175]
	v_bitop3_b32 v45, v45, v252, s66 bitop3:0x78
	v_or3_b32 v254, v40, v44, v41
	v_bitop3_b32 v254, v254, v45, s66 bitop3:0xa8
	v_cmp_ne_u32_e64 vcc, 0, v254
	v_mfma_f32_32x32x16_bf16 v[176:191], a[12:15], v[36:39], v[176:191]
	s_cbranch_vccnz L_slow60
L_back60:
	v_mfma_f32_32x32x16_bf16 v[160:175], a[16:19], v[40:43], v[160:175]
	buffer_load_dwordx4 v[88:91], v250, s[20:23], s100 offen offset:2048 sc1
	buffer_load_dwordx4 v[92:95], v250, s[20:23], s100 offen offset:3072 sc1
	v_mfma_f32_32x32x16_bf16 v[176:191], a[20:23], v[40:43], v[176:191]
	s_waitcnt lgkmcnt(8)
	s_add_u32 m0, s52, 4096
	s_add_u32 s58, s71, 98304
	buffer_load_dwordx4 v10, s[16:19], s58 offen offset:0 lds
	s_waitcnt vmcnt(16)
	v_bitop3_b32 v48, v48, v251, s66 bitop3:0x78
	s_waitcnt vmcnt(15)
	v_bitop3_b32 v52, v52, v251, s66 bitop3:0x78
	v_bitop3_b32 v49, v49, v252, s66 bitop3:0x78
	v_mfma_f32_32x32x16_bf16 v[160:175], a[24:27], v[44:47], v[160:175]
	buffer_load_dwordx4 v11, s[16:19], s58 offen offset:1024 lds
	v_bitop3_b32 v53, v53, v252, s66 bitop3:0x78
	v_or3_b32 v254, v48, v52, v49
	v_bitop3_b32 v254, v254, v53, s66 bitop3:0xa8
	v_cmp_ne_u32 vcc, 0, v254
	v_mfma_f32_32x32x16_bf16 v[176:191], a[28:31], v[44:47], v[176:191]
	s_cbranch_vccnz L_slow61
L_back61:
	buffer_load_dwordx4 v12, s[16:19], s58 offen offset:2048 lds
	v_mfma_f32_32x32x16_bf16 v[160:175], a[32:35], v[48:51], v[160:175]
	buffer_load_dwordx4 v13, s[16:19], s58 offen offset:3072 lds
	ds_read_b64_tr_b16 a[112:113], v248 offset:12288
	v_mfma_f32_32x32x16_bf16 v[176:191], a[36:39], v[48:51], v[176:191]
	s_add_u32 s100, s72, 24576
	ds_read_b64_tr_b16 a[114:115], v248 offset:13312
	buffer_load_dwordx4 v[32:35], v250, s[20:23], s100 offen offset:0 sc1
	ds_read_b64_tr_b16 a[116:117], v249 offset:12288
	ds_read_b64_tr_b16 a[118:119], v249 offset:13312
	s_waitcnt vmcnt(18)
	v_bitop3_b32 v56, v56, v251, s66 bitop3:0x78
	s_waitcnt vmcnt(17)
	v_bitop3_b32 v60, v60, v251, s66 bitop3:0x78
	v_bitop3_b32 v57, v57, v252, s66 bitop3:0x78
	v_mfma_f32_32x32x16_bf16 v[160:175], a[40:43], v[52:55], v[160:175]
	ds_read_b64_tr_b16 a[120:121], v248 offset:14336
	buffer_load_dwordx4 v[36:39], v250, s[20:23], s100 offen offset:1024 sc1
	ds_read_b64_tr_b16 a[122:123], v248 offset:15360
	v_bitop3_b32 v61, v61, v252, s66 bitop3:0x78
	v_or3_b32 v254, v56, v60, v57
	v_bitop3_b32 v254, v254, v61, s66 bitop3:0xa8
	v_cmp_ne_u32 vcc, 0, v254
	v_mfma_f32_32x32x16_bf16 v[176:191], a[44:47], v[52:55], v[176:191]
	s_cbranch_vccnz L_slow62
L_back62:
	ds_read_b64_tr_b16 a[124:125], v249 offset:14336
	ds_read_b64_tr_b16 a[126:127], v249 offset:15360
	v_mfma_f32_32x32x16_bf16 v[160:175], a[48:51], v[56:59], v[160:175]
	buffer_load_dwordx4 v[40:43], v250, s[20:23], s100 offen offset:2048 sc1
	v_mfma_f32_32x32x16_bf16 v[176:191], a[52:55], v[56:59], v[176:191]
	buffer_load_dwordx4 v[44:47], v250, s[20:23], s100 offen offset:3072 sc1
	s_waitcnt vmcnt(19)
	v_bitop3_b32 v64, v64, v251, s66 bitop3:0x78
	s_waitcnt vmcnt(18)
	v_bitop3_b32 v68, v68, v251, s66 bitop3:0x78
	v_bitop3_b32 v65, v65, v252, s66 bitop3:0x78
	v_mfma_f32_32x32x16_bf16 v[160:175], a[56:59], v[60:63], v[160:175]
	v_bitop3_b32 v69, v69, v252, s66 bitop3:0x78
	v_or3_b32 v254, v64, v68, v65
	v_bitop3_b32 v254, v254, v69, s66 bitop3:0xa8
	v_cmp_ne_u32 vcc, 0, v254
	v_mfma_f32_32x32x16_bf16 v[176:191], a[60:63], v[60:63], v[176:191]
	s_cbranch_vccnz L_slow63
L_back63:
	v_mfma_f32_32x32x16_bf16 v[160:175], a[64:67], v[64:67], v[160:175]
	s_add_u32 s100, s72, 12288
	buffer_load_dwordx4 v[48:51], v250, s[20:23], s100 offen offset:0 sc1
	v_mfma_f32_32x32x16_bf16 v[176:191], a[68:71], v[64:67], v[176:191]
	buffer_load_dwordx4 v[52:55], v250, s[20:23], s100 offen offset:1024 sc1
	s_waitcnt vmcnt(15)
	v_bitop3_b32 v72, v72, v251, s66 bitop3:0x78
	s_waitcnt vmcnt(14)
	v_bitop3_b32 v76, v76, v251, s66 bitop3:0x78
	v_bitop3_b32 v73, v73, v252, s66 bitop3:0x78
	v_mfma_f32_32x32x16_bf16 v[160:175], a[72:75], v[68:71], v[160:175]
	v_bitop3_b32 v77, v77, v252, s66 bitop3:0x78
	v_or3_b32 v254, v72, v76, v73
	v_bitop3_b32 v254, v254, v77, s66 bitop3:0xa8
	v_cmp_ne_u32 vcc, 0, v254
	v_mfma_f32_32x32x16_bf16 v[176:191], a[76:79], v[68:71], v[176:191]
	s_cbranch_vccnz L_slow64
L_back64:
	v_mfma_f32_32x32x16_bf16 v[160:175], a[80:83], v[72:75], v[160:175]
	ds_read_b64_tr_b16 a[128:129], v248 offset:0
	buffer_load_dwordx4 v[56:59], v250, s[20:23], s100 offen offset:2048 sc1
	ds_read_b64_tr_b16 a[130:131], v248 offset:1024
	ds_read_b64_tr_b16 a[132:133], v249 offset:0
	ds_read_b64_tr_b16 a[134:135], v249 offset:1024
	v_mfma_f32_32x32x16_bf16 v[176:191], a[84:87], v[72:75], v[176:191]
	ds_read_b64_tr_b16 a[136:137], v248 offset:2048
	ds_read_b64_tr_b16 a[138:139], v248 offset:3072
	ds_read_b64_tr_b16 a[140:141], v249 offset:2048
	buffer_load_dwordx4 v[60:63], v250, s[20:23], s100 offen offset:3072 sc1
	ds_read_b64_tr_b16 a[142:143], v249 offset:3072
	v_cmp_ne_u64_e64 vcc, s[60:61], v[240:241]
	v_cmp_ne_u64 s[84:85], s[60:61], v[244:245]
	s_nop 0
	s_or_b64 vcc, vcc, s[84:85]
	s_nop 0
	s_cbranch_vccnz L_slow65
L_back65:
	s_waitcnt vmcnt(15)
	v_bitop3_b32 v80, v80, v251, s66 bitop3:0x78
	s_waitcnt vmcnt(14)
	v_bitop3_b32 v84, v84, v251, s66 bitop3:0x78
	v_bitop3_b32 v81, v81, v252, s66 bitop3:0x78
	v_mfma_f32_32x32x16_bf16 v[160:175], a[88:91], v[76:79], v[160:175]
	v_mul_f32 v242, v243, v243
	v_mul_f32 v246, v247, v247
	v_xor_b32 v8, 32, v30
	v_xor_b32 v9, 64, v30
	v_xor_b32 v14, 96, v30
	v_bitop3_b32 v85, v85, v252, s66 bitop3:0x78
	v_or3_b32 v254, v80, v84, v81
	v_bitop3_b32 v254, v254, v85, s66 bitop3:0xa8
	v_cmp_ne_u32 vcc, 0, v254
	v_mfma_f32_32x32x16_bf16 v[176:191], a[92:95], v[76:79], v[176:191]
	s_cbranch_vccnz L_slow66
L_back66:
	s_mov_b32 s82, 0xbfb8aa3b
	v_lshlrev_b32_e64 v240, 16, v24
	v_and_b32 v24, 0xffff0000, v24
	v_lshlrev_b32_e64 v241, 16, v25
	v_and_b32 v25, 0xffff0000, v25
	v_lshlrev_b32_e64 v244, 16, v26
	v_mfma_f32_32x32x16_bf16 v[192:207], a[0:3], v[80:83], v[192:207]
	s_add_u32 s100, s73, L_end-L_exit-4+0
	buffer_load_dwordx4 v[64:67], v1, s[20:23], s100 offen offset:0 sc1
	v_and_b32 v26, 0xffff0000, v26
	v_mfma_f32_32x32x16_bf16 v[208:223], a[4:7], v[80:83], v[208:223]
	buffer_load_dwordx4 v[68:71], v1, s[20:23], s100 offen offset:1024 sc1
	ds_write_b128 v2, v[160:163] offset:0
	s_waitcnt vmcnt(15)
	v_bitop3_b32 v88, v88, v251, s66 bitop3:0x78
	s_waitcnt vmcnt(14)
	v_bitop3_b32 v92, v92, v251, s66 bitop3:0x78
	v_bitop3_b32 v89, v89, v252, s66 bitop3:0x78
	v_mfma_f32_32x32x16_bf16 v[192:207], a[8:11], v[84:87], v[192:207]
	v_lshlrev_b32_e64 v245, 16, v27
	v_bitop3_b32 v93, v93, v252, s66 bitop3:0x78
	v_or3_b32 v254, v88, v92, v89
	v_bitop3_b32 v254, v254, v93, s66 bitop3:0xa8
	v_cmp_ne_u32 vcc, 0, v254
	v_mfma_f32_32x32x16_bf16 v[208:223], a[12:15], v[84:87], v[208:223]
	s_cbranch_vccnz L_slow67
L_back67:
	ds_write_b128 v3, v[164:167] offset:0
	v_and_b32 v27, 0xffff0000, v27
	v_mfma_f32_32x32x16_bf16 v[192:207], a[16:19], v[88:91], v[192:207]
	buffer_load_dwordx4 v[72:75], v1, s[20:23], s100 offen offset:2048 sc1
	v_mfma_f32_32x32x16_bf16 v[208:223], a[20:23], v[88:91], v[208:223]
	buffer_load_dwordx4 v[76:79], v1, s[20:23], s100 offen offset:3072 sc1
	ds_write_b128 v4, v[168:171] offset:0
	s_waitcnt vmcnt(11)
	v_bitop3_b32 v32, v32, v251, s66 bitop3:0x78
	s_waitcnt vmcnt(10)
	v_bitop3_b32 v36, v36, v251, s66 bitop3:0x78
	v_bitop3_b32 v33, v33, v252, s66 bitop3:0x78
	v_mfma_f32_32x32x16_bf16 v[192:207], a[24:27], v[92:95], v[192:207]
	ds_write_b128 v5, v[172:175] offset:0
	v_bitop3_b32 v37, v37, v252, s66 bitop3:0x78
	v_or3_b32 v254, v32, v36, v33
	v_bitop3_b32 v254, v254, v37, s66 bitop3:0xa8
	v_cmp_ne_u32 vcc, 0, v254
	v_mfma_f32_32x32x16_bf16 v[208:223], a[28:31], v[92:95], v[208:223]
	s_cbranch_vccnz L_slow68
L_back68:
	ds_write_b128 v2, v[176:179] offset:128
	v_mfma_f32_32x32x16_bf16 v[192:207], a[32:35], v[32:35], v[192:207]
	s_add_u32 s100, s73, 4096
	buffer_load_dwordx4 v[80:83], v1, s[20:23], s100 offen offset:0 sc1
	ds_read_b64_tr_b16 a[144:145], v248 offset:4096
	ds_read_b64_tr_b16 a[146:147], v248 offset:5120
	v_mfma_f32_32x32x16_bf16 v[208:223], a[36:39], v[32:35], v[208:223]
	ds_read_b64_tr_b16 a[148:149], v249 offset:4096
	buffer_load_dwordx4 v[84:87], v1, s[20:23], s100 offen offset:1024 sc1
	ds_read_b64_tr_b16 a[150:151], v249 offset:5120
	ds_read_b64_tr_b16 a[152:153], v248 offset:6144
	s_waitcnt vmcnt(11)
	v_bitop3_b32 v40, v40, v251, s66 bitop3:0x78
	s_waitcnt vmcnt(10)
	v_bitop3_b32 v44, v44, v251, s66 bitop3:0x78
	v_bitop3_b32 v41, v41, v252, s66 bitop3:0x78
	v_mfma_f32_32x32x16_bf16 v[192:207], a[40:43], v[36:39], v[192:207]
	ds_read_b64_tr_b16 a[154:155], v248 offset:7168
	ds_read_b64_tr_b16 a[156:157], v249 offset:6144
	ds_read_b64_tr_b16 a[158:159], v249 offset:7168
	v_bitop3_b32 v45, v45, v252, s66 bitop3:0x78
	v_or3_b32 v254, v40, v44, v41
	v_bitop3_b32 v254, v254, v45, s66 bitop3:0xa8
	v_cmp_ne_u32 vcc, 0, v254
	v_mfma_f32_32x32x16_bf16 v[208:223], a[44:47], v[36:39], v[208:223]
	s_cbranch_vccnz L_slow69
L_back69:
	ds_write_b128 v3, v[180:183] offset:128
	ds_write_b128 v4, v[184:187] offset:128
	ds_write_b128 v5, v[188:191] offset:128
	v_mfma_f32_32x32x16_bf16 v[192:207], a[48:51], v[40:43], v[192:207]
	buffer_load_dwordx4 v[88:91], v1, s[20:23], s100 offen offset:2048 sc1
	v_mfma_f32_32x32x16_bf16 v[208:223], a[52:55], v[40:43], v[208:223]
	buffer_load_dwordx4 v[92:95], v1, s[20:23], s100 offen offset:3072 sc1
	s_waitcnt vmcnt(11)
	v_bitop3_b32 v48, v48, v251, s66 bitop3:0x78
	s_waitcnt vmcnt(10)
	v_bitop3_b32 v52, v52, v251, s66 bitop3:0x78
	v_bitop3_b32 v49, v49, v252, s66 bitop3:0x78
	v_mfma_f32_32x32x16_bf16 v[192:207], a[56:59], v[44:47], v[192:207]
	v_bitop3_b32 v53, v53, v252, s66 bitop3:0x78
	v_or3_b32 v254, v48, v52, v49
	v_bitop3_b32 v254, v254, v53, s66 bitop3:0xa8
	v_cmp_ne_u32 vcc, 0, v254
	v_mfma_f32_32x32x16_bf16 v[208:223], a[60:63], v[44:47], v[208:223]
	s_cbranch_vccnz L_slow70
L_back70:
	s_waitcnt lgkmcnt(0)
	s_barrier
	ds_read_b128 v[160:163], v6 offset:0
	ds_read_b128 v[164:167], v6 offset:16384
	ds_read_b128 v[168:171], v6 offset:32768
	ds_read_b128 v[172:175], v6 offset:49152
	ds_read_b128 v[176:179], v7 offset:0
	ds_read_b128 v[180:183], v7 offset:16384
	ds_read_b128 v[184:187], v7 offset:32768
	ds_read_b128 v[188:191], v7 offset:49152
	v_mfma_f32_32x32x16_bf16 v[192:207], a[64:67], v[48:51], v[192:207]
	s_add_u32 s100, s73, 0
	s_waitcnt lgkmcnt(4)
	buffer_load_dwordx4 v[32:35], v250, s[20:23], s100 offen offset:0 sc1
	v_add_f32_e64 v160, v160, v164
	v_mfma_f32_32x32x16_bf16 v[208:223], a[68:71], v[48:51], v[208:223]
	v_add_f32_e64 v161, v161, v165
	buffer_load_dwordx4 v[36:39], v250, s[20:23], s100 offen offset:1024 sc1
	v_add_f32 v162, v162, v166
	v_add_f32 v163, v163, v167
	s_waitcnt vmcnt(11)
	v_bitop3_b32 v56, v56, v251, s66 bitop3:0x78
	s_waitcnt vmcnt(10)
	v_bitop3_b32 v60, v60, v251, s66 bitop3:0x78
	v_bitop3_b32 v57, v57, v252, s66 bitop3:0x78
	v_mfma_f32_32x32x16_bf16 v[192:207], a[72:75], v[52:55], v[192:207]
	v_add_f32 v168, v168, v172
	v_add_f32 v169, v169, v173
	v_bitop3_b32 v61, v61, v252, s66 bitop3:0x78
	v_or3_b32 v254, v56, v60, v57
	v_bitop3_b32 v254, v254, v61, s66 bitop3:0xa8
	v_cmp_ne_u32_e64 vcc, 0, v254
	v_mfma_f32_32x32x16_bf16 v[208:223], a[76:79], v[52:55], v[208:223]
	s_cbranch_vccnz L_slow71
L_back71:
	v_add_f32 v170, v170, v174
	v_add_f32 v171, v171, v175
	v_add_f32 v160, v160, v168
	v_mfma_f32_32x32x16_bf16 v[192:207], a[80:83], v[56:59], v[192:207]
	v_add_f32_e64 v161, v161, v169
	buffer_load_dwordx4 v[40:43], v250, s[20:23], s100 offen offset:2048 sc1
	v_add_f32 v162, v162, v170
	v_add_f32 v163, v163, v171
	v_mfma_f32_32x32x16_bf16 v[208:223], a[84:87], v[56:59], v[208:223]
	v_fma_f32 v160, v160, v242, v240
	buffer_load_dwordx4 v[44:47], v250, s[20:23], s100 offen offset:3072 sc1
	v_fma_f32 v161, v161, v242, v24
	v_fma_f32 v162, v162, v242, v241
	s_waitcnt vmcnt(11)
	v_bitop3_b32 v64, v64, v251, s63 bitop3:0x78
	s_waitcnt vmcnt(10)
	v_bitop3_b32 v68, v68, v251, s63 bitop3:0x78
	v_bitop3_b32 v65, v65, v252, s63 bitop3:0x78
	v_mfma_f32_32x32x16_bf16 v[192:207], a[88:91], v[60:63], v[192:207]
	v_fma_f32 v163, v163, v242, v25
	v_mul_f32 v164, s82, v160
	v_mul_f32 v165, s82, v161
	v_bitop3_b32 v69, v69, v252, s63 bitop3:0x78
	v_or3_b32 v254, v64, v68, v65
	v_bitop3_b32 v254, v254, v69, s63 bitop3:0xa8
	v_cmp_ne_u32_e64 vcc, 0, v254
	v_mfma_f32_32x32x16_bf16 v[208:223], a[92:95], v[60:63], v[208:223]
	s_cbranch_vccnz L_slow72
L_back72:
	v_mul_f32 v166, s82, v162
	v_mul_f32 v167, s82, v163
	v_exp_f32 v164, v164
	v_exp_f32_e64 v165, v165
	v_mfma_f32_32x32x16_bf16 v[96:111], a[96:99], v[64:67], 0
	s_add_u32 s100, s73, 4096
	v_exp_f32_e64 v166, v166
	buffer_load_dwordx4 v[48:51], v250, s[20:23], s100 offen offset:0 sc1
	v_exp_f32 v167, v167
	v_add_f32 v164, 1.0, v164
	v_mfma_f32_32x32x16_bf16 v[112:127], a[100:103], v[64:67], 0
	v_add_f32_e64 v165, 1.0, v165
	ds_write_b128 v2, v[192:195] offset:8192
	buffer_load_dwordx4 v[52:55], v250, s[20:23], s100 offen offset:1024 sc1
	v_add_f32 v166, 1.0, v166
	v_add_f32 v167, 1.0, v167
	s_waitcnt vmcnt(11)
	v_bitop3_b32 v72, v72, v251, s63 bitop3:0x78
	s_waitcnt vmcnt(10)
	v_bitop3_b32 v76, v76, v251, s63 bitop3:0x78
	v_bitop3_b32 v73, v73, v252, s63 bitop3:0x78
	v_mfma_f32_32x32x16_bf16 v[96:111], a[104:107], v[68:71], v[96:111]
	v_rcp_f32 v164, v164
	v_rcp_f32 v165, v165
	ds_write_b128 v3, v[196:199] offset:8192
	v_rcp_f32_e64 v166, v166
	v_bitop3_b32 v77, v77, v252, s63 bitop3:0x78
	v_or3_b32 v254, v72, v76, v73
	v_bitop3_b32 v254, v254, v77, s63 bitop3:0xa8
	v_cmp_ne_u32_e64 vcc, 0, v254
	v_mfma_f32_32x32x16_bf16 v[112:127], a[108:111], v[68:71], v[112:127]
	s_cbranch_vccnz L_slow73
L_back73:
	v_rcp_f32 v167, v167
	v_mul_f32 v224, v160, v164
	v_mul_f32 v225, v161, v165
	v_mul_f32_e64 v226, v162, v166
	v_mfma_f32_32x32x16_bf16 v[96:111], a[112:115], v[72:75], v[96:111]
	v_mul_f32 v227, v163, v167
	s_waitcnt lgkmcnt(2)
	buffer_load_dwordx4 v[56:59], v250, s[20:23], s100 offen offset:2048 sc1
	v_add_f32_e64 v176, v176, v180
	ds_write_b128 v4, v[200:203] offset:8192
	v_mfma_f32_32x32x16_bf16 v[112:127], a[116:119], v[72:75], v[112:127]
	v_add_f32 v177, v177, v181
	v_add_f32 v178, v178, v182
	buffer_load_dwordx4 v[60:63], v250, s[20:23], s100 offen offset:3072 sc1
	v_add_f32_e64 v179, v179, v183
	ds_write_b128 v5, v[204:207] offset:8192
	s_waitcnt vmcnt(11)
	v_bitop3_b32 v80, v80, v251, s63 bitop3:0x78
	s_waitcnt vmcnt(10)
	v_bitop3_b32 v84, v84, v251, s63 bitop3:0x78
	v_bitop3_b32 v81, v81, v252, s63 bitop3:0x78
	v_mfma_f32_32x32x16_bf16 v[96:111], a[120:123], v[76:79], v[96:111]
	v_add_f32 v184, v184, v188
	v_add_f32 v185, v185, v189
	v_add_f32_e64 v186, v186, v190
	ds_write_b128 v2, v[208:211] offset:8320
	v_bitop3_b32 v85, v85, v252, s63 bitop3:0x78
	v_or3_b32 v254, v80, v84, v81
	v_bitop3_b32 v254, v254, v85, s63 bitop3:0xa8
	v_cmp_ne_u32_e64 vcc, 0, v254
	v_mfma_f32_32x32x16_bf16 v[112:127], a[124:127], v[76:79], v[112:127]
	s_cbranch_vccnz L_slow74
L_back74:
	v_add_f32 v187, v187, v191
	v_add_f32 v176, v176, v184
	v_add_f32 v177, v177, v185
	v_add_f32_e64 v178, v178, v186
	v_mfma_f32_32x32x16_bf16 v[96:111], a[128:131], v[80:83], v[96:111]
	v_add_f32_e64 v179, v179, v187
	v_fma_f32 v176, v176, v242, v244
	v_fma_f32 v177, v177, v242, v26
	ds_write_b128 v3, v[212:215] offset:8320
	v_mfma_f32_32x32x16_bf16 v[112:127], a[132:135], v[80:83], v[112:127]
	v_fma_f32 v178, v178, v242, v245
	v_fma_f32 v179, v179, v242, v27
	v_mul_f32_e64 v180, s82, v176
	ds_write_b128 v4, v[216:219] offset:8320
	s_waitcnt vmcnt(9)
	v_bitop3_b32 v88, v88, v251, s63 bitop3:0x78
	s_waitcnt vmcnt(8)
	v_bitop3_b32 v92, v92, v251, s63 bitop3:0x78
	v_bitop3_b32 v89, v89, v252, s63 bitop3:0x78
	v_mfma_f32_32x32x16_bf16 v[96:111], a[136:139], v[84:87], v[96:111]
	v_mul_f32 v181, s82, v177
	v_mul_f32 v182, s82, v178
	v_mul_f32_e64 v183, s82, v179
	ds_write_b128 v5, v[220:223] offset:8320
	v_bitop3_b32 v93, v93, v252, s63 bitop3:0x78
	v_or3_b32 v254, v88, v92, v89
	v_bitop3_b32 v254, v254, v93, s63 bitop3:0xa8
	v_cmp_ne_u32_e64 vcc, 0, v254
	v_mfma_f32_32x32x16_bf16 v[112:127], a[140:143], v[84:87], v[112:127]
	s_cbranch_vccnz L_slow75
L_back75:
	v_exp_f32 v180, v180
	v_exp_f32 v181, v181
	v_exp_f32 v182, v182
	v_exp_f32_e64 v183, v183
	v_mfma_f32_32x32x16_bf16 v[96:111], a[144:147], v[88:91], v[96:111]
	v_add_f32 v180, 1.0, v180
	v_add_f32 v181, 1.0, v181
	v_add_f32_e64 v182, 1.0, v182
	v_mfma_f32_32x32x16_bf16 v[112:127], a[148:151], v[88:91], v[112:127]
	v_add_f32 v183, 1.0, v183
	v_rcp_f32 v180, v180
	v_rcp_f32_e64 v181, v181
	s_waitcnt vmcnt(7)
	v_bitop3_b32 v32, v32, v251, s63 bitop3:0x78
	s_waitcnt vmcnt(6)
	v_bitop3_b32 v36, v36, v251, s63 bitop3:0x78
	v_bitop3_b32 v33, v33, v252, s63 bitop3:0x78
	v_mfma_f32_32x32x16_bf16 v[96:111], a[152:155], v[92:95], v[96:111]
	v_rcp_f32 v182, v182
	v_rcp_f32 v183, v183
	v_mul_f32_e64 v228, v176, v180
	v_bitop3_b32 v37, v37, v252, s63 bitop3:0x78
	v_or3_b32 v254, v32, v36, v33
	v_bitop3_b32 v254, v254, v37, s63 bitop3:0xa8
	v_cmp_ne_u32_e64 vcc, 0, v254
	v_mfma_f32_32x32x16_bf16 v[112:127], a[156:159], v[92:95], v[112:127]
	s_cbranch_vccnz L_slow76
L_back76:
	v_mul_f32 v229, v177, v181
	v_mul_f32 v230, v178, v182
	v_mul_f32 v231, v179, v183
	s_waitcnt lgkmcnt(0)
	s_barrier
	ds_read_b128 v[192:195], v6 offset:8192
	ds_read_b128 v[196:199], v6 offset:24576
	ds_read_b128 v[200:203], v6 offset:40960
	ds_read_b128 v[204:207], v6 offset:57344
	ds_read_b128 v[208:211], v7 offset:8192
	ds_read_b128 v[212:215], v7 offset:24576
	ds_read_b128 v[216:219], v7 offset:40960
	ds_read_b128 v[220:223], v7 offset:57344
	v_mfma_f32_32x32x16_bf16 v[128:143], a[96:99], v[32:35], 0
	ds_write_b128 v30, v[96:99] offset:0
	ds_write_b128 v8, v[100:103] offset:0
	s_waitcnt lgkmcnt(6)
	v_add_f32 v192, v192, v196
	v_add_f32_e64 v193, v193, v197
	v_mfma_f32_32x32x16_bf16 v[144:159], a[100:103], v[32:35], 0
	v_add_f32 v194, v194, v198
	v_add_f32 v195, v195, v199
	v_add_f32 v200, v200, v204
	v_add_f32 v201, v201, v205
	v_add_f32_e64 v202, v202, v206
	s_waitcnt vmcnt(5)
	v_bitop3_b32 v40, v40, v251, s63 bitop3:0x78
	s_waitcnt vmcnt(4)
	v_bitop3_b32 v44, v44, v251, s63 bitop3:0x78
	v_bitop3_b32 v41, v41, v252, s63 bitop3:0x78
	v_mfma_f32_32x32x16_bf16 v[128:143], a[104:107], v[36:39], v[128:143]
	v_add_f32 v203, v203, v207
	v_add_f32 v192, v192, v200
	v_add_f32 v193, v193, v201
	v_add_f32 v194, v194, v202
	v_add_f32_e64 v195, v195, v203
	v_bitop3_b32 v45, v45, v252, s63 bitop3:0x78
	v_or3_b32 v254, v40, v44, v41
	v_bitop3_b32 v254, v254, v45, s63 bitop3:0xa8
	v_cmp_ne_u32 vcc, 0, v254
	v_mfma_f32_32x32x16_bf16 v[144:159], a[108:111], v[36:39], v[144:159]
	s_cbranch_vccnz L_slow77
L_back77:
	v_fma_f32 v192, v192, v246, v240
	v_fma_f32 v193, v193, v246, v24
	v_fma_f32 v194, v194, v246, v241
	v_fma_f32 v195, v195, v246, v25
	v_mul_f32 v196, s82, v192
	v_mul_f32 v197, s82, v193
	v_mfma_f32_32x32x16_bf16 v[128:143], a[112:115], v[40:43], v[128:143]
	v_mul_f32 v198, s82, v194
	v_mul_f32 v199, s82, v195
	v_exp_f32 v196, v196
	v_exp_f32 v197, v197
	v_exp_f32_e64 v198, v198
	ds_write_b128 v9, v[104:107] offset:0
	v_mfma_f32_32x32x16_bf16 v[144:159], a[116:119], v[40:43], v[144:159]
	v_exp_f32 v199, v199
	v_add_f32 v196, 1.0, v196
	v_add_f32 v197, 1.0, v197
	v_add_f32 v198, 1.0, v198
	v_add_f32 v199, 1.0, v199
	v_rcp_f32 v196, v196
	s_waitcnt vmcnt(3)
	v_bitop3_b32 v48, v48, v251, s63 bitop3:0x78
	s_waitcnt vmcnt(2)
	v_bitop3_b32 v52, v52, v251, s63 bitop3:0x78
	v_bitop3_b32 v49, v49, v252, s63 bitop3:0x78
	v_mfma_f32_32x32x16_bf16 v[128:143], a[120:123], v[44:47], v[128:143]
	ds_write_b128 v14, v[108:111] offset:0
	v_rcp_f32 v197, v197
	v_rcp_f32 v198, v198
	v_rcp_f32 v199, v199
	v_mul_f32 v232, v192, v196
	v_mul_f32_e64 v233, v193, v197
	v_bitop3_b32 v53, v53, v252, s63 bitop3:0x78
	v_or3_b32 v254, v48, v52, v49
	v_bitop3_b32 v254, v254, v53, s63 bitop3:0xa8
	v_cmp_ne_u32 vcc, 0, v254
	v_mfma_f32_32x32x16_bf16 v[144:159], a[124:127], v[44:47], v[144:159]
	s_cbranch_vccnz L_slow78
L_back78:
	s_waitcnt vmcnt(1)
	v_bitop3_b32 v56, v56, v251, s63 bitop3:0x78
	s_waitcnt vmcnt(0)
	v_bitop3_b32 v60, v60, v251, s63 bitop3:0x78
	v_bitop3_b32 v57, v57, v252, s63 bitop3:0x78
	v_bitop3_b32 v61, v61, v252, s63 bitop3:0x78
	v_or3_b32 v254, v56, v60, v57
	v_bitop3_b32 v254, v254, v61, s63 bitop3:0xa8
	v_cmp_ne_u32_e64 vcc, 0, v254
	s_nop 0
	s_cbranch_vccnz L_slow79
L_back79:
	ds_write_b128 v30, v[112:115] offset:128
	v_mul_f32 v234, v194, v198
	v_mul_f32 v235, v195, v199
	s_waitcnt lgkmcnt(5)
	v_add_f32 v208, v208, v212
	v_add_f32 v209, v209, v213
	v_add_f32 v210, v210, v214
	v_mfma_f32_32x32x16_bf16 v[128:143], a[128:131], v[48:51], v[128:143]
	v_add_f32 v211, v211, v215
	v_add_f32 v216, v216, v220
	v_add_f32 v217, v217, v221
	v_add_f32 v218, v218, v222
	v_add_f32_e64 v219, v219, v223
	ds_write_b128 v8, v[116:119] offset:128
	v_mfma_f32_32x32x16_bf16 v[128:143], a[136:139], v[52:55], v[128:143]
	v_add_f32 v208, v208, v216
	v_add_f32 v209, v209, v217
	v_add_f32 v210, v210, v218
	v_add_f32 v211, v211, v219
	v_fma_f32 v208, v208, v246, v244
	v_fma_f32 v209, v209, v246, v26
	v_mfma_f32_32x32x16_bf16 v[128:143], a[144:147], v[56:59], v[128:143]
	ds_write_b128 v9, v[120:123] offset:128
	v_fma_f32 v210, v210, v246, v245
	v_fma_f32 v211, v211, v246, v27
	v_mul_f32 v212, s82, v208
	v_mul_f32 v213, s82, v209
	v_mul_f32_e64 v214, s82, v210
	v_mfma_f32_32x32x16_bf16 v[128:143], a[152:155], v[60:63], v[128:143]
	ds_write_b128 v14, v[124:127] offset:128
	v_mul_f32 v215, s82, v211
	v_exp_f32 v212, v212
	v_exp_f32 v213, v213
	v_exp_f32 v214, v214
	v_exp_f32 v215, v215
	v_add_f32 v212, 1.0, v212
	v_mfma_f32_32x32x16_bf16 v[144:159], a[132:135], v[48:51], v[144:159]
	v_add_f32 v213, 1.0, v213
	v_add_f32 v214, 1.0, v214
	v_add_f32_e64 v215, 1.0, v215
	v_mfma_f32_32x32x16_bf16 v[144:159], a[140:143], v[52:55], v[144:159]
	v_rcp_f32_e64 v212, v212
	ds_write_b128 v30, v[128:131] offset:8192
	v_rcp_f32 v213, v213
	v_rcp_f32 v214, v214
	v_mfma_f32_32x32x16_bf16 v[144:159], a[148:151], v[56:59], v[144:159]
	ds_write_b128 v8, v[132:135] offset:8192
	v_rcp_f32 v215, v215
	v_mul_f32 v236, v208, v212
	v_mfma_f32_32x32x16_bf16 v[144:159], a[156:159], v[60:63], v[144:159]
	ds_write_b128 v9, v[136:139] offset:8192
	v_mul_f32 v237, v209, v213
	v_mul_f32 v238, v210, v214
	v_mul_f32_e64 v239, v211, v215
	ds_write_b128 v14, v[140:143] offset:8192
	s_waitcnt lgkmcnt(4)
	s_barrier
	ds_read_b128 v[160:163], v28 offset:0
	ds_read_b128 v[164:167], v28 offset:16384
	ds_read_b128 v[168:171], v28 offset:32768
	ds_read_b128 v[172:175], v28 offset:49152
	ds_read_b128 v[176:179], v29 offset:0
	ds_read_b128 v[180:183], v29 offset:16384
	ds_read_b128 v[184:187], v29 offset:32768
	ds_read_b128 v[188:191], v29 offset:49152
	ds_write_b128 v30, v[144:147] offset:8320
	v_lshlrev_b32_e64 v96, 16, v16
	v_and_b32 v97, 0xffff0000, v16
	v_lshlrev_b32_e64 v98, 16, v17
	v_and_b32 v99, 0xffff0000, v17
	v_lshlrev_b32_e64 v100, 16, v18
	v_and_b32 v101, 0xffff0000, v18
	ds_write_b128 v8, v[148:151] offset:8320
	v_lshlrev_b32 v102, 16, v19
	v_and_b32 v103, 0xffff0000, v19
	s_waitcnt lgkmcnt(6)
	v_pk_add_f32 v[160:161], v[160:161], v[164:165]
	v_pk_add_f32 v[162:163], v[162:163], v[166:167]
	v_pk_add_f32 v[168:169], v[168:169], v[172:173]
	ds_write_b128 v9, v[152:155] offset:8320
	v_pk_add_f32 v[170:171], v[170:171], v[174:175]
	v_pk_add_f32 v[160:161], v[160:161], v[168:169]
	v_pk_add_f32 v[162:163], v[162:163], v[170:171]
	v_pk_fma_f32 v[96:97], v[160:161], v[224:225], v[96:97]
	v_pk_fma_f32 v[98:99], v[162:163], v[226:227], v[98:99]
	s_waitcnt lgkmcnt(3)
	s_nop 0
	ds_write_b128 v14, v[156:159] offset:8320
	v_pk_add_f32 v[176:177], v[176:177], v[180:181]
	v_pk_add_f32 v[178:179], v[178:179], v[182:183]
	v_pk_add_f32 v[184:185], v[184:185], v[188:189]
	v_pk_add_f32 v[186:187], v[186:187], v[190:191]
	v_pk_add_f32 v[176:177], v[176:177], v[184:185]
	v_pk_add_f32 v[178:179], v[178:179], v[186:187]
	v_pk_fma_f32 v[100:101], v[176:177], v[228:229], v[100:101]
	v_pk_fma_f32 v[102:103], v[178:179], v[230:231], v[102:103]
	v_cvt_pk_bf16_f32 v104, v96, v97
	v_cvt_pk_bf16_f32 v105, v98, v99
	v_cvt_pk_bf16_f32 v106, v100, v101
	v_cvt_pk_bf16_f32 v107, v102, v103
	buffer_store_dwordx4 v[104:107], v15, s[24:27], s54 offen sc1 nt
	s_waitcnt lgkmcnt(0)
	s_barrier
	ds_read_b128 v[192:195], v28 offset:8192
	ds_read_b128 v[196:199], v28 offset:24576
	ds_read_b128 v[200:203], v28 offset:40960
	ds_read_b128 v[204:207], v28 offset:57344
	ds_read_b128 v[208:211], v29 offset:8192
	ds_read_b128 v[212:215], v29 offset:24576
	ds_read_b128 v[216:219], v29 offset:40960
	ds_read_b128 v[220:223], v29 offset:57344
	v_lshlrev_b32_e64 v112, 16, v20
	v_and_b32 v113, 0xffff0000, v20
	v_lshlrev_b32_e64 v114, 16, v21
	v_and_b32 v115, 0xffff0000, v21
	v_lshlrev_b32_e64 v116, 16, v22
	v_and_b32 v117, 0xffff0000, v22
	v_lshlrev_b32 v118, 16, v23
	v_and_b32 v119, 0xffff0000, v23
	s_waitcnt lgkmcnt(4)
	v_pk_add_f32 v[192:193], v[192:193], v[196:197]
	v_pk_add_f32 v[194:195], v[194:195], v[198:199]
	v_pk_add_f32 v[200:201], v[200:201], v[204:205]
	v_pk_add_f32 v[202:203], v[202:203], v[206:207]
	v_pk_add_f32 v[192:193], v[192:193], v[200:201]
	v_pk_add_f32 v[194:195], v[194:195], v[202:203]
	v_pk_fma_f32 v[112:113], v[192:193], v[232:233], v[112:113]
	v_pk_fma_f32 v[114:115], v[194:195], v[234:235], v[114:115]
	s_waitcnt lgkmcnt(0)
	s_nop 0
	v_pk_add_f32 v[208:209], v[208:209], v[212:213]
	v_pk_add_f32 v[210:211], v[210:211], v[214:215]
	v_pk_add_f32 v[216:217], v[216:217], v[220:221]
	v_pk_add_f32 v[218:219], v[218:219], v[222:223]
	v_pk_add_f32 v[208:209], v[208:209], v[216:217]
	v_pk_add_f32 v[210:211], v[210:211], v[218:219]
	v_pk_fma_f32 v[116:117], v[208:209], v[236:237], v[116:117]
	v_pk_fma_f32 v[118:119], v[210:211], v[238:239], v[118:119]
	v_cvt_pk_bf16_f32 v120, v112, v113
	v_cvt_pk_bf16_f32 v121, v114, v115
	v_cvt_pk_bf16_f32 v122, v116, v117
	v_cvt_pk_bf16_f32 v123, v118, v119
	buffer_store_dwordx4 v[120:123], v15, s[24:27], s53 offen sc1 nt
	s_endpgm
L_exit:
	s_endpgm
L_end:
L_slow1:
L_spin1:
	s_sleep 2
	buffer_load_dwordx2 v[254:255], off, s[36:39], 0 sc1
	s_waitcnt vmcnt(0)
	v_cmp_eq_u32 vcc, 0, v255
	s_add_u32 s69, s69, 1
	s_nop 1
	s_cbranch_vccz L_back1
	s_cmp_lt_u32 s69, 0x10000
	s_cbranch_scc1 L_spin1
	s_branch L_back1
L_slow2:
L_spin2:
	s_sleep 2
	buffer_load_dwordx4 v[204:207], v191, s[20:23], s98 offen sc1
	s_waitcnt vmcnt(0)
	v_cmp_ne_u64 vcc, s[60:61], v[204:205]
	s_add_u32 s69, s69, 1
	s_nop 1
	s_cbranch_vccz L_back2
	s_cmp_lt_u32 s69, 0x10000
	s_cbranch_scc1 L_spin2
	s_branch L_back2
L_slow3:
L_spin3:
	s_sleep 2
	buffer_load_dwordx4 v[240:243], v244, s[20:23], s50 offen sc1
	s_add_u32 s59, s48, 0
	buffer_load_dwordx4 v[32:35], v1, s[20:23], s59 offen offset:0 sc1
	buffer_load_dwordx4 v[36:39], v1, s[20:23], s59 offen offset:1024 sc1
	buffer_load_dwordx4 v[40:43], v1, s[20:23], s59 offen offset:2048 sc1
	buffer_load_dwordx4 v[44:47], v1, s[20:23], s59 offen offset:3072 sc1
	s_add_u32 s59, s48, 4096
	buffer_load_dwordx4 v[48:51], v1, s[20:23], s59 offen offset:0 sc1
	buffer_load_dwordx4 v[52:55], v1, s[20:23], s59 offen offset:1024 sc1
	buffer_load_dwordx4 v[56:59], v1, s[20:23], s59 offen offset:2048 sc1
	buffer_load_dwordx4 v[60:63], v1, s[20:23], s59 offen offset:3072 sc1
	s_add_u32 s59, s48, 8192
	buffer_load_dwordx4 v[64:67], v1, s[20:23], s59 offen offset:0 sc1
	buffer_load_dwordx4 v[68:71], v1, s[20:23], s59 offen offset:1024 sc1
	buffer_load_dwordx4 v[72:75], v1, s[20:23], s59 offen offset:2048 sc1
	buffer_load_dwordx4 v[76:79], v1, s[20:23], s59 offen offset:3072 sc1
	s_add_u32 s59, s48, 12288
	buffer_load_dwordx4 v[80:83], v1, s[20:23], s59 offen offset:0 sc1
	buffer_load_dwordx4 v[84:87], v1, s[20:23], s59 offen offset:1024 sc1
	buffer_load_dwordx4 v[88:91], v1, s[20:23], s59 offen offset:2048 sc1
	buffer_load_dwordx4 v[92:95], v1, s[20:23], s59 offen offset:3072 sc1
	s_waitcnt vmcnt(0)
	v_xor_b32 v240, s67, v240
	v_xor_b32 v241, s46, v241
	v_or_b32 v254, v240, v241
	v_xor_b32 v32, s67, v32
	v_xor_b32 v33, v253, v33
	v_or3_b32 v254, v254, v32, v33
	v_xor_b32 v36, s67, v36
	v_xor_b32 v37, v253, v37
	v_or3_b32 v254, v254, v36, v37
	v_xor_b32 v40, s67, v40
	v_xor_b32 v41, v253, v41
	v_or3_b32 v254, v254, v40, v41
	v_xor_b32 v44, s67, v44
	v_xor_b32 v45, v253, v45
	v_or3_b32 v254, v254, v44, v45
	v_xor_b32 v48, s67, v48
	v_xor_b32 v49, v253, v49
	v_or3_b32 v254, v254, v48, v49
	v_xor_b32 v52, s67, v52
	v_xor_b32 v53, v253, v53
	v_or3_b32 v254, v254, v52, v53
	v_xor_b32 v56, s67, v56
	v_xor_b32 v57, v253, v57
	v_or3_b32 v254, v254, v56, v57
	v_xor_b32 v60, s67, v60
	v_xor_b32 v61, v253, v61
	v_or3_b32 v254, v254, v60, v61
	v_xor_b32 v64, s67, v64
	v_xor_b32 v65, v253, v65
	v_or3_b32 v254, v254, v64, v65
	v_xor_b32 v68, s67, v68
	v_xor_b32 v69, v253, v69
	v_or3_b32 v254, v254, v68, v69
	v_xor_b32 v72, s67, v72
	v_xor_b32 v73, v253, v73
	v_or3_b32 v254, v254, v72, v73
	v_xor_b32 v76, s67, v76
	v_xor_b32 v77, v253, v77
	v_or3_b32 v254, v254, v76, v77
	v_xor_b32 v80, s67, v80
	v_xor_b32 v81, v253, v81
	v_or3_b32 v254, v254, v80, v81
	v_xor_b32 v84, s67, v84
	v_xor_b32 v85, v253, v85
	v_or3_b32 v254, v254, v84, v85
	v_xor_b32 v88, s67, v88
	v_xor_b32 v89, v253, v89
	v_or3_b32 v254, v254, v88, v89
	v_xor_b32 v92, s67, v92
	v_xor_b32 v93, v253, v93
	v_or3_b32 v254, v254, v92, v93
	v_and_b32 v254, 3, v254
	v_cmp_ne_u32 vcc, 0, v254
	s_add_u32 s69, s69, 1
	s_nop 1
	s_cbranch_vccz L_back3
	s_cmp_lt_u32 s69, 0x10000
	s_cbranch_scc1 L_spin3
	s_branch L_back3
L_slow4:
L_spin4:
	s_sleep 2
	s_add_u32 s3, s72, 0
	buffer_load_dwordx4 v[32:35], v1, s[20:23], s3 offen offset:0 sc1
	buffer_load_dwordx4 v[36:39], v250, s[20:23], s3 offen offset:0 sc1
	s_waitcnt vmcnt(0)
	v_bitop3_b32 v32, v32, v251, s66 bitop3:0x78
	v_bitop3_b32 v36, v36, v251, s66 bitop3:0x78
	v_bitop3_b32 v33, v33, v252, s66 bitop3:0x78
	v_bitop3_b32 v37, v37, v252, s66 bitop3:0x78
	v_or3_b32 v254, v32, v36, v33
	v_bitop3_b32 v254, v254, v37, s66 bitop3:0xa8
	v_cmp_ne_u32 vcc, 0, v254
	s_add_u32 s69, s69, 1
	s_nop 1
	s_cbranch_vccz L_rest4
	s_cmp_lt_u32 s69, 0x10000
	s_cbranch_scc1 L_spin4
L_rest4:
	buffer_load_dwordx4 v[40:43], v1, s[20:23], s3 offen offset:1024 sc1
	buffer_load_dwordx4 v[44:47], v250, s[20:23], s3 offen offset:1024 sc1
	buffer_load_dwordx4 v[48:51], v1, s[20:23], s3 offen offset:2048 sc1
	buffer_load_dwordx4 v[52:55], v250, s[20:23], s3 offen offset:2048 sc1
	buffer_load_dwordx4 v[56:59], v1, s[20:23], s3 offen offset:3072 sc1
	buffer_load_dwordx4 v[60:63], v250, s[20:23], s3 offen offset:3072 sc1
	s_add_u32 s3, s72, 4096
	buffer_load_dwordx4 v[64:67], v1, s[20:23], s3 offen offset:0 sc1
	buffer_load_dwordx4 v[68:71], v250, s[20:23], s3 offen offset:0 sc1
	buffer_load_dwordx4 v[72:75], v1, s[20:23], s3 offen offset:1024 sc1
	buffer_load_dwordx4 v[76:79], v250, s[20:23], s3 offen offset:1024 sc1
	buffer_load_dwordx4 v[80:83], v1, s[20:23], s3 offen offset:2048 sc1
	buffer_load_dwordx4 v[84:87], v250, s[20:23], s3 offen offset:2048 sc1
	s_waitcnt vmcnt(0)
	s_branch L_back4
L_slow5:
L_spin5:
	s_sleep 2
	s_add_u32 s3, s72, 0
	buffer_load_dwordx4 v[40:43], v1, s[20:23], s3 offen offset:1024 sc1
	buffer_load_dwordx4 v[44:47], v250, s[20:23], s3 offen offset:1024 sc1
	s_waitcnt vmcnt(0)
	v_bitop3_b32 v40, v40, v251, s66 bitop3:0x78
	v_bitop3_b32 v44, v44, v251, s66 bitop3:0x78
	v_bitop3_b32 v41, v41, v252, s66 bitop3:0x78
	v_bitop3_b32 v45, v45, v252, s66 bitop3:0x78
	v_or3_b32 v254, v40, v44, v41
	v_bitop3_b32 v254, v254, v45, s66 bitop3:0xa8
	v_cmp_ne_u32 vcc, 0, v254
	s_add_u32 s69, s69, 1
	s_nop 1
	s_cbranch_vccz L_rest5
	s_cmp_lt_u32 s69, 0x10000
	s_cbranch_scc1 L_spin5
L_rest5:
	buffer_load_dwordx4 v[48:51], v1, s[20:23], s3 offen offset:2048 sc1
	buffer_load_dwordx4 v[52:55], v250, s[20:23], s3 offen offset:2048 sc1
	buffer_load_dwordx4 v[56:59], v1, s[20:23], s3 offen offset:3072 sc1
	buffer_load_dwordx4 v[60:63], v250, s[20:23], s3 offen offset:3072 sc1
	s_add_u32 s3, s72, 4096
	buffer_load_dwordx4 v[64:67], v1, s[20:23], s3 offen offset:0 sc1
	buffer_load_dwordx4 v[68:71], v250, s[20:23], s3 offen offset:0 sc1
	buffer_load_dwordx4 v[72:75], v1, s[20:23], s3 offen offset:1024 sc1
	buffer_load_dwordx4 v[76:79], v250, s[20:23], s3 offen offset:1024 sc1
	buffer_load_dwordx4 v[80:83], v1, s[20:23], s3 offen offset:2048 sc1
	buffer_load_dwordx4 v[84:87], v250, s[20:23], s3 offen offset:2048 sc1
	s_waitcnt vmcnt(0)
	s_branch L_back5
L_slow6:
L_spin6:
	s_sleep 2
	s_add_u32 s3, s72, 0
	buffer_load_dwordx4 v[48:51], v1, s[20:23], s3 offen offset:2048 sc1
	buffer_load_dwordx4 v[52:55], v250, s[20:23], s3 offen offset:2048 sc1
	s_waitcnt vmcnt(0)
	v_bitop3_b32 v48, v48, v251, s66 bitop3:0x78
	v_bitop3_b32 v52, v52, v251, s66 bitop3:0x78
	v_bitop3_b32 v49, v49, v252, s66 bitop3:0x78
	v_bitop3_b32 v53, v53, v252, s66 bitop3:0x78
	v_or3_b32 v254, v48, v52, v49
	v_bitop3_b32 v254, v254, v53, s66 bitop3:0xa8
	v_cmp_ne_u32 vcc, 0, v254
	s_add_u32 s69, s69, 1
	s_nop 1
	s_cbranch_vccz L_rest6
	s_cmp_lt_u32 s69, 0x10000
	s_cbranch_scc1 L_spin6
L_rest6:
	buffer_load_dwordx4 v[56:59], v1, s[20:23], s3 offen offset:3072 sc1
	buffer_load_dwordx4 v[60:63], v250, s[20:23], s3 offen offset:3072 sc1
	s_add_u32 s3, s72, 4096
	buffer_load_dwordx4 v[64:67], v1, s[20:23], s3 offen offset:0 sc1
	buffer_load_dwordx4 v[68:71], v250, s[20:23], s3 offen offset:0 sc1
	buffer_load_dwordx4 v[72:75], v1, s[20:23], s3 offen offset:1024 sc1
	buffer_load_dwordx4 v[76:79], v250, s[20:23], s3 offen offset:1024 sc1
	buffer_load_dwordx4 v[80:83], v1, s[20:23], s3 offen offset:2048 sc1
	buffer_load_dwordx4 v[84:87], v250, s[20:23], s3 offen offset:2048 sc1
	buffer_load_dwordx4 v[88:91], v1, s[20:23], s3 offen offset:3072 sc1
	buffer_load_dwordx4 v[92:95], v250, s[20:23], s3 offen offset:3072 sc1
	s_waitcnt vmcnt(0)
	s_branch L_back6
L_slow7:
L_spin7:
	s_sleep 2
	s_add_u32 s3, s72, 0
	buffer_load_dwordx4 v[56:59], v1, s[20:23], s3 offen offset:3072 sc1
	buffer_load_dwordx4 v[60:63], v250, s[20:23], s3 offen offset:3072 sc1
	s_waitcnt vmcnt(0)
	v_bitop3_b32 v56, v56, v251, s66 bitop3:0x78
	v_bitop3_b32 v60, v60, v251, s66 bitop3:0x78
	v_bitop3_b32 v57, v57, v252, s66 bitop3:0x78
	v_bitop3_b32 v61, v61, v252, s66 bitop3:0x78
	v_or3_b32 v254, v56, v60, v57
	v_bitop3_b32 v254, v254, v61, s66 bitop3:0xa8
	v_cmp_ne_u32 vcc, 0, v254
	s_add_u32 s69, s69, 1
	s_nop 1
	s_cbranch_vccz L_rest7
	s_cmp_lt_u32 s69, 0x10000
	s_cbranch_scc1 L_spin7
L_rest7:
	s_add_u32 s3, s72, 4096
	buffer_load_dwordx4 v[64:67], v1, s[20:23], s3 offen offset:0 sc1
	buffer_load_dwordx4 v[68:71], v250, s[20:23], s3 offen offset:0 sc1
	buffer_load_dwordx4 v[72:75], v1, s[20:23], s3 offen offset:1024 sc1
	buffer_load_dwordx4 v[76:79], v250, s[20:23], s3 offen offset:1024 sc1
	buffer_load_dwordx4 v[80:83], v1, s[20:23], s3 offen offset:2048 sc1
	buffer_load_dwordx4 v[84:87], v250, s[20:23], s3 offen offset:2048 sc1
	buffer_load_dwordx4 v[88:91], v1, s[20:23], s3 offen offset:3072 sc1
	buffer_load_dwordx4 v[92:95], v250, s[20:23], s3 offen offset:3072 sc1
	s_add_u32 s3, s72, 16384
	buffer_load_dwordx4 v[32:35], v1, s[20:23], s3 offen offset:0 sc1
	buffer_load_dwordx4 v[36:39], v250, s[20:23], s3 offen offset:0 sc1
	s_waitcnt vmcnt(0)
	s_branch L_back7
L_slow8:
L_spin8:
	s_sleep 2
	s_add_u32 s3, s72, 4096
	buffer_load_dwordx4 v[64:67], v1, s[20:23], s3 offen offset:0 sc1
	buffer_load_dwordx4 v[68:71], v250, s[20:23], s3 offen offset:0 sc1
	s_waitcnt vmcnt(0)
	v_bitop3_b32 v64, v64, v251, s66 bitop3:0x78
	v_bitop3_b32 v68, v68, v251, s66 bitop3:0x78
	v_bitop3_b32 v65, v65, v252, s66 bitop3:0x78
	v_bitop3_b32 v69, v69, v252, s66 bitop3:0x78
	v_or3_b32 v254, v64, v68, v65
	v_bitop3_b32 v254, v254, v69, s66 bitop3:0xa8
	v_cmp_ne_u32 vcc, 0, v254
	s_add_u32 s69, s69, 1
	s_nop 1
	s_cbranch_vccz L_rest8
	s_cmp_lt_u32 s69, 0x10000
	s_cbranch_scc1 L_spin8
L_rest8:
	buffer_load_dwordx4 v[72:75], v1, s[20:23], s3 offen offset:1024 sc1
	buffer_load_dwordx4 v[76:79], v250, s[20:23], s3 offen offset:1024 sc1
	buffer_load_dwordx4 v[80:83], v1, s[20:23], s3 offen offset:2048 sc1
	buffer_load_dwordx4 v[84:87], v250, s[20:23], s3 offen offset:2048 sc1
	buffer_load_dwordx4 v[88:91], v1, s[20:23], s3 offen offset:3072 sc1
	buffer_load_dwordx4 v[92:95], v250, s[20:23], s3 offen offset:3072 sc1
	s_add_u32 s3, s72, 16384
	buffer_load_dwordx4 v[32:35], v1, s[20:23], s3 offen offset:0 sc1
	buffer_load_dwordx4 v[36:39], v250, s[20:23], s3 offen offset:0 sc1
	buffer_load_dwordx4 v[40:43], v1, s[20:23], s3 offen offset:1024 sc1
	buffer_load_dwordx4 v[44:47], v250, s[20:23], s3 offen offset:1024 sc1
	s_waitcnt vmcnt(0)
	s_branch L_back8
L_slow9:
L_spin9:
	s_sleep 2
	s_add_u32 s3, s72, 4096
	buffer_load_dwordx4 v[72:75], v1, s[20:23], s3 offen offset:1024 sc1
	buffer_load_dwordx4 v[76:79], v250, s[20:23], s3 offen offset:1024 sc1
	s_waitcnt vmcnt(0)
	v_bitop3_b32 v72, v72, v251, s66 bitop3:0x78
	v_bitop3_b32 v76, v76, v251, s66 bitop3:0x78
	v_bitop3_b32 v73, v73, v252, s66 bitop3:0x78
	v_bitop3_b32 v77, v77, v252, s66 bitop3:0x78
	v_or3_b32 v254, v72, v76, v73
	v_bitop3_b32 v254, v254, v77, s66 bitop3:0xa8
	v_cmp_ne_u32 vcc, 0, v254
	s_add_u32 s69, s69, 1
	s_nop 1
	s_cbranch_vccz L_rest9
	s_cmp_lt_u32 s69, 0x10000
	s_cbranch_scc1 L_spin9
L_rest9:
	buffer_load_dwordx4 v[80:83], v1, s[20:23], s3 offen offset:2048 sc1
	buffer_load_dwordx4 v[84:87], v250, s[20:23], s3 offen offset:2048 sc1
	buffer_load_dwordx4 v[88:91], v1, s[20:23], s3 offen offset:3072 sc1
	buffer_load_dwordx4 v[92:95], v250, s[20:23], s3 offen offset:3072 sc1
	s_add_u32 s3, s72, 16384
	buffer_load_dwordx4 v[32:35], v1, s[20:23], s3 offen offset:0 sc1
	buffer_load_dwordx4 v[36:39], v250, s[20:23], s3 offen offset:0 sc1
	buffer_load_dwordx4 v[40:43], v1, s[20:23], s3 offen offset:1024 sc1
	buffer_load_dwordx4 v[44:47], v250, s[20:23], s3 offen offset:1024 sc1
	buffer_load_dwordx4 v[48:51], v1, s[20:23], s3 offen offset:2048 sc1
	buffer_load_dwordx4 v[52:55], v250, s[20:23], s3 offen offset:2048 sc1
	s_waitcnt vmcnt(0)
	s_branch L_back9
L_slow10:
L_spin10:
	s_sleep 2
	s_add_u32 s3, s72, 4096
	buffer_load_dwordx4 v[80:83], v1, s[20:23], s3 offen offset:2048 sc1
	buffer_load_dwordx4 v[84:87], v250, s[20:23], s3 offen offset:2048 sc1
	s_waitcnt vmcnt(0)
	v_bitop3_b32 v80, v80, v251, s66 bitop3:0x78
	v_bitop3_b32 v84, v84, v251, s66 bitop3:0x78
	v_bitop3_b32 v81, v81, v252, s66 bitop3:0x78
	v_bitop3_b32 v85, v85, v252, s66 bitop3:0x78
	v_or3_b32 v254, v80, v84, v81
	v_bitop3_b32 v254, v254, v85, s66 bitop3:0xa8
	v_cmp_ne_u32 vcc, 0, v254
	s_add_u32 s69, s69, 1
	s_nop 1
	s_cbranch_vccz L_rest10
	s_cmp_lt_u32 s69, 0x10000
	s_cbranch_scc1 L_spin10
L_rest10:
	buffer_load_dwordx4 v[88:91], v1, s[20:23], s3 offen offset:3072 sc1
	buffer_load_dwordx4 v[92:95], v250, s[20:23], s3 offen offset:3072 sc1
	s_add_u32 s3, s72, 16384
	buffer_load_dwordx4 v[32:35], v1, s[20:23], s3 offen offset:0 sc1
	buffer_load_dwordx4 v[36:39], v250, s[20:23], s3 offen offset:0 sc1
	buffer_load_dwordx4 v[40:43], v1, s[20:23], s3 offen offset:1024 sc1
	buffer_load_dwordx4 v[44:47], v250, s[20:23], s3 offen offset:1024 sc1
	buffer_load_dwordx4 v[48:51], v1, s[20:23], s3 offen offset:2048 sc1
	buffer_load_dwordx4 v[52:55], v250, s[20:23], s3 offen offset:2048 sc1
	buffer_load_dwordx4 v[56:59], v1, s[20:23], s3 offen offset:3072 sc1
	buffer_load_dwordx4 v[60:63], v250, s[20:23], s3 offen offset:3072 sc1
	s_waitcnt vmcnt(0)
	s_branch L_back10
L_slow11:
L_spin11:
	s_sleep 2
	s_add_u32 s3, s72, 4096
	buffer_load_dwordx4 v[88:91], v1, s[20:23], s3 offen offset:3072 sc1
	buffer_load_dwordx4 v[92:95], v250, s[20:23], s3 offen offset:3072 sc1
	s_waitcnt vmcnt(0)
	v_bitop3_b32 v88, v88, v251, s66 bitop3:0x78
	v_bitop3_b32 v92, v92, v251, s66 bitop3:0x78
	v_bitop3_b32 v89, v89, v252, s66 bitop3:0x78
	v_bitop3_b32 v93, v93, v252, s66 bitop3:0x78
	v_or3_b32 v254, v88, v92, v89
	v_bitop3_b32 v254, v254, v93, s66 bitop3:0xa8
	v_cmp_ne_u32 vcc, 0, v254
	s_add_u32 s69, s69, 1
	s_nop 1
	s_cbranch_vccz L_rest11
	s_cmp_lt_u32 s69, 0x10000
	s_cbranch_scc1 L_spin11
L_rest11:
	s_add_u32 s3, s72, 16384
	buffer_load_dwordx4 v[32:35], v1, s[20:23], s3 offen offset:0 sc1
	buffer_load_dwordx4 v[36:39], v250, s[20:23], s3 offen offset:0 sc1
	buffer_load_dwordx4 v[40:43], v1, s[20:23], s3 offen offset:1024 sc1
	buffer_load_dwordx4 v[44:47], v250, s[20:23], s3 offen offset:1024 sc1
	buffer_load_dwordx4 v[48:51], v1, s[20:23], s3 offen offset:2048 sc1
	buffer_load_dwordx4 v[52:55], v250, s[20:23], s3 offen offset:2048 sc1
	buffer_load_dwordx4 v[56:59], v1, s[20:23], s3 offen offset:3072 sc1
	buffer_load_dwordx4 v[60:63], v250, s[20:23], s3 offen offset:3072 sc1
	s_add_u32 s3, s72, 20480
	buffer_load_dwordx4 v[64:67], v1, s[20:23], s3 offen offset:0 sc1
	buffer_load_dwordx4 v[68:71], v250, s[20:23], s3 offen offset:0 sc1
	s_waitcnt vmcnt(0)
	s_branch L_back11
L_slow12:
L_spin12:
	s_sleep 2
	s_add_u32 s3, s72, 16384
	buffer_load_dwordx4 v[32:35], v1, s[20:23], s3 offen offset:0 sc1
	buffer_load_dwordx4 v[36:39], v250, s[20:23], s3 offen offset:0 sc1
	s_waitcnt vmcnt(0)
	v_bitop3_b32 v32, v32, v251, s66 bitop3:0x78
	v_bitop3_b32 v36, v36, v251, s66 bitop3:0x78
	v_bitop3_b32 v33, v33, v252, s66 bitop3:0x78
	v_bitop3_b32 v37, v37, v252, s66 bitop3:0x78
	v_or3_b32 v254, v32, v36, v33
	v_bitop3_b32 v254, v254, v37, s66 bitop3:0xa8
	v_cmp_ne_u32 vcc, 0, v254
	s_add_u32 s69, s69, 1
	s_nop 1
	s_cbranch_vccz L_rest12
	s_cmp_lt_u32 s69, 0x10000
	s_cbranch_scc1 L_spin12
L_rest12:
	buffer_load_dwordx4 v[40:43], v1, s[20:23], s3 offen offset:1024 sc1
	buffer_load_dwordx4 v[44:47], v250, s[20:23], s3 offen offset:1024 sc1
	buffer_load_dwordx4 v[48:51], v1, s[20:23], s3 offen offset:2048 sc1
	buffer_load_dwordx4 v[52:55], v250, s[20:23], s3 offen offset:2048 sc1
	buffer_load_dwordx4 v[56:59], v1, s[20:23], s3 offen offset:3072 sc1
	buffer_load_dwordx4 v[60:63], v250, s[20:23], s3 offen offset:3072 sc1
	s_add_u32 s3, s72, 20480
	buffer_load_dwordx4 v[64:67], v1, s[20:23], s3 offen offset:0 sc1
	buffer_load_dwordx4 v[68:71], v250, s[20:23], s3 offen offset:0 sc1
	buffer_load_dwordx4 v[72:75], v1, s[20:23], s3 offen offset:1024 sc1
	buffer_load_dwordx4 v[76:79], v250, s[20:23], s3 offen offset:1024 sc1
	s_waitcnt vmcnt(0)
	s_branch L_back12
L_slow13:
L_spin13:
	s_sleep 2
	s_add_u32 s3, s72, 16384
	buffer_load_dwordx4 v[40:43], v1, s[20:23], s3 offen offset:1024 sc1
	buffer_load_dwordx4 v[44:47], v250, s[20:23], s3 offen offset:1024 sc1
	s_waitcnt vmcnt(0)
	v_bitop3_b32 v40, v40, v251, s66 bitop3:0x78
	v_bitop3_b32 v44, v44, v251, s66 bitop3:0x78
	v_bitop3_b32 v41, v41, v252, s66 bitop3:0x78
	v_bitop3_b32 v45, v45, v252, s66 bitop3:0x78
	v_or3_b32 v254, v40, v44, v41
	v_bitop3_b32 v254, v254, v45, s66 bitop3:0xa8
	v_cmp_ne_u32 vcc, 0, v254
	s_add_u32 s69, s69, 1
	s_nop 1
	s_cbranch_vccz L_rest13
	s_cmp_lt_u32 s69, 0x10000
	s_cbranch_scc1 L_spin13
L_rest13:
	buffer_load_dwordx4 v[48:51], v1, s[20:23], s3 offen offset:2048 sc1
	buffer_load_dwordx4 v[52:55], v250, s[20:23], s3 offen offset:2048 sc1
	buffer_load_dwordx4 v[56:59], v1, s[20:23], s3 offen offset:3072 sc1
	buffer_load_dwordx4 v[60:63], v250, s[20:23], s3 offen offset:3072 sc1
	s_add_u32 s3, s72, 20480
	buffer_load_dwordx4 v[64:67], v1, s[20:23], s3 offen offset:0 sc1
	buffer_load_dwordx4 v[68:71], v250, s[20:23], s3 offen offset:0 sc1
	buffer_load_dwordx4 v[72:75], v1, s[20:23], s3 offen offset:1024 sc1
	buffer_load_dwordx4 v[76:79], v250, s[20:23], s3 offen offset:1024 sc1
	buffer_load_dwordx4 v[80:83], v1, s[20:23], s3 offen offset:2048 sc1
	buffer_load_dwordx4 v[84:87], v250, s[20:23], s3 offen offset:2048 sc1
	s_waitcnt vmcnt(0)
	s_branch L_back13
L_slow14:
L_spin14:
	s_sleep 2
	s_add_u32 s3, s72, 16384
	buffer_load_dwordx4 v[48:51], v1, s[20:23], s3 offen offset:2048 sc1
	buffer_load_dwordx4 v[52:55], v250, s[20:23], s3 offen offset:2048 sc1
	s_waitcnt vmcnt(0)
	v_bitop3_b32 v48, v48, v251, s66 bitop3:0x78
	v_bitop3_b32 v52, v52, v251, s66 bitop3:0x78
	v_bitop3_b32 v49, v49, v252, s66 bitop3:0x78
	v_bitop3_b32 v53, v53, v252, s66 bitop3:0x78
	v_or3_b32 v254, v48, v52, v49
	v_bitop3_b32 v254, v254, v53, s66 bitop3:0xa8
	v_cmp_ne_u32 vcc, 0, v254
	s_add_u32 s69, s69, 1
	s_nop 1
	s_cbranch_vccz L_rest14
	s_cmp_lt_u32 s69, 0x10000
	s_cbranch_scc1 L_spin14
L_rest14:
	buffer_load_dwordx4 v[56:59], v1, s[20:23], s3 offen offset:3072 sc1
	buffer_load_dwordx4 v[60:63], v250, s[20:23], s3 offen offset:3072 sc1
	s_add_u32 s3, s72, 20480
	buffer_load_dwordx4 v[64:67], v1, s[20:23], s3 offen offset:0 sc1
	buffer_load_dwordx4 v[68:71], v250, s[20:23], s3 offen offset:0 sc1
	buffer_load_dwordx4 v[72:75], v1, s[20:23], s3 offen offset:1024 sc1
	buffer_load_dwordx4 v[76:79], v250, s[20:23], s3 offen offset:1024 sc1
	buffer_load_dwordx4 v[80:83], v1, s[20:23], s3 offen offset:2048 sc1
	buffer_load_dwordx4 v[84:87], v250, s[20:23], s3 offen offset:2048 sc1
	buffer_load_dwordx4 v[88:91], v1, s[20:23], s3 offen offset:3072 sc1
	buffer_load_dwordx4 v[92:95], v250, s[20:23], s3 offen offset:3072 sc1
	s_waitcnt vmcnt(0)
	s_branch L_back14
L_slow15:
L_spin15:
	s_sleep 2
	s_add_u32 s3, s72, 16384
	buffer_load_dwordx4 v[56:59], v1, s[20:23], s3 offen offset:3072 sc1
	buffer_load_dwordx4 v[60:63], v250, s[20:23], s3 offen offset:3072 sc1
	s_waitcnt vmcnt(0)
	v_bitop3_b32 v56, v56, v251, s66 bitop3:0x78
	v_bitop3_b32 v60, v60, v251, s66 bitop3:0x78
	v_bitop3_b32 v57, v57, v252, s66 bitop3:0x78
	v_bitop3_b32 v61, v61, v252, s66 bitop3:0x78
	v_or3_b32 v254, v56, v60, v57
	v_bitop3_b32 v254, v254, v61, s66 bitop3:0xa8
	v_cmp_ne_u32 vcc, 0, v254
	s_add_u32 s69, s69, 1
	s_nop 1
	s_cbranch_vccz L_rest15
	s_cmp_lt_u32 s69, 0x10000
	s_cbranch_scc1 L_spin15
L_rest15:
	s_add_u32 s3, s72, 20480
	buffer_load_dwordx4 v[64:67], v1, s[20:23], s3 offen offset:0 sc1
	buffer_load_dwordx4 v[68:71], v250, s[20:23], s3 offen offset:0 sc1
	buffer_load_dwordx4 v[72:75], v1, s[20:23], s3 offen offset:1024 sc1
	buffer_load_dwordx4 v[76:79], v250, s[20:23], s3 offen offset:1024 sc1
	buffer_load_dwordx4 v[80:83], v1, s[20:23], s3 offen offset:2048 sc1
	buffer_load_dwordx4 v[84:87], v250, s[20:23], s3 offen offset:2048 sc1
	buffer_load_dwordx4 v[88:91], v1, s[20:23], s3 offen offset:3072 sc1
	buffer_load_dwordx4 v[92:95], v250, s[20:23], s3 offen offset:3072 sc1
	s_add_u32 s3, s72, 8192
	buffer_load_dwordx4 v[32:35], v1, s[20:23], s3 offen offset:0 sc1
	buffer_load_dwordx4 v[36:39], v1, s[20:23], s3 offen offset:1024 sc1
	s_waitcnt vmcnt(0)
	s_branch L_back15
L_slow16:
L_spin16:
	s_sleep 2
	s_add_u32 s3, s72, 20480
	buffer_load_dwordx4 v[64:67], v1, s[20:23], s3 offen offset:0 sc1
	buffer_load_dwordx4 v[68:71], v250, s[20:23], s3 offen offset:0 sc1
	s_waitcnt vmcnt(0)
	v_bitop3_b32 v64, v64, v251, s66 bitop3:0x78
	v_bitop3_b32 v68, v68, v251, s66 bitop3:0x78
	v_bitop3_b32 v65, v65, v252, s66 bitop3:0x78
	v_bitop3_b32 v69, v69, v252, s66 bitop3:0x78
	v_or3_b32 v254, v64, v68, v65
	v_bitop3_b32 v254, v254, v69, s66 bitop3:0xa8
	v_cmp_ne_u32 vcc, 0, v254
	s_add_u32 s69, s69, 1
	s_nop 1
	s_cbranch_vccz L_rest16
	s_cmp_lt_u32 s69, 0x10000
	s_cbranch_scc1 L_spin16
L_rest16:
	buffer_load_dwordx4 v[72:75], v1, s[20:23], s3 offen offset:1024 sc1
	buffer_load_dwordx4 v[76:79], v250, s[20:23], s3 offen offset:1024 sc1
	buffer_load_dwordx4 v[80:83], v1, s[20:23], s3 offen offset:2048 sc1
	buffer_load_dwordx4 v[84:87], v250, s[20:23], s3 offen offset:2048 sc1
	buffer_load_dwordx4 v[88:91], v1, s[20:23], s3 offen offset:3072 sc1
	buffer_load_dwordx4 v[92:95], v250, s[20:23], s3 offen offset:3072 sc1
	s_add_u32 s3, s72, 8192
	buffer_load_dwordx4 v[32:35], v1, s[20:23], s3 offen offset:0 sc1
	buffer_load_dwordx4 v[36:39], v1, s[20:23], s3 offen offset:1024 sc1
	buffer_load_dwordx4 v[40:43], v1, s[20:23], s3 offen offset:2048 sc1
	buffer_load_dwordx4 v[44:47], v1, s[20:23], s3 offen offset:3072 sc1
	s_waitcnt vmcnt(0)
	s_branch L_back16
L_slow17:
L_spin17:
	s_sleep 2
	s_add_u32 s3, s72, 20480
	buffer_load_dwordx4 v[72:75], v1, s[20:23], s3 offen offset:1024 sc1
	buffer_load_dwordx4 v[76:79], v250, s[20:23], s3 offen offset:1024 sc1
	s_waitcnt vmcnt(0)
	v_bitop3_b32 v72, v72, v251, s66 bitop3:0x78
	v_bitop3_b32 v76, v76, v251, s66 bitop3:0x78
	v_bitop3_b32 v73, v73, v252, s66 bitop3:0x78
	v_bitop3_b32 v77, v77, v252, s66 bitop3:0x78
	v_or3_b32 v254, v72, v76, v73
	v_bitop3_b32 v254, v254, v77, s66 bitop3:0xa8
	v_cmp_ne_u32 vcc, 0, v254
	s_add_u32 s69, s69, 1
	s_nop 1
	s_cbranch_vccz L_rest17
	s_cmp_lt_u32 s69, 0x10000
	s_cbranch_scc1 L_spin17
L_rest17:
	buffer_load_dwordx4 v[80:83], v1, s[20:23], s3 offen offset:2048 sc1
	buffer_load_dwordx4 v[84:87], v250, s[20:23], s3 offen offset:2048 sc1
	buffer_load_dwordx4 v[88:91], v1, s[20:23], s3 offen offset:3072 sc1
	buffer_load_dwordx4 v[92:95], v250, s[20:23], s3 offen offset:3072 sc1
	s_add_u32 s3, s72, 8192
	buffer_load_dwordx4 v[32:35], v1, s[20:23], s3 offen offset:0 sc1
	buffer_load_dwordx4 v[36:39], v1, s[20:23], s3 offen offset:1024 sc1
	buffer_load_dwordx4 v[40:43], v1, s[20:23], s3 offen offset:2048 sc1
	buffer_load_dwordx4 v[44:47], v1, s[20:23], s3 offen offset:3072 sc1
	s_add_u32 s3, s72, 24576
	buffer_load_dwordx4 v[48:51], v1, s[20:23], s3 offen offset:0 sc1
	buffer_load_dwordx4 v[52:55], v1, s[20:23], s3 offen offset:1024 sc1
	s_waitcnt vmcnt(0)
	s_branch L_back17
L_slow18:
L_spin18:
	s_sleep 2
	s_add_u32 s3, s72, 20480
	buffer_load_dwordx4 v[80:83], v1, s[20:23], s3 offen offset:2048 sc1
	buffer_load_dwordx4 v[84:87], v250, s[20:23], s3 offen offset:2048 sc1
	s_waitcnt vmcnt(0)
	v_bitop3_b32 v80, v80, v251, s66 bitop3:0x78
	v_bitop3_b32 v84, v84, v251, s66 bitop3:0x78
	v_bitop3_b32 v81, v81, v252, s66 bitop3:0x78
	v_bitop3_b32 v85, v85, v252, s66 bitop3:0x78
	v_or3_b32 v254, v80, v84, v81
	v_bitop3_b32 v254, v254, v85, s66 bitop3:0xa8
	v_cmp_ne_u32 vcc, 0, v254
	s_add_u32 s69, s69, 1
	s_nop 1
	s_cbranch_vccz L_rest18
	s_cmp_lt_u32 s69, 0x10000
	s_cbranch_scc1 L_spin18
L_rest18:
	buffer_load_dwordx4 v[88:91], v1, s[20:23], s3 offen offset:3072 sc1
	buffer_load_dwordx4 v[92:95], v250, s[20:23], s3 offen offset:3072 sc1
	s_add_u32 s3, s72, 8192
	buffer_load_dwordx4 v[32:35], v1, s[20:23], s3 offen offset:0 sc1
	buffer_load_dwordx4 v[36:39], v1, s[20:23], s3 offen offset:1024 sc1
	buffer_load_dwordx4 v[40:43], v1, s[20:23], s3 offen offset:2048 sc1
	buffer_load_dwordx4 v[44:47], v1, s[20:23], s3 offen offset:3072 sc1
	s_add_u32 s3, s72, 24576
	buffer_load_dwordx4 v[48:51], v1, s[20:23], s3 offen offset:0 sc1
	buffer_load_dwordx4 v[52:55], v1, s[20:23], s3 offen offset:1024 sc1
	buffer_load_dwordx4 v[56:59], v1, s[20:23], s3 offen offset:2048 sc1
	buffer_load_dwordx4 v[60:63], v1, s[20:23], s3 offen offset:3072 sc1
	s_waitcnt vmcnt(0)
	s_branch L_back18
L_slow19:
L_spin19:
	s_sleep 2
	s_add_u32 s3, s72, 20480
	buffer_load_dwordx4 v[88:91], v1, s[20:23], s3 offen offset:3072 sc1
	buffer_load_dwordx4 v[92:95], v250, s[20:23], s3 offen offset:3072 sc1
	s_waitcnt vmcnt(0)
	v_bitop3_b32 v88, v88, v251, s66 bitop3:0x78
	v_bitop3_b32 v92, v92, v251, s66 bitop3:0x78
	v_bitop3_b32 v89, v89, v252, s66 bitop3:0x78
	v_bitop3_b32 v93, v93, v252, s66 bitop3:0x78
	v_or3_b32 v254, v88, v92, v89
	v_bitop3_b32 v254, v254, v93, s66 bitop3:0xa8
	v_cmp_ne_u32 vcc, 0, v254
	s_add_u32 s69, s69, 1
	s_nop 1
	s_cbranch_vccz L_rest19
	s_cmp_lt_u32 s69, 0x10000
	s_cbranch_scc1 L_spin19
L_rest19:
	s_add_u32 s3, s72, 8192
	buffer_load_dwordx4 v[32:35], v1, s[20:23], s3 offen offset:0 sc1
	buffer_load_dwordx4 v[36:39], v1, s[20:23], s3 offen offset:1024 sc1
	buffer_load_dwordx4 v[40:43], v1, s[20:23], s3 offen offset:2048 sc1
	buffer_load_dwordx4 v[44:47], v1, s[20:23], s3 offen offset:3072 sc1
	s_add_u32 s3, s72, 24576
	buffer_load_dwordx4 v[48:51], v1, s[20:23], s3 offen offset:0 sc1
	buffer_load_dwordx4 v[52:55], v1, s[20:23], s3 offen offset:1024 sc1
	buffer_load_dwordx4 v[56:59], v1, s[20:23], s3 offen offset:2048 sc1
	buffer_load_dwordx4 v[60:63], v1, s[20:23], s3 offen offset:3072 sc1
	s_add_u32 s3, s72, 12288
	buffer_load_dwordx4 v[64:67], v1, s[20:23], s3 offen offset:0 sc1
	buffer_load_dwordx4 v[68:71], v1, s[20:23], s3 offen offset:1024 sc1
	s_waitcnt vmcnt(0)
	s_branch L_back19
L_slow20:
L_spin20:
	s_sleep 2
	s_add_u32 s3, s72, 8192
	buffer_load_dwordx4 v[32:35], v1, s[20:23], s3 offen offset:0 sc1
	buffer_load_dwordx4 v[36:39], v1, s[20:23], s3 offen offset:1024 sc1
	s_waitcnt vmcnt(0)
	v_bitop3_b32 v32, v32, v251, s66 bitop3:0x78
	v_bitop3_b32 v36, v36, v251, s66 bitop3:0x78
	v_bitop3_b32 v33, v33, v252, s66 bitop3:0x78
	v_bitop3_b32 v37, v37, v252, s66 bitop3:0x78
	v_or3_b32 v254, v32, v36, v33
	v_bitop3_b32 v254, v254, v37, s66 bitop3:0xa8
	v_cmp_ne_u32 vcc, 0, v254
	s_add_u32 s69, s69, 1
	s_nop 1
	s_cbranch_vccz L_rest20
	s_cmp_lt_u32 s69, 0x10000
	s_cbranch_scc1 L_spin20
L_rest20:
	buffer_load_dwordx4 v[40:43], v1, s[20:23], s3 offen offset:2048 sc1
	buffer_load_dwordx4 v[44:47], v1, s[20:23], s3 offen offset:3072 sc1
	s_add_u32 s3, s72, 24576
	buffer_load_dwordx4 v[48:51], v1, s[20:23], s3 offen offset:0 sc1
	buffer_load_dwordx4 v[52:55], v1, s[20:23], s3 offen offset:1024 sc1
	buffer_load_dwordx4 v[56:59], v1, s[20:23], s3 offen offset:2048 sc1
	buffer_load_dwordx4 v[60:63], v1, s[20:23], s3 offen offset:3072 sc1
	s_add_u32 s3, s72, 12288
	buffer_load_dwordx4 v[64:67], v1, s[20:23], s3 offen offset:0 sc1
	buffer_load_dwordx4 v[68:71], v1, s[20:23], s3 offen offset:1024 sc1
	buffer_load_dwordx4 v[72:75], v1, s[20:23], s3 offen offset:2048 sc1
	buffer_load_dwordx4 v[76:79], v1, s[20:23], s3 offen offset:3072 sc1
	s_waitcnt vmcnt(0)
	s_branch L_back20
L_slow21:
L_spin21:
	s_sleep 2
	s_add_u32 s3, s72, 8192
	buffer_load_dwordx4 v[40:43], v1, s[20:23], s3 offen offset:2048 sc1
	buffer_load_dwordx4 v[44:47], v1, s[20:23], s3 offen offset:3072 sc1
	s_waitcnt vmcnt(0)
	v_bitop3_b32 v40, v40, v251, s66 bitop3:0x78
	v_bitop3_b32 v44, v44, v251, s66 bitop3:0x78
	v_bitop3_b32 v41, v41, v252, s66 bitop3:0x78
	v_bitop3_b32 v45, v45, v252, s66 bitop3:0x78
	v_or3_b32 v254, v40, v44, v41
	v_bitop3_b32 v254, v254, v45, s66 bitop3:0xa8
	v_cmp_ne_u32 vcc, 0, v254
	s_add_u32 s69, s69, 1
	s_nop 1
	s_cbranch_vccz L_rest21
	s_cmp_lt_u32 s69, 0x10000
	s_cbranch_scc1 L_spin21
L_rest21:
	s_add_u32 s3, s72, 24576
	buffer_load_dwordx4 v[48:51], v1, s[20:23], s3 offen offset:0 sc1
	buffer_load_dwordx4 v[52:55], v1, s[20:23], s3 offen offset:1024 sc1
	buffer_load_dwordx4 v[56:59], v1, s[20:23], s3 offen offset:2048 sc1
	buffer_load_dwordx4 v[60:63], v1, s[20:23], s3 offen offset:3072 sc1
	s_add_u32 s3, s72, 12288
	buffer_load_dwordx4 v[64:67], v1, s[20:23], s3 offen offset:0 sc1
	buffer_load_dwordx4 v[68:71], v1, s[20:23], s3 offen offset:1024 sc1
	buffer_load_dwordx4 v[72:75], v1, s[20:23], s3 offen offset:2048 sc1
	buffer_load_dwordx4 v[76:79], v1, s[20:23], s3 offen offset:3072 sc1
	s_add_u32 s3, s72, 8192
	buffer_load_dwordx4 v[80:83], v250, s[20:23], s3 offen offset:0 sc1
	buffer_load_dwordx4 v[84:87], v250, s[20:23], s3 offen offset:1024 sc1
	s_waitcnt vmcnt(0)
	s_branch L_back21
L_slow22:
L_spin22:
	s_sleep 2
	s_add_u32 s3, s72, 24576
	buffer_load_dwordx4 v[48:51], v1, s[20:23], s3 offen offset:0 sc1
	buffer_load_dwordx4 v[52:55], v1, s[20:23], s3 offen offset:1024 sc1
	s_waitcnt vmcnt(0)
	v_bitop3_b32 v48, v48, v251, s66 bitop3:0x78
	v_bitop3_b32 v52, v52, v251, s66 bitop3:0x78
	v_bitop3_b32 v49, v49, v252, s66 bitop3:0x78
	v_bitop3_b32 v53, v53, v252, s66 bitop3:0x78
	v_or3_b32 v254, v48, v52, v49
	v_bitop3_b32 v254, v254, v53, s66 bitop3:0xa8
	v_cmp_ne_u32 vcc, 0, v254
	s_add_u32 s69, s69, 1
	s_nop 1
	s_cbranch_vccz L_rest22
	s_cmp_lt_u32 s69, 0x10000
	s_cbranch_scc1 L_spin22
L_rest22:
	buffer_load_dwordx4 v[56:59], v1, s[20:23], s3 offen offset:2048 sc1
	buffer_load_dwordx4 v[60:63], v1, s[20:23], s3 offen offset:3072 sc1
	s_add_u32 s3, s72, 12288
	buffer_load_dwordx4 v[64:67], v1, s[20:23], s3 offen offset:0 sc1
	buffer_load_dwordx4 v[68:71], v1, s[20:23], s3 offen offset:1024 sc1
	buffer_load_dwordx4 v[72:75], v1, s[20:23], s3 offen offset:2048 sc1
	buffer_load_dwordx4 v[76:79], v1, s[20:23], s3 offen offset:3072 sc1
	s_add_u32 s3, s72, 8192
	buffer_load_dwordx4 v[80:83], v250, s[20:23], s3 offen offset:0 sc1
	buffer_load_dwordx4 v[84:87], v250, s[20:23], s3 offen offset:1024 sc1
	buffer_load_dwordx4 v[88:91], v250, s[20:23], s3 offen offset:2048 sc1
	buffer_load_dwordx4 v[92:95], v250, s[20:23], s3 offen offset:3072 sc1
	s_waitcnt vmcnt(0)
	s_branch L_back22
L_slow23:
L_spin23:
	s_sleep 2
	s_add_u32 s3, s72, 24576
	buffer_load_dwordx4 v[56:59], v1, s[20:23], s3 offen offset:2048 sc1
	buffer_load_dwordx4 v[60:63], v1, s[20:23], s3 offen offset:3072 sc1
	s_waitcnt vmcnt(0)
	v_bitop3_b32 v56, v56, v251, s66 bitop3:0x78
	v_bitop3_b32 v60, v60, v251, s66 bitop3:0x78
	v_bitop3_b32 v57, v57, v252, s66 bitop3:0x78
	v_bitop3_b32 v61, v61, v252, s66 bitop3:0x78
	v_or3_b32 v254, v56, v60, v57
	v_bitop3_b32 v254, v254, v61, s66 bitop3:0xa8
	v_cmp_ne_u32 vcc, 0, v254
	s_add_u32 s69, s69, 1
	s_nop 1
	s_cbranch_vccz L_rest23
	s_cmp_lt_u32 s69, 0x10000
	s_cbranch_scc1 L_spin23
L_rest23:
	s_add_u32 s3, s72, 12288
	buffer_load_dwordx4 v[64:67], v1, s[20:23], s3 offen offset:0 sc1
	buffer_load_dwordx4 v[68:71], v1, s[20:23], s3 offen offset:1024 sc1
	buffer_load_dwordx4 v[72:75], v1, s[20:23], s3 offen offset:2048 sc1
	buffer_load_dwordx4 v[76:79], v1, s[20:23], s3 offen offset:3072 sc1
	s_add_u32 s3, s72, 8192
	buffer_load_dwordx4 v[80:83], v250, s[20:23], s3 offen offset:0 sc1
	buffer_load_dwordx4 v[84:87], v250, s[20:23], s3 offen offset:1024 sc1
	buffer_load_dwordx4 v[88:91], v250, s[20:23], s3 offen offset:2048 sc1
	buffer_load_dwordx4 v[92:95], v250, s[20:23], s3 offen offset:3072 sc1
	s_add_u32 s3, s72, 24576
	buffer_load_dwordx4 v[32:35], v250, s[20:23], s3 offen offset:0 sc1
	buffer_load_dwordx4 v[36:39], v250, s[20:23], s3 offen offset:1024 sc1
	s_waitcnt vmcnt(0)
	s_branch L_back23
L_slow24:
L_spin24:
	s_sleep 2
	s_add_u32 s3, s72, 12288
	buffer_load_dwordx4 v[64:67], v1, s[20:23], s3 offen offset:0 sc1
	buffer_load_dwordx4 v[68:71], v1, s[20:23], s3 offen offset:1024 sc1
	s_waitcnt vmcnt(0)
	v_bitop3_b32 v64, v64, v251, s66 bitop3:0x78
	v_bitop3_b32 v68, v68, v251, s66 bitop3:0x78
	v_bitop3_b32 v65, v65, v252, s66 bitop3:0x78
	v_bitop3_b32 v69, v69, v252, s66 bitop3:0x78
	v_or3_b32 v254, v64, v68, v65
	v_bitop3_b32 v254, v254, v69, s66 bitop3:0xa8
	v_cmp_ne_u32 vcc, 0, v254
	s_add_u32 s69, s69, 1
	s_nop 1
	s_cbranch_vccz L_rest24
	s_cmp_lt_u32 s69, 0x10000
	s_cbranch_scc1 L_spin24
L_rest24:
	buffer_load_dwordx4 v[72:75], v1, s[20:23], s3 offen offset:2048 sc1
	buffer_load_dwordx4 v[76:79], v1, s[20:23], s3 offen offset:3072 sc1
	s_add_u32 s3, s72, 8192
	buffer_load_dwordx4 v[80:83], v250, s[20:23], s3 offen offset:0 sc1
	buffer_load_dwordx4 v[84:87], v250, s[20:23], s3 offen offset:1024 sc1
	buffer_load_dwordx4 v[88:91], v250, s[20:23], s3 offen offset:2048 sc1
	buffer_load_dwordx4 v[92:95], v250, s[20:23], s3 offen offset:3072 sc1
	s_add_u32 s3, s72, 24576
	buffer_load_dwordx4 v[32:35], v250, s[20:23], s3 offen offset:0 sc1
	buffer_load_dwordx4 v[36:39], v250, s[20:23], s3 offen offset:1024 sc1
	buffer_load_dwordx4 v[40:43], v250, s[20:23], s3 offen offset:2048 sc1
	buffer_load_dwordx4 v[44:47], v250, s[20:23], s3 offen offset:3072 sc1
	s_waitcnt vmcnt(0)
	s_branch L_back24
L_slow25:
L_spin25:
	s_sleep 2
	s_add_u32 s3, s72, 12288
	buffer_load_dwordx4 v[72:75], v1, s[20:23], s3 offen offset:2048 sc1
	buffer_load_dwordx4 v[76:79], v1, s[20:23], s3 offen offset:3072 sc1
	s_waitcnt vmcnt(0)
	v_bitop3_b32 v72, v72, v251, s66 bitop3:0x78
	v_bitop3_b32 v76, v76, v251, s66 bitop3:0x78
	v_bitop3_b32 v73, v73, v252, s66 bitop3:0x78
	v_bitop3_b32 v77, v77, v252, s66 bitop3:0x78
	v_or3_b32 v254, v72, v76, v73
	v_bitop3_b32 v254, v254, v77, s66 bitop3:0xa8
	v_cmp_ne_u32 vcc, 0, v254
	s_add_u32 s69, s69, 1
	s_nop 1
	s_cbranch_vccz L_rest25
	s_cmp_lt_u32 s69, 0x10000
	s_cbranch_scc1 L_spin25
L_rest25:
	s_add_u32 s3, s72, 8192
	buffer_load_dwordx4 v[80:83], v250, s[20:23], s3 offen offset:0 sc1
	buffer_load_dwordx4 v[84:87], v250, s[20:23], s3 offen offset:1024 sc1
	buffer_load_dwordx4 v[88:91], v250, s[20:23], s3 offen offset:2048 sc1
	buffer_load_dwordx4 v[92:95], v250, s[20:23], s3 offen offset:3072 sc1
	s_add_u32 s3, s72, 24576
	buffer_load_dwordx4 v[32:35], v250, s[20:23], s3 offen offset:0 sc1
	buffer_load_dwordx4 v[36:39], v250, s[20:23], s3 offen offset:1024 sc1
	buffer_load_dwordx4 v[40:43], v250, s[20:23], s3 offen offset:2048 sc1
	buffer_load_dwordx4 v[44:47], v250, s[20:23], s3 offen offset:3072 sc1
	s_add_u32 s3, s72, 12288
	buffer_load_dwordx4 v[48:51], v250, s[20:23], s3 offen offset:0 sc1
	buffer_load_dwordx4 v[52:55], v250, s[20:23], s3 offen offset:1024 sc1
	s_waitcnt vmcnt(0)
	s_branch L_back25
L_slow26:
L_spin26:
	s_sleep 2
	buffer_load_dwordx4 v[240:243], v14, s[20:23], s47 offen sc1
	buffer_load_dwordx4 v[244:247], v14, s[20:23], s47 offen offset:512 sc1
	s_waitcnt vmcnt(0)
	v_cmp_ne_u64 vcc, s[60:61], v[240:241]
	v_cmp_ne_u64 s[84:85], s[60:61], v[244:245]
	s_nop 0
	s_or_b64 vcc, vcc, s[84:85]
	s_add_u32 s69, s69, 1
	s_nop 1
	s_cbranch_vccz L_back26
	s_cmp_lt_u32 s69, 0x10000
	s_cbranch_scc1 L_spin26
	s_branch L_back26
L_slow27:
L_spin27:
	s_sleep 2
	s_add_u32 s3, s72, 8192
	buffer_load_dwordx4 v[80:83], v250, s[20:23], s3 offen offset:0 sc1
	buffer_load_dwordx4 v[84:87], v250, s[20:23], s3 offen offset:1024 sc1
	s_waitcnt vmcnt(0)
	v_bitop3_b32 v80, v80, v251, s66 bitop3:0x78
	v_bitop3_b32 v84, v84, v251, s66 bitop3:0x78
	v_bitop3_b32 v81, v81, v252, s66 bitop3:0x78
	v_bitop3_b32 v85, v85, v252, s66 bitop3:0x78
	v_or3_b32 v254, v80, v84, v81
	v_bitop3_b32 v254, v254, v85, s66 bitop3:0xa8
	v_cmp_ne_u32 vcc, 0, v254
	s_add_u32 s69, s69, 1
	s_nop 1
	s_cbranch_vccz L_rest27
	s_cmp_lt_u32 s69, 0x10000
	s_cbranch_scc1 L_spin27
L_rest27:
	buffer_load_dwordx4 v[88:91], v250, s[20:23], s3 offen offset:2048 sc1
	buffer_load_dwordx4 v[92:95], v250, s[20:23], s3 offen offset:3072 sc1
	s_add_u32 s3, s72, 24576
	buffer_load_dwordx4 v[32:35], v250, s[20:23], s3 offen offset:0 sc1
	buffer_load_dwordx4 v[36:39], v250, s[20:23], s3 offen offset:1024 sc1
	buffer_load_dwordx4 v[40:43], v250, s[20:23], s3 offen offset:2048 sc1
	buffer_load_dwordx4 v[44:47], v250, s[20:23], s3 offen offset:3072 sc1
	s_add_u32 s3, s72, 12288
	buffer_load_dwordx4 v[48:51], v250, s[20:23], s3 offen offset:0 sc1
	buffer_load_dwordx4 v[52:55], v250, s[20:23], s3 offen offset:1024 sc1
	buffer_load_dwordx4 v[56:59], v250, s[20:23], s3 offen offset:2048 sc1
	buffer_load_dwordx4 v[60:63], v250, s[20:23], s3 offen offset:3072 sc1
	s_waitcnt vmcnt(0)
	s_branch L_back27
L_slow28:
L_spin28:
	s_sleep 2
	s_add_u32 s3, s72, 8192
	buffer_load_dwordx4 v[88:91], v250, s[20:23], s3 offen offset:2048 sc1
	buffer_load_dwordx4 v[92:95], v250, s[20:23], s3 offen offset:3072 sc1
	s_waitcnt vmcnt(0)
	v_bitop3_b32 v88, v88, v251, s66 bitop3:0x78
	v_bitop3_b32 v92, v92, v251, s66 bitop3:0x78
	v_bitop3_b32 v89, v89, v252, s66 bitop3:0x78
	v_bitop3_b32 v93, v93, v252, s66 bitop3:0x78
	v_or3_b32 v254, v88, v92, v89
	v_bitop3_b32 v254, v254, v93, s66 bitop3:0xa8
	v_cmp_ne_u32 vcc, 0, v254
	s_add_u32 s69, s69, 1
	s_nop 1
	s_cbranch_vccz L_rest28
	s_cmp_lt_u32 s69, 0x10000
	s_cbranch_scc1 L_spin28
L_rest28:
	s_add_u32 s3, s72, 24576
	buffer_load_dwordx4 v[32:35], v250, s[20:23], s3 offen offset:0 sc1
	buffer_load_dwordx4 v[36:39], v250, s[20:23], s3 offen offset:1024 sc1
	buffer_load_dwordx4 v[40:43], v250, s[20:23], s3 offen offset:2048 sc1
	buffer_load_dwordx4 v[44:47], v250, s[20:23], s3 offen offset:3072 sc1
	s_add_u32 s3, s72, 12288
	buffer_load_dwordx4 v[48:51], v250, s[20:23], s3 offen offset:0 sc1
	buffer_load_dwordx4 v[52:55], v250, s[20:23], s3 offen offset:1024 sc1
	buffer_load_dwordx4 v[56:59], v250, s[20:23], s3 offen offset:2048 sc1
	buffer_load_dwordx4 v[60:63], v250, s[20:23], s3 offen offset:3072 sc1
	s_add_u32 s3, s73, 0
	buffer_load_dwordx4 v[64:67], v1, s[20:23], s3 offen offset:0 sc1
	buffer_load_dwordx4 v[68:71], v1, s[20:23], s3 offen offset:1024 sc1
	s_waitcnt vmcnt(0)
	s_branch L_back28
L_slow29:
L_spin29:
	s_sleep 2
	s_add_u32 s3, s72, 24576
	buffer_load_dwordx4 v[32:35], v250, s[20:23], s3 offen offset:0 sc1
	buffer_load_dwordx4 v[36:39], v250, s[20:23], s3 offen offset:1024 sc1
	s_waitcnt vmcnt(0)
	v_bitop3_b32 v32, v32, v251, s66 bitop3:0x78
	v_bitop3_b32 v36, v36, v251, s66 bitop3:0x78
	v_bitop3_b32 v33, v33, v252, s66 bitop3:0x78
	v_bitop3_b32 v37, v37, v252, s66 bitop3:0x78
	v_or3_b32 v254, v32, v36, v33
	v_bitop3_b32 v254, v254, v37, s66 bitop3:0xa8
	v_cmp_ne_u32 vcc, 0, v254
	s_add_u32 s69, s69, 1
	s_nop 1
	s_cbranch_vccz L_rest29
	s_cmp_lt_u32 s69, 0x10000
	s_cbranch_scc1 L_spin29
L_rest29:
	buffer_load_dwordx4 v[40:43], v250, s[20:23], s3 offen offset:2048 sc1
	buffer_load_dwordx4 v[44:47], v250, s[20:23], s3 offen offset:3072 sc1
	s_add_u32 s3, s72, 12288
	buffer_load_dwordx4 v[48:51], v250, s[20:23], s3 offen offset:0 sc1
	buffer_load_dwordx4 v[52:55], v250, s[20:23], s3 offen offset:1024 sc1
	buffer_load_dwordx4 v[56:59], v250, s[20:23], s3 offen offset:2048 sc1
	buffer_load_dwordx4 v[60:63], v250, s[20:23], s3 offen offset:3072 sc1
	s_add_u32 s3, s73, 0
	buffer_load_dwordx4 v[64:67], v1, s[20:23], s3 offen offset:0 sc1
	buffer_load_dwordx4 v[68:71], v1, s[20:23], s3 offen offset:1024 sc1
	buffer_load_dwordx4 v[72:75], v1, s[20:23], s3 offen offset:2048 sc1
	buffer_load_dwordx4 v[76:79], v1, s[20:23], s3 offen offset:3072 sc1
	s_waitcnt vmcnt(0)
	s_branch L_back29
L_slow30:
L_spin30:
	s_sleep 2
	s_add_u32 s3, s72, 24576
	buffer_load_dwordx4 v[40:43], v250, s[20:23], s3 offen offset:2048 sc1
	buffer_load_dwordx4 v[44:47], v250, s[20:23], s3 offen offset:3072 sc1
	s_waitcnt vmcnt(0)
	v_bitop3_b32 v40, v40, v251, s66 bitop3:0x78
	v_bitop3_b32 v44, v44, v251, s66 bitop3:0x78
	v_bitop3_b32 v41, v41, v252, s66 bitop3:0x78
	v_bitop3_b32 v45, v45, v252, s66 bitop3:0x78
	v_or3_b32 v254, v40, v44, v41
	v_bitop3_b32 v254, v254, v45, s66 bitop3:0xa8
	v_cmp_ne_u32 vcc, 0, v254
	s_add_u32 s69, s69, 1
	s_nop 1
	s_cbranch_vccz L_rest30
	s_cmp_lt_u32 s69, 0x10000
	s_cbranch_scc1 L_spin30
L_rest30:
	s_add_u32 s3, s72, 12288
	buffer_load_dwordx4 v[48:51], v250, s[20:23], s3 offen offset:0 sc1
	buffer_load_dwordx4 v[52:55], v250, s[20:23], s3 offen offset:1024 sc1
	buffer_load_dwordx4 v[56:59], v250, s[20:23], s3 offen offset:2048 sc1
	buffer_load_dwordx4 v[60:63], v250, s[20:23], s3 offen offset:3072 sc1
	s_add_u32 s3, s73, 0
	buffer_load_dwordx4 v[64:67], v1, s[20:23], s3 offen offset:0 sc1
	buffer_load_dwordx4 v[68:71], v1, s[20:23], s3 offen offset:1024 sc1
	buffer_load_dwordx4 v[72:75], v1, s[20:23], s3 offen offset:2048 sc1
	buffer_load_dwordx4 v[76:79], v1, s[20:23], s3 offen offset:3072 sc1
	s_add_u32 s3, s73, 4096
	buffer_load_dwordx4 v[80:83], v1, s[20:23], s3 offen offset:0 sc1
	buffer_load_dwordx4 v[84:87], v1, s[20:23], s3 offen offset:1024 sc1
	s_waitcnt vmcnt(0)
	s_branch L_back30
L_slow31:
L_spin31:
	s_sleep 2
	s_add_u32 s3, s72, 12288
	buffer_load_dwordx4 v[48:51], v250, s[20:23], s3 offen offset:0 sc1
	buffer_load_dwordx4 v[52:55], v250, s[20:23], s3 offen offset:1024 sc1
	s_waitcnt vmcnt(0)
	v_bitop3_b32 v48, v48, v251, s66 bitop3:0x78
	v_bitop3_b32 v52, v52, v251, s66 bitop3:0x78
	v_bitop3_b32 v49, v49, v252, s66 bitop3:0x78
	v_bitop3_b32 v53, v53, v252, s66 bitop3:0x78
	v_or3_b32 v254, v48, v52, v49
	v_bitop3_b32 v254, v254, v53, s66 bitop3:0xa8
	v_cmp_ne_u32 vcc, 0, v254
	s_add_u32 s69, s69, 1
	s_nop 1
	s_cbranch_vccz L_rest31
	s_cmp_lt_u32 s69, 0x10000
	s_cbranch_scc1 L_spin31
L_rest31:
	buffer_load_dwordx4 v[56:59], v250, s[20:23], s3 offen offset:2048 sc1
	buffer_load_dwordx4 v[60:63], v250, s[20:23], s3 offen offset:3072 sc1
	s_add_u32 s3, s73, 0
	buffer_load_dwordx4 v[64:67], v1, s[20:23], s3 offen offset:0 sc1
	buffer_load_dwordx4 v[68:71], v1, s[20:23], s3 offen offset:1024 sc1
	buffer_load_dwordx4 v[72:75], v1, s[20:23], s3 offen offset:2048 sc1
	buffer_load_dwordx4 v[76:79], v1, s[20:23], s3 offen offset:3072 sc1
	s_add_u32 s3, s73, 4096
	buffer_load_dwordx4 v[80:83], v1, s[20:23], s3 offen offset:0 sc1
	buffer_load_dwordx4 v[84:87], v1, s[20:23], s3 offen offset:1024 sc1
	buffer_load_dwordx4 v[88:91], v1, s[20:23], s3 offen offset:2048 sc1
	buffer_load_dwordx4 v[92:95], v1, s[20:23], s3 offen offset:3072 sc1
	s_waitcnt vmcnt(0)
	s_branch L_back31
L_slow32:
L_spin32:
	s_sleep 2
	s_add_u32 s3, s72, 12288
	buffer_load_dwordx4 v[56:59], v250, s[20:23], s3 offen offset:2048 sc1
	buffer_load_dwordx4 v[60:63], v250, s[20:23], s3 offen offset:3072 sc1
	s_waitcnt vmcnt(0)
	v_bitop3_b32 v56, v56, v251, s66 bitop3:0x78
	v_bitop3_b32 v60, v60, v251, s66 bitop3:0x78
	v_bitop3_b32 v57, v57, v252, s66 bitop3:0x78
	v_bitop3_b32 v61, v61, v252, s66 bitop3:0x78
	v_or3_b32 v254, v56, v60, v57
	v_bitop3_b32 v254, v254, v61, s66 bitop3:0xa8
	v_cmp_ne_u32 vcc, 0, v254
	s_add_u32 s69, s69, 1
	s_nop 1
	s_cbranch_vccz L_rest32
	s_cmp_lt_u32 s69, 0x10000
	s_cbranch_scc1 L_spin32
L_rest32:
	s_add_u32 s3, s73, 0
	buffer_load_dwordx4 v[64:67], v1, s[20:23], s3 offen offset:0 sc1
	buffer_load_dwordx4 v[68:71], v1, s[20:23], s3 offen offset:1024 sc1
	buffer_load_dwordx4 v[72:75], v1, s[20:23], s3 offen offset:2048 sc1
	buffer_load_dwordx4 v[76:79], v1, s[20:23], s3 offen offset:3072 sc1
	s_add_u32 s3, s73, 4096
	buffer_load_dwordx4 v[80:83], v1, s[20:23], s3 offen offset:0 sc1
	buffer_load_dwordx4 v[84:87], v1, s[20:23], s3 offen offset:1024 sc1
	buffer_load_dwordx4 v[88:91], v1, s[20:23], s3 offen offset:2048 sc1
	buffer_load_dwordx4 v[92:95], v1, s[20:23], s3 offen offset:3072 sc1
	s_add_u32 s3, s73, 0
	buffer_load_dwordx4 v[32:35], v250, s[20:23], s3 offen offset:0 sc1
	buffer_load_dwordx4 v[36:39], v250, s[20:23], s3 offen offset:1024 sc1
	s_waitcnt vmcnt(0)
	s_branch L_back32
L_slow33:
L_spin33:
	s_sleep 2
	s_add_u32 s3, s73, 0
	buffer_load_dwordx4 v[64:67], v1, s[20:23], s3 offen offset:0 sc1
	buffer_load_dwordx4 v[68:71], v1, s[20:23], s3 offen offset:1024 sc1
	s_waitcnt vmcnt(0)
	v_bitop3_b32 v64, v64, v251, s63 bitop3:0x78
	v_bitop3_b32 v68, v68, v251, s63 bitop3:0x78
	v_bitop3_b32 v65, v65, v252, s63 bitop3:0x78
	v_bitop3_b32 v69, v69, v252, s63 bitop3:0x78
	v_or3_b32 v254, v64, v68, v65
	v_bitop3_b32 v254, v254, v69, s63 bitop3:0xa8
	v_cmp_ne_u32 vcc, 0, v254
	s_add_u32 s69, s69, 1
	s_nop 1
	s_cbranch_vccz L_rest33
	s_cmp_lt_u32 s69, 0x10000
	s_cbranch_scc1 L_spin33
L_rest33:
	buffer_load_dwordx4 v[72:75], v1, s[20:23], s3 offen offset:2048 sc1
	buffer_load_dwordx4 v[76:79], v1, s[20:23], s3 offen offset:3072 sc1
	s_add_u32 s3, s73, 4096
	buffer_load_dwordx4 v[80:83], v1, s[20:23], s3 offen offset:0 sc1
	buffer_load_dwordx4 v[84:87], v1, s[20:23], s3 offen offset:1024 sc1
	buffer_load_dwordx4 v[88:91], v1, s[20:23], s3 offen offset:2048 sc1
	buffer_load_dwordx4 v[92:95], v1, s[20:23], s3 offen offset:3072 sc1
	s_add_u32 s3, s73, 0
	buffer_load_dwordx4 v[32:35], v250, s[20:23], s3 offen offset:0 sc1
	buffer_load_dwordx4 v[36:39], v250, s[20:23], s3 offen offset:1024 sc1
	buffer_load_dwordx4 v[40:43], v250, s[20:23], s3 offen offset:2048 sc1
	buffer_load_dwordx4 v[44:47], v250, s[20:23], s3 offen offset:3072 sc1
	s_waitcnt vmcnt(0)
	s_branch L_back33
L_slow34:
L_spin34:
	s_sleep 2
	s_add_u32 s3, s73, 0
	buffer_load_dwordx4 v[72:75], v1, s[20:23], s3 offen offset:2048 sc1
	buffer_load_dwordx4 v[76:79], v1, s[20:23], s3 offen offset:3072 sc1
	s_waitcnt vmcnt(0)
	v_bitop3_b32 v72, v72, v251, s63 bitop3:0x78
	v_bitop3_b32 v76, v76, v251, s63 bitop3:0x78
	v_bitop3_b32 v73, v73, v252, s63 bitop3:0x78
	v_bitop3_b32 v77, v77, v252, s63 bitop3:0x78
	v_or3_b32 v254, v72, v76, v73
	v_bitop3_b32 v254, v254, v77, s63 bitop3:0xa8
	v_cmp_ne_u32 vcc, 0, v254
	s_add_u32 s69, s69, 1
	s_nop 1
	s_cbranch_vccz L_rest34
	s_cmp_lt_u32 s69, 0x10000
	s_cbranch_scc1 L_spin34
L_rest34:
	s_add_u32 s3, s73, 4096
	buffer_load_dwordx4 v[80:83], v1, s[20:23], s3 offen offset:0 sc1
	buffer_load_dwordx4 v[84:87], v1, s[20:23], s3 offen offset:1024 sc1
	buffer_load_dwordx4 v[88:91], v1, s[20:23], s3 offen offset:2048 sc1
	buffer_load_dwordx4 v[92:95], v1, s[20:23], s3 offen offset:3072 sc1
	s_add_u32 s3, s73, 0
	buffer_load_dwordx4 v[32:35], v250, s[20:23], s3 offen offset:0 sc1
	buffer_load_dwordx4 v[36:39], v250, s[20:23], s3 offen offset:1024 sc1
	buffer_load_dwordx4 v[40:43], v250, s[20:23], s3 offen offset:2048 sc1
	buffer_load_dwordx4 v[44:47], v250, s[20:23], s3 offen offset:3072 sc1
	s_add_u32 s3, s73, 4096
	buffer_load_dwordx4 v[48:51], v250, s[20:23], s3 offen offset:0 sc1
	buffer_load_dwordx4 v[52:55], v250, s[20:23], s3 offen offset:1024 sc1
	s_waitcnt vmcnt(0)
	s_branch L_back34
L_slow35:
L_spin35:
	s_sleep 2
	s_add_u32 s3, s73, 4096
	buffer_load_dwordx4 v[80:83], v1, s[20:23], s3 offen offset:0 sc1
	buffer_load_dwordx4 v[84:87], v1, s[20:23], s3 offen offset:1024 sc1
	s_waitcnt vmcnt(0)
	v_bitop3_b32 v80, v80, v251, s63 bitop3:0x78
	v_bitop3_b32 v84, v84, v251, s63 bitop3:0x78
	v_bitop3_b32 v81, v81, v252, s63 bitop3:0x78
	v_bitop3_b32 v85, v85, v252, s63 bitop3:0x78
	v_or3_b32 v254, v80, v84, v81
	v_bitop3_b32 v254, v254, v85, s63 bitop3:0xa8
	v_cmp_ne_u32 vcc, 0, v254
	s_add_u32 s69, s69, 1
	s_nop 1
	s_cbranch_vccz L_rest35
	s_cmp_lt_u32 s69, 0x10000
	s_cbranch_scc1 L_spin35
L_rest35:
	buffer_load_dwordx4 v[88:91], v1, s[20:23], s3 offen offset:2048 sc1
	buffer_load_dwordx4 v[92:95], v1, s[20:23], s3 offen offset:3072 sc1
	s_add_u32 s3, s73, 0
	buffer_load_dwordx4 v[32:35], v250, s[20:23], s3 offen offset:0 sc1
	buffer_load_dwordx4 v[36:39], v250, s[20:23], s3 offen offset:1024 sc1
	buffer_load_dwordx4 v[40:43], v250, s[20:23], s3 offen offset:2048 sc1
	buffer_load_dwordx4 v[44:47], v250, s[20:23], s3 offen offset:3072 sc1
	s_add_u32 s3, s73, 4096
	buffer_load_dwordx4 v[48:51], v250, s[20:23], s3 offen offset:0 sc1
	buffer_load_dwordx4 v[52:55], v250, s[20:23], s3 offen offset:1024 sc1
	buffer_load_dwordx4 v[56:59], v250, s[20:23], s3 offen offset:2048 sc1
	buffer_load_dwordx4 v[60:63], v250, s[20:23], s3 offen offset:3072 sc1
	s_waitcnt vmcnt(0)
	s_branch L_back35
L_slow36:
L_spin36:
	s_sleep 2
	s_add_u32 s3, s73, 4096
	buffer_load_dwordx4 v[88:91], v1, s[20:23], s3 offen offset:2048 sc1
	buffer_load_dwordx4 v[92:95], v1, s[20:23], s3 offen offset:3072 sc1
	s_waitcnt vmcnt(0)
	v_bitop3_b32 v88, v88, v251, s63 bitop3:0x78
	v_bitop3_b32 v92, v92, v251, s63 bitop3:0x78
	v_bitop3_b32 v89, v89, v252, s63 bitop3:0x78
	v_bitop3_b32 v93, v93, v252, s63 bitop3:0x78
	v_or3_b32 v254, v88, v92, v89
	v_bitop3_b32 v254, v254, v93, s63 bitop3:0xa8
	v_cmp_ne_u32 vcc, 0, v254
	s_add_u32 s69, s69, 1
	s_nop 1
	s_cbranch_vccz L_rest36
	s_cmp_lt_u32 s69, 0x10000
	s_cbranch_scc1 L_spin36
L_rest36:
	s_add_u32 s3, s73, 0
	buffer_load_dwordx4 v[32:35], v250, s[20:23], s3 offen offset:0 sc1
	buffer_load_dwordx4 v[36:39], v250, s[20:23], s3 offen offset:1024 sc1
	buffer_load_dwordx4 v[40:43], v250, s[20:23], s3 offen offset:2048 sc1
	buffer_load_dwordx4 v[44:47], v250, s[20:23], s3 offen offset:3072 sc1
	s_add_u32 s3, s73, 4096
	buffer_load_dwordx4 v[48:51], v250, s[20:23], s3 offen offset:0 sc1
	buffer_load_dwordx4 v[52:55], v250, s[20:23], s3 offen offset:1024 sc1
	buffer_load_dwordx4 v[56:59], v250, s[20:23], s3 offen offset:2048 sc1
	buffer_load_dwordx4 v[60:63], v250, s[20:23], s3 offen offset:3072 sc1
	s_waitcnt vmcnt(0)
	s_branch L_back36
L_slow37:
L_spin37:
	s_sleep 2
	s_add_u32 s3, s73, 0
	buffer_load_dwordx4 v[32:35], v250, s[20:23], s3 offen offset:0 sc1
	buffer_load_dwordx4 v[36:39], v250, s[20:23], s3 offen offset:1024 sc1
	s_waitcnt vmcnt(0)
	v_bitop3_b32 v32, v32, v251, s63 bitop3:0x78
	v_bitop3_b32 v36, v36, v251, s63 bitop3:0x78
	v_bitop3_b32 v33, v33, v252, s63 bitop3:0x78
	v_bitop3_b32 v37, v37, v252, s63 bitop3:0x78
	v_or3_b32 v254, v32, v36, v33
	v_bitop3_b32 v254, v254, v37, s63 bitop3:0xa8
	v_cmp_ne_u32 vcc, 0, v254
	s_add_u32 s69, s69, 1
	s_nop 1
	s_cbranch_vccz L_rest37
	s_cmp_lt_u32 s69, 0x10000
	s_cbranch_scc1 L_spin37
L_rest37:
	buffer_load_dwordx4 v[40:43], v250, s[20:23], s3 offen offset:2048 sc1
	buffer_load_dwordx4 v[44:47], v250, s[20:23], s3 offen offset:3072 sc1
	s_add_u32 s3, s73, 4096
	buffer_load_dwordx4 v[48:51], v250, s[20:23], s3 offen offset:0 sc1
	buffer_load_dwordx4 v[52:55], v250, s[20:23], s3 offen offset:1024 sc1
	buffer_load_dwordx4 v[56:59], v250, s[20:23], s3 offen offset:2048 sc1
	buffer_load_dwordx4 v[60:63], v250, s[20:23], s3 offen offset:3072 sc1
	s_waitcnt vmcnt(0)
	s_branch L_back37
L_slow38:
L_spin38:
	s_sleep 2
	s_add_u32 s3, s73, 0
	buffer_load_dwordx4 v[40:43], v250, s[20:23], s3 offen offset:2048 sc1
	buffer_load_dwordx4 v[44:47], v250, s[20:23], s3 offen offset:3072 sc1
	s_waitcnt vmcnt(0)
	v_bitop3_b32 v40, v40, v251, s63 bitop3:0x78
	v_bitop3_b32 v44, v44, v251, s63 bitop3:0x78
	v_bitop3_b32 v41, v41, v252, s63 bitop3:0x78
	v_bitop3_b32 v45, v45, v252, s63 bitop3:0x78
	v_or3_b32 v254, v40, v44, v41
	v_bitop3_b32 v254, v254, v45, s63 bitop3:0xa8
	v_cmp_ne_u32 vcc, 0, v254
	s_add_u32 s69, s69, 1
	s_nop 1
	s_cbranch_vccz L_rest38
	s_cmp_lt_u32 s69, 0x10000
	s_cbranch_scc1 L_spin38
L_rest38:
	s_add_u32 s3, s73, 4096
	buffer_load_dwordx4 v[48:51], v250, s[20:23], s3 offen offset:0 sc1
	buffer_load_dwordx4 v[52:55], v250, s[20:23], s3 offen offset:1024 sc1
	buffer_load_dwordx4 v[56:59], v250, s[20:23], s3 offen offset:2048 sc1
	buffer_load_dwordx4 v[60:63], v250, s[20:23], s3 offen offset:3072 sc1
	s_waitcnt vmcnt(0)
	s_branch L_back38
L_slow39:
L_spin39:
	s_sleep 2
	s_add_u32 s3, s73, 4096
	buffer_load_dwordx4 v[48:51], v250, s[20:23], s3 offen offset:0 sc1
	buffer_load_dwordx4 v[52:55], v250, s[20:23], s3 offen offset:1024 sc1
	s_waitcnt vmcnt(0)
	v_bitop3_b32 v48, v48, v251, s63 bitop3:0x78
	v_bitop3_b32 v52, v52, v251, s63 bitop3:0x78
	v_bitop3_b32 v49, v49, v252, s63 bitop3:0x78
	v_bitop3_b32 v53, v53, v252, s63 bitop3:0x78
	v_or3_b32 v254, v48, v52, v49
	v_bitop3_b32 v254, v254, v53, s63 bitop3:0xa8
	v_cmp_ne_u32 vcc, 0, v254
	s_add_u32 s69, s69, 1
	s_nop 1
	s_cbranch_vccz L_rest39
	s_cmp_lt_u32 s69, 0x10000
	s_cbranch_scc1 L_spin39
L_rest39:
	buffer_load_dwordx4 v[56:59], v250, s[20:23], s3 offen offset:2048 sc1
	buffer_load_dwordx4 v[60:63], v250, s[20:23], s3 offen offset:3072 sc1
	s_waitcnt vmcnt(0)
	s_branch L_back39
L_slow40:
L_spin40:
	s_sleep 2
	s_add_u32 s3, s73, 4096
	buffer_load_dwordx4 v[56:59], v250, s[20:23], s3 offen offset:2048 sc1
	buffer_load_dwordx4 v[60:63], v250, s[20:23], s3 offen offset:3072 sc1
	s_waitcnt vmcnt(0)
	v_bitop3_b32 v56, v56, v251, s63 bitop3:0x78
	v_bitop3_b32 v60, v60, v251, s63 bitop3:0x78
	v_bitop3_b32 v57, v57, v252, s63 bitop3:0x78
	v_bitop3_b32 v61, v61, v252, s63 bitop3:0x78
	v_or3_b32 v254, v56, v60, v57
	v_bitop3_b32 v254, v254, v61, s63 bitop3:0xa8
	v_cmp_ne_u32 vcc, 0, v254
	s_add_u32 s69, s69, 1
	s_nop 1
	s_cbranch_vccz L_back40
	s_cmp_lt_u32 s69, 0x10000
	s_cbranch_scc1 L_spin40
	s_branch L_back40
L_slow41:
L_spin41:
	s_sleep 2
	buffer_load_dwordx2 v[254:255], off, s[36:39], 0 sc1
	s_waitcnt vmcnt(0)
	v_cmp_eq_u32 vcc, 0, v255
	s_add_u32 s69, s69, 1
	s_nop 1
	s_cbranch_vccz L_back41
	s_cmp_lt_u32 s69, 0x10000
	s_cbranch_scc1 L_spin41
	s_branch L_back41
L_slow42:
L_spin42:
	s_sleep 2
	buffer_load_dwordx4 v[204:207], v191, s[20:23], s98 offen sc1
	s_waitcnt vmcnt(0)
	v_cmp_ne_u64 vcc, s[60:61], v[204:205]
	s_add_u32 s69, s69, 1
	s_nop 1
	s_cbranch_vccz L_back42
	s_cmp_lt_u32 s69, 0x10000
	s_cbranch_scc1 L_spin42
	s_branch L_back42
L_slow43:
L_spin43:
	s_sleep 2
	s_add_u32 s3, s72, 0
	buffer_load_dwordx4 v[32:35], v1, s[20:23], s3 offen offset:0 sc1
	buffer_load_dwordx4 v[36:39], v250, s[20:23], s3 offen offset:0 sc1
	s_waitcnt vmcnt(0)
	v_bitop3_b32 v32, v32, v251, s66 bitop3:0x78
	v_bitop3_b32 v36, v36, v251, s66 bitop3:0x78
	v_bitop3_b32 v33, v33, v252, s66 bitop3:0x78
	v_bitop3_b32 v37, v37, v252, s66 bitop3:0x78
	v_or3_b32 v254, v32, v36, v33
	v_bitop3_b32 v254, v254, v37, s66 bitop3:0xa8
	v_cmp_ne_u32 vcc, 0, v254
	s_add_u32 s69, s69, 1
	s_nop 1
	s_cbranch_vccz L_rest43
	s_cmp_lt_u32 s69, 0x10000
	s_cbranch_scc1 L_spin43
L_rest43:
	buffer_load_dwordx4 v[40:43], v1, s[20:23], s3 offen offset:1024 sc1
	buffer_load_dwordx4 v[44:47], v250, s[20:23], s3 offen offset:1024 sc1
	buffer_load_dwordx4 v[48:51], v1, s[20:23], s3 offen offset:2048 sc1
	buffer_load_dwordx4 v[52:55], v250, s[20:23], s3 offen offset:2048 sc1
	buffer_load_dwordx4 v[56:59], v1, s[20:23], s3 offen offset:3072 sc1
	buffer_load_dwordx4 v[60:63], v250, s[20:23], s3 offen offset:3072 sc1
	s_add_u32 s3, s72, 4096
	buffer_load_dwordx4 v[64:67], v1, s[20:23], s3 offen offset:0 sc1
	buffer_load_dwordx4 v[68:71], v250, s[20:23], s3 offen offset:0 sc1
	buffer_load_dwordx4 v[72:75], v1, s[20:23], s3 offen offset:1024 sc1
	buffer_load_dwordx4 v[76:79], v250, s[20:23], s3 offen offset:1024 sc1
	buffer_load_dwordx4 v[80:83], v1, s[20:23], s3 offen offset:2048 sc1
	buffer_load_dwordx4 v[84:87], v250, s[20:23], s3 offen offset:2048 sc1
	s_waitcnt vmcnt(0)
	s_branch L_back43
L_slow44:
L_spin44:
	s_sleep 2
	s_add_u32 s3, s72, 0
	buffer_load_dwordx4 v[40:43], v1, s[20:23], s3 offen offset:1024 sc1
	buffer_load_dwordx4 v[44:47], v250, s[20:23], s3 offen offset:1024 sc1
	s_waitcnt vmcnt(0)
	v_bitop3_b32 v40, v40, v251, s66 bitop3:0x78
	v_bitop3_b32 v44, v44, v251, s66 bitop3:0x78
	v_bitop3_b32 v41, v41, v252, s66 bitop3:0x78
	v_bitop3_b32 v45, v45, v252, s66 bitop3:0x78
	v_or3_b32 v254, v40, v44, v41
	v_bitop3_b32 v254, v254, v45, s66 bitop3:0xa8
	v_cmp_ne_u32 vcc, 0, v254
	s_add_u32 s69, s69, 1
	s_nop 1
	s_cbranch_vccz L_rest44
	s_cmp_lt_u32 s69, 0x10000
	s_cbranch_scc1 L_spin44
L_rest44:
	buffer_load_dwordx4 v[48:51], v1, s[20:23], s3 offen offset:2048 sc1
	buffer_load_dwordx4 v[52:55], v250, s[20:23], s3 offen offset:2048 sc1
	buffer_load_dwordx4 v[56:59], v1, s[20:23], s3 offen offset:3072 sc1
	buffer_load_dwordx4 v[60:63], v250, s[20:23], s3 offen offset:3072 sc1
	s_add_u32 s3, s72, 4096
	buffer_load_dwordx4 v[64:67], v1, s[20:23], s3 offen offset:0 sc1
	buffer_load_dwordx4 v[68:71], v250, s[20:23], s3 offen offset:0 sc1
	buffer_load_dwordx4 v[72:75], v1, s[20:23], s3 offen offset:1024 sc1
	buffer_load_dwordx4 v[76:79], v250, s[20:23], s3 offen offset:1024 sc1
	buffer_load_dwordx4 v[80:83], v1, s[20:23], s3 offen offset:2048 sc1
	buffer_load_dwordx4 v[84:87], v250, s[20:23], s3 offen offset:2048 sc1
	s_waitcnt vmcnt(0)
	s_branch L_back44
L_slow45:
L_spin45:
	s_sleep 2
	s_add_u32 s3, s72, 0
	buffer_load_dwordx4 v[48:51], v1, s[20:23], s3 offen offset:2048 sc1
	buffer_load_dwordx4 v[52:55], v250, s[20:23], s3 offen offset:2048 sc1
	s_waitcnt vmcnt(0)
	v_bitop3_b32 v48, v48, v251, s66 bitop3:0x78
	v_bitop3_b32 v52, v52, v251, s66 bitop3:0x78
	v_bitop3_b32 v49, v49, v252, s66 bitop3:0x78
	v_bitop3_b32 v53, v53, v252, s66 bitop3:0x78
	v_or3_b32 v254, v48, v52, v49
	v_bitop3_b32 v254, v254, v53, s66 bitop3:0xa8
	v_cmp_ne_u32 vcc, 0, v254
	s_add_u32 s69, s69, 1
	s_nop 1
	s_cbranch_vccz L_rest45
	s_cmp_lt_u32 s69, 0x10000
	s_cbranch_scc1 L_spin45
L_rest45:
	buffer_load_dwordx4 v[56:59], v1, s[20:23], s3 offen offset:3072 sc1
	buffer_load_dwordx4 v[60:63], v250, s[20:23], s3 offen offset:3072 sc1
	s_add_u32 s3, s72, 4096
	buffer_load_dwordx4 v[64:67], v1, s[20:23], s3 offen offset:0 sc1
	buffer_load_dwordx4 v[68:71], v250, s[20:23], s3 offen offset:0 sc1
	buffer_load_dwordx4 v[72:75], v1, s[20:23], s3 offen offset:1024 sc1
	buffer_load_dwordx4 v[76:79], v250, s[20:23], s3 offen offset:1024 sc1
	buffer_load_dwordx4 v[80:83], v1, s[20:23], s3 offen offset:2048 sc1
	buffer_load_dwordx4 v[84:87], v250, s[20:23], s3 offen offset:2048 sc1
	buffer_load_dwordx4 v[88:91], v1, s[20:23], s3 offen offset:3072 sc1
	buffer_load_dwordx4 v[92:95], v250, s[20:23], s3 offen offset:3072 sc1
	s_waitcnt vmcnt(0)
	s_branch L_back45
L_slow46:
L_spin46:
	s_sleep 2
	s_add_u32 s3, s72, 0
	buffer_load_dwordx4 v[56:59], v1, s[20:23], s3 offen offset:3072 sc1
	buffer_load_dwordx4 v[60:63], v250, s[20:23], s3 offen offset:3072 sc1
	s_waitcnt vmcnt(0)
	v_bitop3_b32 v56, v56, v251, s66 bitop3:0x78
	v_bitop3_b32 v60, v60, v251, s66 bitop3:0x78
	v_bitop3_b32 v57, v57, v252, s66 bitop3:0x78
	v_bitop3_b32 v61, v61, v252, s66 bitop3:0x78
	v_or3_b32 v254, v56, v60, v57
	v_bitop3_b32 v254, v254, v61, s66 bitop3:0xa8
	v_cmp_ne_u32 vcc, 0, v254
	s_add_u32 s69, s69, 1
	s_nop 1
	s_cbranch_vccz L_rest46
	s_cmp_lt_u32 s69, 0x10000
	s_cbranch_scc1 L_spin46
L_rest46:
	s_add_u32 s3, s72, 4096
	buffer_load_dwordx4 v[64:67], v1, s[20:23], s3 offen offset:0 sc1
	buffer_load_dwordx4 v[68:71], v250, s[20:23], s3 offen offset:0 sc1
	buffer_load_dwordx4 v[72:75], v1, s[20:23], s3 offen offset:1024 sc1
	buffer_load_dwordx4 v[76:79], v250, s[20:23], s3 offen offset:1024 sc1
	buffer_load_dwordx4 v[80:83], v1, s[20:23], s3 offen offset:2048 sc1
	buffer_load_dwordx4 v[84:87], v250, s[20:23], s3 offen offset:2048 sc1
	buffer_load_dwordx4 v[88:91], v1, s[20:23], s3 offen offset:3072 sc1
	buffer_load_dwordx4 v[92:95], v250, s[20:23], s3 offen offset:3072 sc1
	s_add_u32 s3, s72, 16384
	buffer_load_dwordx4 v[32:35], v1, s[20:23], s3 offen offset:0 sc1
	buffer_load_dwordx4 v[36:39], v250, s[20:23], s3 offen offset:0 sc1
	s_waitcnt vmcnt(0)
	s_branch L_back46
L_slow47:
L_spin47:
	s_sleep 2
	s_add_u32 s3, s72, 4096
	buffer_load_dwordx4 v[64:67], v1, s[20:23], s3 offen offset:0 sc1
	buffer_load_dwordx4 v[68:71], v250, s[20:23], s3 offen offset:0 sc1
	s_waitcnt vmcnt(0)
	v_bitop3_b32 v64, v64, v251, s66 bitop3:0x78
	v_bitop3_b32 v68, v68, v251, s66 bitop3:0x78
	v_bitop3_b32 v65, v65, v252, s66 bitop3:0x78
	v_bitop3_b32 v69, v69, v252, s66 bitop3:0x78
	v_or3_b32 v254, v64, v68, v65
	v_bitop3_b32 v254, v254, v69, s66 bitop3:0xa8
	v_cmp_ne_u32 vcc, 0, v254
	s_add_u32 s69, s69, 1
	s_nop 1
	s_cbranch_vccz L_rest47
	s_cmp_lt_u32 s69, 0x10000
	s_cbranch_scc1 L_spin47
L_rest47:
	buffer_load_dwordx4 v[72:75], v1, s[20:23], s3 offen offset:1024 sc1
	buffer_load_dwordx4 v[76:79], v250, s[20:23], s3 offen offset:1024 sc1
	buffer_load_dwordx4 v[80:83], v1, s[20:23], s3 offen offset:2048 sc1
	buffer_load_dwordx4 v[84:87], v250, s[20:23], s3 offen offset:2048 sc1
	buffer_load_dwordx4 v[88:91], v1, s[20:23], s3 offen offset:3072 sc1
	buffer_load_dwordx4 v[92:95], v250, s[20:23], s3 offen offset:3072 sc1
	s_add_u32 s3, s72, 16384
	buffer_load_dwordx4 v[32:35], v1, s[20:23], s3 offen offset:0 sc1
	buffer_load_dwordx4 v[36:39], v250, s[20:23], s3 offen offset:0 sc1
	buffer_load_dwordx4 v[40:43], v1, s[20:23], s3 offen offset:1024 sc1
	s_waitcnt vmcnt(0)
	s_branch L_back47
L_slow48:
L_spin48:
	s_sleep 2
	s_add_u32 s3, s72, 4096
	buffer_load_dwordx4 v[72:75], v1, s[20:23], s3 offen offset:1024 sc1
	buffer_load_dwordx4 v[76:79], v250, s[20:23], s3 offen offset:1024 sc1
	s_waitcnt vmcnt(0)
	v_bitop3_b32 v72, v72, v251, s66 bitop3:0x78
	v_bitop3_b32 v76, v76, v251, s66 bitop3:0x78
	v_bitop3_b32 v73, v73, v252, s66 bitop3:0x78
	v_bitop3_b32 v77, v77, v252, s66 bitop3:0x78
	v_or3_b32 v254, v72, v76, v73
	v_bitop3_b32 v254, v254, v77, s66 bitop3:0xa8
	v_cmp_ne_u32 vcc, 0, v254
	s_add_u32 s69, s69, 1
	s_nop 1
	s_cbranch_vccz L_rest48
	s_cmp_lt_u32 s69, 0x10000
	s_cbranch_scc1 L_spin48
L_rest48:
	buffer_load_dwordx4 v[80:83], v1, s[20:23], s3 offen offset:2048 sc1
	buffer_load_dwordx4 v[84:87], v250, s[20:23], s3 offen offset:2048 sc1
	buffer_load_dwordx4 v[88:91], v1, s[20:23], s3 offen offset:3072 sc1
	buffer_load_dwordx4 v[92:95], v250, s[20:23], s3 offen offset:3072 sc1
	s_add_u32 s3, s72, 16384
	buffer_load_dwordx4 v[32:35], v1, s[20:23], s3 offen offset:0 sc1
	buffer_load_dwordx4 v[36:39], v250, s[20:23], s3 offen offset:0 sc1
	buffer_load_dwordx4 v[40:43], v1, s[20:23], s3 offen offset:1024 sc1
	buffer_load_dwordx4 v[44:47], v250, s[20:23], s3 offen offset:1024 sc1
	buffer_load_dwordx4 v[48:51], v1, s[20:23], s3 offen offset:2048 sc1
	buffer_load_dwordx4 v[52:55], v250, s[20:23], s3 offen offset:2048 sc1
	s_waitcnt vmcnt(0)
	s_branch L_back48
L_slow49:
L_spin49:
	s_sleep 2
	s_add_u32 s3, s72, 4096
	buffer_load_dwordx4 v[80:83], v1, s[20:23], s3 offen offset:2048 sc1
	buffer_load_dwordx4 v[84:87], v250, s[20:23], s3 offen offset:2048 sc1
	s_waitcnt vmcnt(0)
	v_bitop3_b32 v80, v80, v251, s66 bitop3:0x78
	v_bitop3_b32 v84, v84, v251, s66 bitop3:0x78
	v_bitop3_b32 v81, v81, v252, s66 bitop3:0x78
	v_bitop3_b32 v85, v85, v252, s66 bitop3:0x78
	v_or3_b32 v254, v80, v84, v81
	v_bitop3_b32 v254, v254, v85, s66 bitop3:0xa8
	v_cmp_ne_u32 vcc, 0, v254
	s_add_u32 s69, s69, 1
	s_nop 1
	s_cbranch_vccz L_rest49
	s_cmp_lt_u32 s69, 0x10000
	s_cbranch_scc1 L_spin49
L_rest49:
	buffer_load_dwordx4 v[88:91], v1, s[20:23], s3 offen offset:3072 sc1
	buffer_load_dwordx4 v[92:95], v250, s[20:23], s3 offen offset:3072 sc1
	s_add_u32 s3, s72, 16384
	buffer_load_dwordx4 v[32:35], v1, s[20:23], s3 offen offset:0 sc1
	buffer_load_dwordx4 v[36:39], v250, s[20:23], s3 offen offset:0 sc1
	buffer_load_dwordx4 v[40:43], v1, s[20:23], s3 offen offset:1024 sc1
	buffer_load_dwordx4 v[44:47], v250, s[20:23], s3 offen offset:1024 sc1
	buffer_load_dwordx4 v[48:51], v1, s[20:23], s3 offen offset:2048 sc1
	buffer_load_dwordx4 v[52:55], v250, s[20:23], s3 offen offset:2048 sc1
	buffer_load_dwordx4 v[56:59], v1, s[20:23], s3 offen offset:3072 sc1
	buffer_load_dwordx4 v[60:63], v250, s[20:23], s3 offen offset:3072 sc1
	s_waitcnt vmcnt(0)
	s_branch L_back49
L_slow50:
L_spin50:
	s_sleep 2
	s_add_u32 s3, s72, 4096
	buffer_load_dwordx4 v[88:91], v1, s[20:23], s3 offen offset:3072 sc1
	buffer_load_dwordx4 v[92:95], v250, s[20:23], s3 offen offset:3072 sc1
	s_waitcnt vmcnt(0)
	v_bitop3_b32 v88, v88, v251, s66 bitop3:0x78
	v_bitop3_b32 v92, v92, v251, s66 bitop3:0x78
	v_bitop3_b32 v89, v89, v252, s66 bitop3:0x78
	v_bitop3_b32 v93, v93, v252, s66 bitop3:0x78
	v_or3_b32 v254, v88, v92, v89
	v_bitop3_b32 v254, v254, v93, s66 bitop3:0xa8
	v_cmp_ne_u32 vcc, 0, v254
	s_add_u32 s69, s69, 1
	s_nop 1
	s_cbranch_vccz L_rest50
	s_cmp_lt_u32 s69, 0x10000
	s_cbranch_scc1 L_spin50
L_rest50:
	s_add_u32 s3, s72, 16384
	buffer_load_dwordx4 v[32:35], v1, s[20:23], s3 offen offset:0 sc1
	buffer_load_dwordx4 v[36:39], v250, s[20:23], s3 offen offset:0 sc1
	buffer_load_dwordx4 v[40:43], v1, s[20:23], s3 offen offset:1024 sc1
	buffer_load_dwordx4 v[44:47], v250, s[20:23], s3 offen offset:1024 sc1
	buffer_load_dwordx4 v[48:51], v1, s[20:23], s3 offen offset:2048 sc1
	buffer_load_dwordx4 v[52:55], v250, s[20:23], s3 offen offset:2048 sc1
	buffer_load_dwordx4 v[56:59], v1, s[20:23], s3 offen offset:3072 sc1
	buffer_load_dwordx4 v[60:63], v250, s[20:23], s3 offen offset:3072 sc1
	s_add_u32 s3, s72, 20480
	buffer_load_dwordx4 v[64:67], v1, s[20:23], s3 offen offset:0 sc1
	buffer_load_dwordx4 v[68:71], v250, s[20:23], s3 offen offset:0 sc1
	s_waitcnt vmcnt(0)
	s_branch L_back50
L_slow51:
L_spin51:
	s_sleep 2
	s_add_u32 s3, s72, 16384
	buffer_load_dwordx4 v[32:35], v1, s[20:23], s3 offen offset:0 sc1
	buffer_load_dwordx4 v[36:39], v250, s[20:23], s3 offen offset:0 sc1
	s_waitcnt vmcnt(0)
	v_bitop3_b32 v32, v32, v251, s66 bitop3:0x78
	v_bitop3_b32 v36, v36, v251, s66 bitop3:0x78
	v_bitop3_b32 v33, v33, v252, s66 bitop3:0x78
	v_bitop3_b32 v37, v37, v252, s66 bitop3:0x78
	v_or3_b32 v254, v32, v36, v33
	v_bitop3_b32 v254, v254, v37, s66 bitop3:0xa8
	v_cmp_ne_u32 vcc, 0, v254
	s_add_u32 s69, s69, 1
	s_nop 1
	s_cbranch_vccz L_rest51
	s_cmp_lt_u32 s69, 0x10000
	s_cbranch_scc1 L_spin51
L_rest51:
	buffer_load_dwordx4 v[40:43], v1, s[20:23], s3 offen offset:1024 sc1
	buffer_load_dwordx4 v[44:47], v250, s[20:23], s3 offen offset:1024 sc1
	buffer_load_dwordx4 v[48:51], v1, s[20:23], s3 offen offset:2048 sc1
	buffer_load_dwordx4 v[52:55], v250, s[20:23], s3 offen offset:2048 sc1
	buffer_load_dwordx4 v[56:59], v1, s[20:23], s3 offen offset:3072 sc1
	buffer_load_dwordx4 v[60:63], v250, s[20:23], s3 offen offset:3072 sc1
	s_add_u32 s3, s72, 20480
	buffer_load_dwordx4 v[64:67], v1, s[20:23], s3 offen offset:0 sc1
	buffer_load_dwordx4 v[68:71], v250, s[20:23], s3 offen offset:0 sc1
	buffer_load_dwordx4 v[72:75], v1, s[20:23], s3 offen offset:1024 sc1
	buffer_load_dwordx4 v[76:79], v250, s[20:23], s3 offen offset:1024 sc1
	s_waitcnt vmcnt(0)
	s_branch L_back51
L_slow52:
L_spin52:
	s_sleep 2
	s_add_u32 s3, s72, 16384
	buffer_load_dwordx4 v[40:43], v1, s[20:23], s3 offen offset:1024 sc1
	buffer_load_dwordx4 v[44:47], v250, s[20:23], s3 offen offset:1024 sc1
	s_waitcnt vmcnt(0)
	v_bitop3_b32 v40, v40, v251, s66 bitop3:0x78
	v_bitop3_b32 v44, v44, v251, s66 bitop3:0x78
	v_bitop3_b32 v41, v41, v252, s66 bitop3:0x78
	v_bitop3_b32 v45, v45, v252, s66 bitop3:0x78
	v_or3_b32 v254, v40, v44, v41
	v_bitop3_b32 v254, v254, v45, s66 bitop3:0xa8
	v_cmp_ne_u32 vcc, 0, v254
	s_add_u32 s69, s69, 1
	s_nop 1
	s_cbranch_vccz L_rest52
	s_cmp_lt_u32 s69, 0x10000
	s_cbranch_scc1 L_spin52
L_rest52:
	buffer_load_dwordx4 v[48:51], v1, s[20:23], s3 offen offset:2048 sc1
	buffer_load_dwordx4 v[52:55], v250, s[20:23], s3 offen offset:2048 sc1
	buffer_load_dwordx4 v[56:59], v1, s[20:23], s3 offen offset:3072 sc1
	buffer_load_dwordx4 v[60:63], v250, s[20:23], s3 offen offset:3072 sc1
	s_add_u32 s3, s72, 20480
	buffer_load_dwordx4 v[64:67], v1, s[20:23], s3 offen offset:0 sc1
	buffer_load_dwordx4 v[68:71], v250, s[20:23], s3 offen offset:0 sc1
	buffer_load_dwordx4 v[72:75], v1, s[20:23], s3 offen offset:1024 sc1
	buffer_load_dwordx4 v[76:79], v250, s[20:23], s3 offen offset:1024 sc1
	buffer_load_dwordx4 v[80:83], v1, s[20:23], s3 offen offset:2048 sc1
	buffer_load_dwordx4 v[84:87], v250, s[20:23], s3 offen offset:2048 sc1
	s_waitcnt vmcnt(0)
	s_branch L_back52
L_slow53:
L_spin53:
	s_sleep 2
	s_add_u32 s3, s72, 16384
	buffer_load_dwordx4 v[48:51], v1, s[20:23], s3 offen offset:2048 sc1
	buffer_load_dwordx4 v[52:55], v250, s[20:23], s3 offen offset:2048 sc1
	s_waitcnt vmcnt(0)
	v_bitop3_b32 v48, v48, v251, s66 bitop3:0x78
	v_bitop3_b32 v52, v52, v251, s66 bitop3:0x78
	v_bitop3_b32 v49, v49, v252, s66 bitop3:0x78
	v_bitop3_b32 v53, v53, v252, s66 bitop3:0x78
	v_or3_b32 v254, v48, v52, v49
	v_bitop3_b32 v254, v254, v53, s66 bitop3:0xa8
	v_cmp_ne_u32 vcc, 0, v254
	s_add_u32 s69, s69, 1
	s_nop 1
	s_cbranch_vccz L_rest53
	s_cmp_lt_u32 s69, 0x10000
	s_cbranch_scc1 L_spin53
L_rest53:
	buffer_load_dwordx4 v[56:59], v1, s[20:23], s3 offen offset:3072 sc1
	buffer_load_dwordx4 v[60:63], v250, s[20:23], s3 offen offset:3072 sc1
	s_add_u32 s3, s72, 20480
	buffer_load_dwordx4 v[64:67], v1, s[20:23], s3 offen offset:0 sc1
	buffer_load_dwordx4 v[68:71], v250, s[20:23], s3 offen offset:0 sc1
	buffer_load_dwordx4 v[72:75], v1, s[20:23], s3 offen offset:1024 sc1
	buffer_load_dwordx4 v[76:79], v250, s[20:23], s3 offen offset:1024 sc1
	buffer_load_dwordx4 v[80:83], v1, s[20:23], s3 offen offset:2048 sc1
	buffer_load_dwordx4 v[84:87], v250, s[20:23], s3 offen offset:2048 sc1
	buffer_load_dwordx4 v[88:91], v1, s[20:23], s3 offen offset:3072 sc1
	s_waitcnt vmcnt(0)
	s_branch L_back53
L_slow54:
L_spin54:
	s_sleep 2
	s_add_u32 s3, s72, 16384
	buffer_load_dwordx4 v[56:59], v1, s[20:23], s3 offen offset:3072 sc1
	buffer_load_dwordx4 v[60:63], v250, s[20:23], s3 offen offset:3072 sc1
	s_waitcnt vmcnt(0)
	v_bitop3_b32 v56, v56, v251, s66 bitop3:0x78
	v_bitop3_b32 v60, v60, v251, s66 bitop3:0x78
	v_bitop3_b32 v57, v57, v252, s66 bitop3:0x78
	v_bitop3_b32 v61, v61, v252, s66 bitop3:0x78
	v_or3_b32 v254, v56, v60, v57
	v_bitop3_b32 v254, v254, v61, s66 bitop3:0xa8
	v_cmp_ne_u32 vcc, 0, v254
	s_add_u32 s69, s69, 1
	s_nop 1
	s_cbranch_vccz L_rest54
	s_cmp_lt_u32 s69, 0x10000
	s_cbranch_scc1 L_spin54
L_rest54:
	s_add_u32 s3, s72, 20480
	buffer_load_dwordx4 v[64:67], v1, s[20:23], s3 offen offset:0 sc1
	buffer_load_dwordx4 v[68:71], v250, s[20:23], s3 offen offset:0 sc1
	buffer_load_dwordx4 v[72:75], v1, s[20:23], s3 offen offset:1024 sc1
	buffer_load_dwordx4 v[76:79], v250, s[20:23], s3 offen offset:1024 sc1
	buffer_load_dwordx4 v[80:83], v1, s[20:23], s3 offen offset:2048 sc1
	buffer_load_dwordx4 v[84:87], v250, s[20:23], s3 offen offset:2048 sc1
	buffer_load_dwordx4 v[88:91], v1, s[20:23], s3 offen offset:3072 sc1
	buffer_load_dwordx4 v[92:95], v250, s[20:23], s3 offen offset:3072 sc1
	s_add_u32 s3, s72, 8192
	buffer_load_dwordx4 v[32:35], v1, s[20:23], s3 offen offset:0 sc1
	buffer_load_dwordx4 v[36:39], v1, s[20:23], s3 offen offset:1024 sc1
	s_waitcnt vmcnt(0)
	s_branch L_back54
L_slow55:
L_spin55:
	s_sleep 2
	s_add_u32 s3, s72, 20480
	buffer_load_dwordx4 v[64:67], v1, s[20:23], s3 offen offset:0 sc1
	buffer_load_dwordx4 v[68:71], v250, s[20:23], s3 offen offset:0 sc1
	s_waitcnt vmcnt(0)
	v_bitop3_b32 v64, v64, v251, s66 bitop3:0x78
	v_bitop3_b32 v68, v68, v251, s66 bitop3:0x78
	v_bitop3_b32 v65, v65, v252, s66 bitop3:0x78
	v_bitop3_b32 v69, v69, v252, s66 bitop3:0x78
	v_or3_b32 v254, v64, v68, v65
	v_bitop3_b32 v254, v254, v69, s66 bitop3:0xa8
	v_cmp_ne_u32 vcc, 0, v254
	s_add_u32 s69, s69, 1
	s_nop 1
	s_cbranch_vccz L_rest55
	s_cmp_lt_u32 s69, 0x10000
	s_cbranch_scc1 L_spin55
L_rest55:
	buffer_load_dwordx4 v[72:75], v1, s[20:23], s3 offen offset:1024 sc1
	buffer_load_dwordx4 v[76:79], v250, s[20:23], s3 offen offset:1024 sc1
	buffer_load_dwordx4 v[80:83], v1, s[20:23], s3 offen offset:2048 sc1
	buffer_load_dwordx4 v[84:87], v250, s[20:23], s3 offen offset:2048 sc1
	buffer_load_dwordx4 v[88:91], v1, s[20:23], s3 offen offset:3072 sc1
	buffer_load_dwordx4 v[92:95], v250, s[20:23], s3 offen offset:3072 sc1
	s_add_u32 s3, s72, 8192
	buffer_load_dwordx4 v[32:35], v1, s[20:23], s3 offen offset:0 sc1
	buffer_load_dwordx4 v[36:39], v1, s[20:23], s3 offen offset:1024 sc1
	buffer_load_dwordx4 v[40:43], v1, s[20:23], s3 offen offset:2048 sc1
	buffer_load_dwordx4 v[44:47], v1, s[20:23], s3 offen offset:3072 sc1
	s_waitcnt vmcnt(0)
	s_branch L_back55
L_slow56:
L_spin56:
	s_sleep 2
	s_add_u32 s3, s72, 20480
	buffer_load_dwordx4 v[72:75], v1, s[20:23], s3 offen offset:1024 sc1
	buffer_load_dwordx4 v[76:79], v250, s[20:23], s3 offen offset:1024 sc1
	s_waitcnt vmcnt(0)
	v_bitop3_b32 v72, v72, v251, s66 bitop3:0x78
	v_bitop3_b32 v76, v76, v251, s66 bitop3:0x78
	v_bitop3_b32 v73, v73, v252, s66 bitop3:0x78
	v_bitop3_b32 v77, v77, v252, s66 bitop3:0x78
	v_or3_b32 v254, v72, v76, v73
	v_bitop3_b32 v254, v254, v77, s66 bitop3:0xa8
	v_cmp_ne_u32 vcc, 0, v254
	s_add_u32 s69, s69, 1
	s_nop 1
	s_cbranch_vccz L_rest56
	s_cmp_lt_u32 s69, 0x10000
	s_cbranch_scc1 L_spin56
L_rest56:
	buffer_load_dwordx4 v[80:83], v1, s[20:23], s3 offen offset:2048 sc1
	buffer_load_dwordx4 v[84:87], v250, s[20:23], s3 offen offset:2048 sc1
	buffer_load_dwordx4 v[88:91], v1, s[20:23], s3 offen offset:3072 sc1
	buffer_load_dwordx4 v[92:95], v250, s[20:23], s3 offen offset:3072 sc1
	s_add_u32 s3, s72, 8192
	buffer_load_dwordx4 v[32:35], v1, s[20:23], s3 offen offset:0 sc1
	buffer_load_dwordx4 v[36:39], v1, s[20:23], s3 offen offset:1024 sc1
	buffer_load_dwordx4 v[40:43], v1, s[20:23], s3 offen offset:2048 sc1
	buffer_load_dwordx4 v[44:47], v1, s[20:23], s3 offen offset:3072 sc1
	s_add_u32 s3, s72, 24576
	buffer_load_dwordx4 v[48:51], v1, s[20:23], s3 offen offset:0 sc1
	s_waitcnt vmcnt(0)
	s_branch L_back56
L_slow57:
L_spin57:
	s_sleep 2
	s_add_u32 s3, s72, 20480
	buffer_load_dwordx4 v[80:83], v1, s[20:23], s3 offen offset:2048 sc1
	buffer_load_dwordx4 v[84:87], v250, s[20:23], s3 offen offset:2048 sc1
	s_waitcnt vmcnt(0)
	v_bitop3_b32 v80, v80, v251, s66 bitop3:0x78
	v_bitop3_b32 v84, v84, v251, s66 bitop3:0x78
	v_bitop3_b32 v81, v81, v252, s66 bitop3:0x78
	v_bitop3_b32 v85, v85, v252, s66 bitop3:0x78
	v_or3_b32 v254, v80, v84, v81
	v_bitop3_b32 v254, v254, v85, s66 bitop3:0xa8
	v_cmp_ne_u32 vcc, 0, v254
	s_add_u32 s69, s69, 1
	s_nop 1
	s_cbranch_vccz L_rest57
	s_cmp_lt_u32 s69, 0x10000
	s_cbranch_scc1 L_spin57
L_rest57:
	buffer_load_dwordx4 v[88:91], v1, s[20:23], s3 offen offset:3072 sc1
	buffer_load_dwordx4 v[92:95], v250, s[20:23], s3 offen offset:3072 sc1
	s_add_u32 s3, s72, 8192
	buffer_load_dwordx4 v[32:35], v1, s[20:23], s3 offen offset:0 sc1
	buffer_load_dwordx4 v[36:39], v1, s[20:23], s3 offen offset:1024 sc1
	buffer_load_dwordx4 v[40:43], v1, s[20:23], s3 offen offset:2048 sc1
	buffer_load_dwordx4 v[44:47], v1, s[20:23], s3 offen offset:3072 sc1
	s_add_u32 s3, s72, 24576
	buffer_load_dwordx4 v[48:51], v1, s[20:23], s3 offen offset:0 sc1
	buffer_load_dwordx4 v[52:55], v1, s[20:23], s3 offen offset:1024 sc1
	buffer_load_dwordx4 v[56:59], v1, s[20:23], s3 offen offset:2048 sc1
	buffer_load_dwordx4 v[60:63], v1, s[20:23], s3 offen offset:3072 sc1
	s_waitcnt vmcnt(0)
	s_branch L_back57
L_slow58:
L_spin58:
	s_sleep 2
	s_add_u32 s3, s72, 20480
	buffer_load_dwordx4 v[88:91], v1, s[20:23], s3 offen offset:3072 sc1
	buffer_load_dwordx4 v[92:95], v250, s[20:23], s3 offen offset:3072 sc1
	s_waitcnt vmcnt(0)
	v_bitop3_b32 v88, v88, v251, s66 bitop3:0x78
	v_bitop3_b32 v92, v92, v251, s66 bitop3:0x78
	v_bitop3_b32 v89, v89, v252, s66 bitop3:0x78
	v_bitop3_b32 v93, v93, v252, s66 bitop3:0x78
	v_or3_b32 v254, v88, v92, v89
	v_bitop3_b32 v254, v254, v93, s66 bitop3:0xa8
	v_cmp_ne_u32 vcc, 0, v254
	s_add_u32 s69, s69, 1
	s_nop 1
	s_cbranch_vccz L_rest58
	s_cmp_lt_u32 s69, 0x10000
	s_cbranch_scc1 L_spin58
L_rest58:
	s_add_u32 s3, s72, 8192
	buffer_load_dwordx4 v[32:35], v1, s[20:23], s3 offen offset:0 sc1
	buffer_load_dwordx4 v[36:39], v1, s[20:23], s3 offen offset:1024 sc1
	buffer_load_dwordx4 v[40:43], v1, s[20:23], s3 offen offset:2048 sc1
	buffer_load_dwordx4 v[44:47], v1, s[20:23], s3 offen offset:3072 sc1
	s_add_u32 s3, s72, 24576
	buffer_load_dwordx4 v[48:51], v1, s[20:23], s3 offen offset:0 sc1
	buffer_load_dwordx4 v[52:55], v1, s[20:23], s3 offen offset:1024 sc1
	buffer_load_dwordx4 v[56:59], v1, s[20:23], s3 offen offset:2048 sc1
	buffer_load_dwordx4 v[60:63], v1, s[20:23], s3 offen offset:3072 sc1
	s_add_u32 s3, s72, 12288
	buffer_load_dwordx4 v[64:67], v1, s[20:23], s3 offen offset:0 sc1
	buffer_load_dwordx4 v[68:71], v1, s[20:23], s3 offen offset:1024 sc1
	s_waitcnt vmcnt(0)
	s_branch L_back58
L_slow59:
L_spin59:
	s_sleep 2
	s_add_u32 s3, s72, 8192
	buffer_load_dwordx4 v[32:35], v1, s[20:23], s3 offen offset:0 sc1
	buffer_load_dwordx4 v[36:39], v1, s[20:23], s3 offen offset:1024 sc1
	s_waitcnt vmcnt(0)
	v_bitop3_b32 v32, v32, v251, s66 bitop3:0x78
	v_bitop3_b32 v36, v36, v251, s66 bitop3:0x78
	v_bitop3_b32 v33, v33, v252, s66 bitop3:0x78
	v_bitop3_b32 v37, v37, v252, s66 bitop3:0x78
	v_or3_b32 v254, v32, v36, v33
	v_bitop3_b32 v254, v254, v37, s66 bitop3:0xa8
	v_cmp_ne_u32 vcc, 0, v254
	s_add_u32 s69, s69, 1
	s_nop 1
	s_cbranch_vccz L_rest59
	s_cmp_lt_u32 s69, 0x10000
	s_cbranch_scc1 L_spin59
L_rest59:
	buffer_load_dwordx4 v[40:43], v1, s[20:23], s3 offen offset:2048 sc1
	buffer_load_dwordx4 v[44:47], v1, s[20:23], s3 offen offset:3072 sc1
	s_add_u32 s3, s72, 24576
	buffer_load_dwordx4 v[48:51], v1, s[20:23], s3 offen offset:0 sc1
	buffer_load_dwordx4 v[52:55], v1, s[20:23], s3 offen offset:1024 sc1
	buffer_load_dwordx4 v[56:59], v1, s[20:23], s3 offen offset:2048 sc1
	buffer_load_dwordx4 v[60:63], v1, s[20:23], s3 offen offset:3072 sc1
	s_add_u32 s3, s72, 12288
	buffer_load_dwordx4 v[64:67], v1, s[20:23], s3 offen offset:0 sc1
	buffer_load_dwordx4 v[68:71], v1, s[20:23], s3 offen offset:1024 sc1
	buffer_load_dwordx4 v[72:75], v1, s[20:23], s3 offen offset:2048 sc1
	buffer_load_dwordx4 v[76:79], v1, s[20:23], s3 offen offset:3072 sc1
	s_waitcnt vmcnt(0)
	s_branch L_back59
L_slow60:
L_spin60:
	s_sleep 2
	s_add_u32 s3, s72, 8192
	buffer_load_dwordx4 v[40:43], v1, s[20:23], s3 offen offset:2048 sc1
	buffer_load_dwordx4 v[44:47], v1, s[20:23], s3 offen offset:3072 sc1
	s_waitcnt vmcnt(0)
	v_bitop3_b32 v40, v40, v251, s66 bitop3:0x78
	v_bitop3_b32 v44, v44, v251, s66 bitop3:0x78
	v_bitop3_b32 v41, v41, v252, s66 bitop3:0x78
	v_bitop3_b32 v45, v45, v252, s66 bitop3:0x78
	v_or3_b32 v254, v40, v44, v41
	v_bitop3_b32 v254, v254, v45, s66 bitop3:0xa8
	v_cmp_ne_u32 vcc, 0, v254
	s_add_u32 s69, s69, 1
	s_nop 1
	s_cbranch_vccz L_rest60
	s_cmp_lt_u32 s69, 0x10000
	s_cbranch_scc1 L_spin60
L_rest60:
	s_add_u32 s3, s72, 24576
	buffer_load_dwordx4 v[48:51], v1, s[20:23], s3 offen offset:0 sc1
	buffer_load_dwordx4 v[52:55], v1, s[20:23], s3 offen offset:1024 sc1
	buffer_load_dwordx4 v[56:59], v1, s[20:23], s3 offen offset:2048 sc1
	buffer_load_dwordx4 v[60:63], v1, s[20:23], s3 offen offset:3072 sc1
	s_add_u32 s3, s72, 12288
	buffer_load_dwordx4 v[64:67], v1, s[20:23], s3 offen offset:0 sc1
	buffer_load_dwordx4 v[68:71], v1, s[20:23], s3 offen offset:1024 sc1
	buffer_load_dwordx4 v[72:75], v1, s[20:23], s3 offen offset:2048 sc1
	buffer_load_dwordx4 v[76:79], v1, s[20:23], s3 offen offset:3072 sc1
	s_add_u32 s3, s72, 8192
	buffer_load_dwordx4 v[80:83], v250, s[20:23], s3 offen offset:0 sc1
	buffer_load_dwordx4 v[84:87], v250, s[20:23], s3 offen offset:1024 sc1
	s_waitcnt vmcnt(0)
	s_branch L_back60
L_slow61:
L_spin61:
	s_sleep 2
	s_add_u32 s3, s72, 24576
	buffer_load_dwordx4 v[48:51], v1, s[20:23], s3 offen offset:0 sc1
	buffer_load_dwordx4 v[52:55], v1, s[20:23], s3 offen offset:1024 sc1
	s_waitcnt vmcnt(0)
	v_bitop3_b32 v48, v48, v251, s66 bitop3:0x78
	v_bitop3_b32 v52, v52, v251, s66 bitop3:0x78
	v_bitop3_b32 v49, v49, v252, s66 bitop3:0x78
	v_bitop3_b32 v53, v53, v252, s66 bitop3:0x78
	v_or3_b32 v254, v48, v52, v49
	v_bitop3_b32 v254, v254, v53, s66 bitop3:0xa8
	v_cmp_ne_u32 vcc, 0, v254
	s_add_u32 s69, s69, 1
	s_nop 1
	s_cbranch_vccz L_rest61
	s_cmp_lt_u32 s69, 0x10000
	s_cbranch_scc1 L_spin61
L_rest61:
	buffer_load_dwordx4 v[56:59], v1, s[20:23], s3 offen offset:2048 sc1
	buffer_load_dwordx4 v[60:63], v1, s[20:23], s3 offen offset:3072 sc1
	s_add_u32 s3, s72, 12288
	buffer_load_dwordx4 v[64:67], v1, s[20:23], s3 offen offset:0 sc1
	buffer_load_dwordx4 v[68:71], v1, s[20:23], s3 offen offset:1024 sc1
	buffer_load_dwordx4 v[72:75], v1, s[20:23], s3 offen offset:2048 sc1
	buffer_load_dwordx4 v[76:79], v1, s[20:23], s3 offen offset:3072 sc1
	s_add_u32 s3, s72, 8192
	buffer_load_dwordx4 v[80:83], v250, s[20:23], s3 offen offset:0 sc1
	buffer_load_dwordx4 v[84:87], v250, s[20:23], s3 offen offset:1024 sc1
	buffer_load_dwordx4 v[88:91], v250, s[20:23], s3 offen offset:2048 sc1
	buffer_load_dwordx4 v[92:95], v250, s[20:23], s3 offen offset:3072 sc1
	s_waitcnt vmcnt(0)
	s_branch L_back61
L_slow62:
L_spin62:
	s_sleep 2
	s_add_u32 s3, s72, 24576
	buffer_load_dwordx4 v[56:59], v1, s[20:23], s3 offen offset:2048 sc1
	buffer_load_dwordx4 v[60:63], v1, s[20:23], s3 offen offset:3072 sc1
	s_waitcnt vmcnt(0)
	v_bitop3_b32 v56, v56, v251, s66 bitop3:0x78
	v_bitop3_b32 v60, v60, v251, s66 bitop3:0x78
	v_bitop3_b32 v57, v57, v252, s66 bitop3:0x78
	v_bitop3_b32 v61, v61, v252, s66 bitop3:0x78
	v_or3_b32 v254, v56, v60, v57
	v_bitop3_b32 v254, v254, v61, s66 bitop3:0xa8
	v_cmp_ne_u32 vcc, 0, v254
	s_add_u32 s69, s69, 1
	s_nop 1
	s_cbranch_vccz L_rest62
	s_cmp_lt_u32 s69, 0x10000
	s_cbranch_scc1 L_spin62
L_rest62:
	s_add_u32 s3, s72, 12288
	buffer_load_dwordx4 v[64:67], v1, s[20:23], s3 offen offset:0 sc1
	buffer_load_dwordx4 v[68:71], v1, s[20:23], s3 offen offset:1024 sc1
	buffer_load_dwordx4 v[72:75], v1, s[20:23], s3 offen offset:2048 sc1
	buffer_load_dwordx4 v[76:79], v1, s[20:23], s3 offen offset:3072 sc1
	s_add_u32 s3, s72, 8192
	buffer_load_dwordx4 v[80:83], v250, s[20:23], s3 offen offset:0 sc1
	buffer_load_dwordx4 v[84:87], v250, s[20:23], s3 offen offset:1024 sc1
	buffer_load_dwordx4 v[88:91], v250, s[20:23], s3 offen offset:2048 sc1
	buffer_load_dwordx4 v[92:95], v250, s[20:23], s3 offen offset:3072 sc1
	s_add_u32 s3, s72, 24576
	buffer_load_dwordx4 v[32:35], v250, s[20:23], s3 offen offset:0 sc1
	buffer_load_dwordx4 v[36:39], v250, s[20:23], s3 offen offset:1024 sc1
	s_waitcnt vmcnt(0)
	s_branch L_back62
L_slow63:
L_spin63:
	s_sleep 2
	s_add_u32 s3, s72, 12288
	buffer_load_dwordx4 v[64:67], v1, s[20:23], s3 offen offset:0 sc1
	buffer_load_dwordx4 v[68:71], v1, s[20:23], s3 offen offset:1024 sc1
	s_waitcnt vmcnt(0)
	v_bitop3_b32 v64, v64, v251, s66 bitop3:0x78
	v_bitop3_b32 v68, v68, v251, s66 bitop3:0x78
	v_bitop3_b32 v65, v65, v252, s66 bitop3:0x78
	v_bitop3_b32 v69, v69, v252, s66 bitop3:0x78
	v_or3_b32 v254, v64, v68, v65
	v_bitop3_b32 v254, v254, v69, s66 bitop3:0xa8
	v_cmp_ne_u32 vcc, 0, v254
	s_add_u32 s69, s69, 1
	s_nop 1
	s_cbranch_vccz L_rest63
	s_cmp_lt_u32 s69, 0x10000
	s_cbranch_scc1 L_spin63
L_rest63:
	buffer_load_dwordx4 v[72:75], v1, s[20:23], s3 offen offset:2048 sc1
	buffer_load_dwordx4 v[76:79], v1, s[20:23], s3 offen offset:3072 sc1
	s_add_u32 s3, s72, 8192
	buffer_load_dwordx4 v[80:83], v250, s[20:23], s3 offen offset:0 sc1
	buffer_load_dwordx4 v[84:87], v250, s[20:23], s3 offen offset:1024 sc1
	buffer_load_dwordx4 v[88:91], v250, s[20:23], s3 offen offset:2048 sc1
	buffer_load_dwordx4 v[92:95], v250, s[20:23], s3 offen offset:3072 sc1
	s_add_u32 s3, s72, 24576
	buffer_load_dwordx4 v[32:35], v250, s[20:23], s3 offen offset:0 sc1
	buffer_load_dwordx4 v[36:39], v250, s[20:23], s3 offen offset:1024 sc1
	buffer_load_dwordx4 v[40:43], v250, s[20:23], s3 offen offset:2048 sc1
	buffer_load_dwordx4 v[44:47], v250, s[20:23], s3 offen offset:3072 sc1
	s_waitcnt vmcnt(0)
	s_branch L_back63
L_slow64:
L_spin64:
	s_sleep 2
	s_add_u32 s3, s72, 12288
	buffer_load_dwordx4 v[72:75], v1, s[20:23], s3 offen offset:2048 sc1
	buffer_load_dwordx4 v[76:79], v1, s[20:23], s3 offen offset:3072 sc1
	s_waitcnt vmcnt(0)
	v_bitop3_b32 v72, v72, v251, s66 bitop3:0x78
	v_bitop3_b32 v76, v76, v251, s66 bitop3:0x78
	v_bitop3_b32 v73, v73, v252, s66 bitop3:0x78
	v_bitop3_b32 v77, v77, v252, s66 bitop3:0x78
	v_or3_b32 v254, v72, v76, v73
	v_bitop3_b32 v254, v254, v77, s66 bitop3:0xa8
	v_cmp_ne_u32 vcc, 0, v254
	s_add_u32 s69, s69, 1
	s_nop 1
	s_cbranch_vccz L_rest64
	s_cmp_lt_u32 s69, 0x10000
	s_cbranch_scc1 L_spin64
L_rest64:
	s_add_u32 s3, s72, 8192
	buffer_load_dwordx4 v[80:83], v250, s[20:23], s3 offen offset:0 sc1
	buffer_load_dwordx4 v[84:87], v250, s[20:23], s3 offen offset:1024 sc1
	buffer_load_dwordx4 v[88:91], v250, s[20:23], s3 offen offset:2048 sc1
	buffer_load_dwordx4 v[92:95], v250, s[20:23], s3 offen offset:3072 sc1
	s_add_u32 s3, s72, 24576
	buffer_load_dwordx4 v[32:35], v250, s[20:23], s3 offen offset:0 sc1
	buffer_load_dwordx4 v[36:39], v250, s[20:23], s3 offen offset:1024 sc1
	buffer_load_dwordx4 v[40:43], v250, s[20:23], s3 offen offset:2048 sc1
	buffer_load_dwordx4 v[44:47], v250, s[20:23], s3 offen offset:3072 sc1
	s_add_u32 s3, s72, 12288
	buffer_load_dwordx4 v[48:51], v250, s[20:23], s3 offen offset:0 sc1
	buffer_load_dwordx4 v[52:55], v250, s[20:23], s3 offen offset:1024 sc1
	s_waitcnt vmcnt(0)
	s_branch L_back64
L_slow65:
L_spin65:
	s_sleep 2
	buffer_load_dwordx4 v[240:243], v14, s[20:23], s47 offen sc1
	buffer_load_dwordx4 v[244:247], v14, s[20:23], s47 offen offset:512 sc1
	s_waitcnt vmcnt(0)
	v_cmp_ne_u64 vcc, s[60:61], v[240:241]
	v_cmp_ne_u64 s[84:85], s[60:61], v[244:245]
	s_nop 0
	s_or_b64 vcc, vcc, s[84:85]
	s_add_u32 s69, s69, 1
	s_nop 1
	s_cbranch_vccz L_back65
	s_cmp_lt_u32 s69, 0x10000
	s_cbranch_scc1 L_spin65
	s_branch L_back65
L_slow66:
L_spin66:
	s_sleep 2
	s_add_u32 s3, s72, 8192
	buffer_load_dwordx4 v[80:83], v250, s[20:23], s3 offen offset:0 sc1
	buffer_load_dwordx4 v[84:87], v250, s[20:23], s3 offen offset:1024 sc1
	s_waitcnt vmcnt(0)
	v_bitop3_b32 v80, v80, v251, s66 bitop3:0x78
	v_bitop3_b32 v84, v84, v251, s66 bitop3:0x78
	v_bitop3_b32 v81, v81, v252, s66 bitop3:0x78
	v_bitop3_b32 v85, v85, v252, s66 bitop3:0x78
	v_or3_b32 v254, v80, v84, v81
	v_bitop3_b32 v254, v254, v85, s66 bitop3:0xa8
	v_cmp_ne_u32 vcc, 0, v254
	s_add_u32 s69, s69, 1
	s_nop 1
	s_cbranch_vccz L_rest66
	s_cmp_lt_u32 s69, 0x10000
	s_cbranch_scc1 L_spin66
L_rest66:
	buffer_load_dwordx4 v[88:91], v250, s[20:23], s3 offen offset:2048 sc1
	buffer_load_dwordx4 v[92:95], v250, s[20:23], s3 offen offset:3072 sc1
	s_add_u32 s3, s72, 24576
	buffer_load_dwordx4 v[32:35], v250, s[20:23], s3 offen offset:0 sc1
	buffer_load_dwordx4 v[36:39], v250, s[20:23], s3 offen offset:1024 sc1
	buffer_load_dwordx4 v[40:43], v250, s[20:23], s3 offen offset:2048 sc1
	buffer_load_dwordx4 v[44:47], v250, s[20:23], s3 offen offset:3072 sc1
	s_add_u32 s3, s72, 12288
	buffer_load_dwordx4 v[48:51], v250, s[20:23], s3 offen offset:0 sc1
	buffer_load_dwordx4 v[52:55], v250, s[20:23], s3 offen offset:1024 sc1
	buffer_load_dwordx4 v[56:59], v250, s[20:23], s3 offen offset:2048 sc1
	buffer_load_dwordx4 v[60:63], v250, s[20:23], s3 offen offset:3072 sc1
	s_waitcnt vmcnt(0)
	s_branch L_back66
L_slow67:
L_spin67:
	s_sleep 2
	s_add_u32 s3, s72, 8192
	buffer_load_dwordx4 v[88:91], v250, s[20:23], s3 offen offset:2048 sc1
	buffer_load_dwordx4 v[92:95], v250, s[20:23], s3 offen offset:3072 sc1
	s_waitcnt vmcnt(0)
	v_bitop3_b32 v88, v88, v251, s66 bitop3:0x78
	v_bitop3_b32 v92, v92, v251, s66 bitop3:0x78
	v_bitop3_b32 v89, v89, v252, s66 bitop3:0x78
	v_bitop3_b32 v93, v93, v252, s66 bitop3:0x78
	v_or3_b32 v254, v88, v92, v89
	v_bitop3_b32 v254, v254, v93, s66 bitop3:0xa8
	v_cmp_ne_u32 vcc, 0, v254
	s_add_u32 s69, s69, 1
	s_nop 1
	s_cbranch_vccz L_rest67
	s_cmp_lt_u32 s69, 0x10000
	s_cbranch_scc1 L_spin67
L_rest67:
	s_add_u32 s3, s72, 24576
	buffer_load_dwordx4 v[32:35], v250, s[20:23], s3 offen offset:0 sc1
	buffer_load_dwordx4 v[36:39], v250, s[20:23], s3 offen offset:1024 sc1
	buffer_load_dwordx4 v[40:43], v250, s[20:23], s3 offen offset:2048 sc1
	buffer_load_dwordx4 v[44:47], v250, s[20:23], s3 offen offset:3072 sc1
	s_add_u32 s3, s72, 12288
	buffer_load_dwordx4 v[48:51], v250, s[20:23], s3 offen offset:0 sc1
	buffer_load_dwordx4 v[52:55], v250, s[20:23], s3 offen offset:1024 sc1
	buffer_load_dwordx4 v[56:59], v250, s[20:23], s3 offen offset:2048 sc1
	buffer_load_dwordx4 v[60:63], v250, s[20:23], s3 offen offset:3072 sc1
	s_add_u32 s3, s73, 0
	buffer_load_dwordx4 v[64:67], v1, s[20:23], s3 offen offset:0 sc1
	buffer_load_dwordx4 v[68:71], v1, s[20:23], s3 offen offset:1024 sc1
	s_waitcnt vmcnt(0)
	s_branch L_back67
L_slow68:
L_spin68:
	s_sleep 2
	s_add_u32 s3, s72, 24576
	buffer_load_dwordx4 v[32:35], v250, s[20:23], s3 offen offset:0 sc1
	buffer_load_dwordx4 v[36:39], v250, s[20:23], s3 offen offset:1024 sc1
	s_waitcnt vmcnt(0)
	v_bitop3_b32 v32, v32, v251, s66 bitop3:0x78
	v_bitop3_b32 v36, v36, v251, s66 bitop3:0x78
	v_bitop3_b32 v33, v33, v252, s66 bitop3:0x78
	v_bitop3_b32 v37, v37, v252, s66 bitop3:0x78
	v_or3_b32 v254, v32, v36, v33
	v_bitop3_b32 v254, v254, v37, s66 bitop3:0xa8
	v_cmp_ne_u32 vcc, 0, v254
	s_add_u32 s69, s69, 1
	s_nop 1
	s_cbranch_vccz L_rest68
	s_cmp_lt_u32 s69, 0x10000
	s_cbranch_scc1 L_spin68
L_rest68:
	buffer_load_dwordx4 v[40:43], v250, s[20:23], s3 offen offset:2048 sc1
	buffer_load_dwordx4 v[44:47], v250, s[20:23], s3 offen offset:3072 sc1
	s_add_u32 s3, s72, 12288
	buffer_load_dwordx4 v[48:51], v250, s[20:23], s3 offen offset:0 sc1
	buffer_load_dwordx4 v[52:55], v250, s[20:23], s3 offen offset:1024 sc1
	buffer_load_dwordx4 v[56:59], v250, s[20:23], s3 offen offset:2048 sc1
	buffer_load_dwordx4 v[60:63], v250, s[20:23], s3 offen offset:3072 sc1
	s_add_u32 s3, s73, 0
	buffer_load_dwordx4 v[64:67], v1, s[20:23], s3 offen offset:0 sc1
	buffer_load_dwordx4 v[68:71], v1, s[20:23], s3 offen offset:1024 sc1
	buffer_load_dwordx4 v[72:75], v1, s[20:23], s3 offen offset:2048 sc1
	buffer_load_dwordx4 v[76:79], v1, s[20:23], s3 offen offset:3072 sc1
	s_waitcnt vmcnt(0)
	s_branch L_back68
L_slow69:
L_spin69:
	s_sleep 2
	s_add_u32 s3, s72, 24576
	buffer_load_dwordx4 v[40:43], v250, s[20:23], s3 offen offset:2048 sc1
	buffer_load_dwordx4 v[44:47], v250, s[20:23], s3 offen offset:3072 sc1
	s_waitcnt vmcnt(0)
	v_bitop3_b32 v40, v40, v251, s66 bitop3:0x78
	v_bitop3_b32 v44, v44, v251, s66 bitop3:0x78
	v_bitop3_b32 v41, v41, v252, s66 bitop3:0x78
	v_bitop3_b32 v45, v45, v252, s66 bitop3:0x78
	v_or3_b32 v254, v40, v44, v41
	v_bitop3_b32 v254, v254, v45, s66 bitop3:0xa8
	v_cmp_ne_u32 vcc, 0, v254
	s_add_u32 s69, s69, 1
	s_nop 1
	s_cbranch_vccz L_rest69
	s_cmp_lt_u32 s69, 0x10000
	s_cbranch_scc1 L_spin69
L_rest69:
	s_add_u32 s3, s72, 12288
	buffer_load_dwordx4 v[48:51], v250, s[20:23], s3 offen offset:0 sc1
	buffer_load_dwordx4 v[52:55], v250, s[20:23], s3 offen offset:1024 sc1
	buffer_load_dwordx4 v[56:59], v250, s[20:23], s3 offen offset:2048 sc1
	buffer_load_dwordx4 v[60:63], v250, s[20:23], s3 offen offset:3072 sc1
	s_add_u32 s3, s73, 0
	buffer_load_dwordx4 v[64:67], v1, s[20:23], s3 offen offset:0 sc1
	buffer_load_dwordx4 v[68:71], v1, s[20:23], s3 offen offset:1024 sc1
	buffer_load_dwordx4 v[72:75], v1, s[20:23], s3 offen offset:2048 sc1
	buffer_load_dwordx4 v[76:79], v1, s[20:23], s3 offen offset:3072 sc1
	s_add_u32 s3, s73, 4096
	buffer_load_dwordx4 v[80:83], v1, s[20:23], s3 offen offset:0 sc1
	buffer_load_dwordx4 v[84:87], v1, s[20:23], s3 offen offset:1024 sc1
	s_waitcnt vmcnt(0)
	s_branch L_back69
L_slow70:
L_spin70:
	s_sleep 2
	s_add_u32 s3, s72, 12288
	buffer_load_dwordx4 v[48:51], v250, s[20:23], s3 offen offset:0 sc1
	buffer_load_dwordx4 v[52:55], v250, s[20:23], s3 offen offset:1024 sc1
	s_waitcnt vmcnt(0)
	v_bitop3_b32 v48, v48, v251, s66 bitop3:0x78
	v_bitop3_b32 v52, v52, v251, s66 bitop3:0x78
	v_bitop3_b32 v49, v49, v252, s66 bitop3:0x78
	v_bitop3_b32 v53, v53, v252, s66 bitop3:0x78
	v_or3_b32 v254, v48, v52, v49
	v_bitop3_b32 v254, v254, v53, s66 bitop3:0xa8
	v_cmp_ne_u32 vcc, 0, v254
	s_add_u32 s69, s69, 1
	s_nop 1
	s_cbranch_vccz L_rest70
	s_cmp_lt_u32 s69, 0x10000
	s_cbranch_scc1 L_spin70
L_rest70:
	buffer_load_dwordx4 v[56:59], v250, s[20:23], s3 offen offset:2048 sc1
	buffer_load_dwordx4 v[60:63], v250, s[20:23], s3 offen offset:3072 sc1
	s_add_u32 s3, s73, 0
	buffer_load_dwordx4 v[64:67], v1, s[20:23], s3 offen offset:0 sc1
	buffer_load_dwordx4 v[68:71], v1, s[20:23], s3 offen offset:1024 sc1
	buffer_load_dwordx4 v[72:75], v1, s[20:23], s3 offen offset:2048 sc1
	buffer_load_dwordx4 v[76:79], v1, s[20:23], s3 offen offset:3072 sc1
	s_add_u32 s3, s73, 4096
	buffer_load_dwordx4 v[80:83], v1, s[20:23], s3 offen offset:0 sc1
	buffer_load_dwordx4 v[84:87], v1, s[20:23], s3 offen offset:1024 sc1
	buffer_load_dwordx4 v[88:91], v1, s[20:23], s3 offen offset:2048 sc1
	buffer_load_dwordx4 v[92:95], v1, s[20:23], s3 offen offset:3072 sc1
	s_waitcnt vmcnt(0)
	s_branch L_back70
L_slow71:
L_spin71:
	s_sleep 2
	s_add_u32 s3, s72, 12288
	buffer_load_dwordx4 v[56:59], v250, s[20:23], s3 offen offset:2048 sc1
	buffer_load_dwordx4 v[60:63], v250, s[20:23], s3 offen offset:3072 sc1
	s_waitcnt vmcnt(0)
	v_bitop3_b32 v56, v56, v251, s66 bitop3:0x78
	v_bitop3_b32 v60, v60, v251, s66 bitop3:0x78
	v_bitop3_b32 v57, v57, v252, s66 bitop3:0x78
	v_bitop3_b32 v61, v61, v252, s66 bitop3:0x78
	v_or3_b32 v254, v56, v60, v57
	v_bitop3_b32 v254, v254, v61, s66 bitop3:0xa8
	v_cmp_ne_u32 vcc, 0, v254
	s_add_u32 s69, s69, 1
	s_nop 1
	s_cbranch_vccz L_rest71
	s_cmp_lt_u32 s69, 0x10000
	s_cbranch_scc1 L_spin71
L_rest71:
	s_add_u32 s3, s73, 0
	buffer_load_dwordx4 v[64:67], v1, s[20:23], s3 offen offset:0 sc1
	buffer_load_dwordx4 v[68:71], v1, s[20:23], s3 offen offset:1024 sc1
	buffer_load_dwordx4 v[72:75], v1, s[20:23], s3 offen offset:2048 sc1
	buffer_load_dwordx4 v[76:79], v1, s[20:23], s3 offen offset:3072 sc1
	s_add_u32 s3, s73, 4096
	buffer_load_dwordx4 v[80:83], v1, s[20:23], s3 offen offset:0 sc1
	buffer_load_dwordx4 v[84:87], v1, s[20:23], s3 offen offset:1024 sc1
	buffer_load_dwordx4 v[88:91], v1, s[20:23], s3 offen offset:2048 sc1
	buffer_load_dwordx4 v[92:95], v1, s[20:23], s3 offen offset:3072 sc1
	s_add_u32 s3, s73, 0
	buffer_load_dwordx4 v[32:35], v250, s[20:23], s3 offen offset:0 sc1
	buffer_load_dwordx4 v[36:39], v250, s[20:23], s3 offen offset:1024 sc1
	s_waitcnt vmcnt(0)
	s_branch L_back71
L_slow72:
L_spin72:
	s_sleep 2
	s_add_u32 s3, s73, 0
	buffer_load_dwordx4 v[64:67], v1, s[20:23], s3 offen offset:0 sc1
	buffer_load_dwordx4 v[68:71], v1, s[20:23], s3 offen offset:1024 sc1
	s_waitcnt vmcnt(0)
	v_bitop3_b32 v64, v64, v251, s63 bitop3:0x78
	v_bitop3_b32 v68, v68, v251, s63 bitop3:0x78
	v_bitop3_b32 v65, v65, v252, s63 bitop3:0x78
	v_bitop3_b32 v69, v69, v252, s63 bitop3:0x78
	v_or3_b32 v254, v64, v68, v65
	v_bitop3_b32 v254, v254, v69, s63 bitop3:0xa8
	v_cmp_ne_u32 vcc, 0, v254
	s_add_u32 s69, s69, 1
	s_nop 1
	s_cbranch_vccz L_rest72
	s_cmp_lt_u32 s69, 0x10000
	s_cbranch_scc1 L_spin72
L_rest72:
	buffer_load_dwordx4 v[72:75], v1, s[20:23], s3 offen offset:2048 sc1
	buffer_load_dwordx4 v[76:79], v1, s[20:23], s3 offen offset:3072 sc1
	s_add_u32 s3, s73, 4096
	buffer_load_dwordx4 v[80:83], v1, s[20:23], s3 offen offset:0 sc1
	buffer_load_dwordx4 v[84:87], v1, s[20:23], s3 offen offset:1024 sc1
	buffer_load_dwordx4 v[88:91], v1, s[20:23], s3 offen offset:2048 sc1
	buffer_load_dwordx4 v[92:95], v1, s[20:23], s3 offen offset:3072 sc1
	s_add_u32 s3, s73, 0
	buffer_load_dwordx4 v[32:35], v250, s[20:23], s3 offen offset:0 sc1
	buffer_load_dwordx4 v[36:39], v250, s[20:23], s3 offen offset:1024 sc1
	buffer_load_dwordx4 v[40:43], v250, s[20:23], s3 offen offset:2048 sc1
	buffer_load_dwordx4 v[44:47], v250, s[20:23], s3 offen offset:3072 sc1
	s_waitcnt vmcnt(0)
	s_branch L_back72
L_slow73:
L_spin73:
	s_sleep 2
	s_add_u32 s3, s73, 0
	buffer_load_dwordx4 v[72:75], v1, s[20:23], s3 offen offset:2048 sc1
	buffer_load_dwordx4 v[76:79], v1, s[20:23], s3 offen offset:3072 sc1
	s_waitcnt vmcnt(0)
	v_bitop3_b32 v72, v72, v251, s63 bitop3:0x78
	v_bitop3_b32 v76, v76, v251, s63 bitop3:0x78
	v_bitop3_b32 v73, v73, v252, s63 bitop3:0x78
	v_bitop3_b32 v77, v77, v252, s63 bitop3:0x78
	v_or3_b32 v254, v72, v76, v73
	v_bitop3_b32 v254, v254, v77, s63 bitop3:0xa8
	v_cmp_ne_u32 vcc, 0, v254
	s_add_u32 s69, s69, 1
	s_nop 1
	s_cbranch_vccz L_rest73
	s_cmp_lt_u32 s69, 0x10000
	s_cbranch_scc1 L_spin73
L_rest73:
	s_add_u32 s3, s73, 4096
	buffer_load_dwordx4 v[80:83], v1, s[20:23], s3 offen offset:0 sc1
	buffer_load_dwordx4 v[84:87], v1, s[20:23], s3 offen offset:1024 sc1
	buffer_load_dwordx4 v[88:91], v1, s[20:23], s3 offen offset:2048 sc1
	buffer_load_dwordx4 v[92:95], v1, s[20:23], s3 offen offset:3072 sc1
	s_add_u32 s3, s73, 0
	buffer_load_dwordx4 v[32:35], v250, s[20:23], s3 offen offset:0 sc1
	buffer_load_dwordx4 v[36:39], v250, s[20:23], s3 offen offset:1024 sc1
	buffer_load_dwordx4 v[40:43], v250, s[20:23], s3 offen offset:2048 sc1
	buffer_load_dwordx4 v[44:47], v250, s[20:23], s3 offen offset:3072 sc1
	s_add_u32 s3, s73, 4096
	buffer_load_dwordx4 v[48:51], v250, s[20:23], s3 offen offset:0 sc1
	buffer_load_dwordx4 v[52:55], v250, s[20:23], s3 offen offset:1024 sc1
	s_waitcnt vmcnt(0)
	s_branch L_back73
L_slow74:
L_spin74:
	s_sleep 2
	s_add_u32 s3, s73, 4096
	buffer_load_dwordx4 v[80:83], v1, s[20:23], s3 offen offset:0 sc1
	buffer_load_dwordx4 v[84:87], v1, s[20:23], s3 offen offset:1024 sc1
	s_waitcnt vmcnt(0)
	v_bitop3_b32 v80, v80, v251, s63 bitop3:0x78
	v_bitop3_b32 v84, v84, v251, s63 bitop3:0x78
	v_bitop3_b32 v81, v81, v252, s63 bitop3:0x78
	v_bitop3_b32 v85, v85, v252, s63 bitop3:0x78
	v_or3_b32 v254, v80, v84, v81
	v_bitop3_b32 v254, v254, v85, s63 bitop3:0xa8
	v_cmp_ne_u32 vcc, 0, v254
	s_add_u32 s69, s69, 1
	s_nop 1
	s_cbranch_vccz L_rest74
	s_cmp_lt_u32 s69, 0x10000
	s_cbranch_scc1 L_spin74
L_rest74:
	buffer_load_dwordx4 v[88:91], v1, s[20:23], s3 offen offset:2048 sc1
	buffer_load_dwordx4 v[92:95], v1, s[20:23], s3 offen offset:3072 sc1
	s_add_u32 s3, s73, 0
	buffer_load_dwordx4 v[32:35], v250, s[20:23], s3 offen offset:0 sc1
	buffer_load_dwordx4 v[36:39], v250, s[20:23], s3 offen offset:1024 sc1
	buffer_load_dwordx4 v[40:43], v250, s[20:23], s3 offen offset:2048 sc1
	buffer_load_dwordx4 v[44:47], v250, s[20:23], s3 offen offset:3072 sc1
	s_add_u32 s3, s73, 4096
	buffer_load_dwordx4 v[48:51], v250, s[20:23], s3 offen offset:0 sc1
	buffer_load_dwordx4 v[52:55], v250, s[20:23], s3 offen offset:1024 sc1
	buffer_load_dwordx4 v[56:59], v250, s[20:23], s3 offen offset:2048 sc1
	buffer_load_dwordx4 v[60:63], v250, s[20:23], s3 offen offset:3072 sc1
	s_waitcnt vmcnt(0)
	s_branch L_back74
L_slow75:
L_spin75:
	s_sleep 2
	s_add_u32 s3, s73, 4096
	buffer_load_dwordx4 v[88:91], v1, s[20:23], s3 offen offset:2048 sc1
	buffer_load_dwordx4 v[92:95], v1, s[20:23], s3 offen offset:3072 sc1
	s_waitcnt vmcnt(0)
	v_bitop3_b32 v88, v88, v251, s63 bitop3:0x78
	v_bitop3_b32 v92, v92, v251, s63 bitop3:0x78
	v_bitop3_b32 v89, v89, v252, s63 bitop3:0x78
	v_bitop3_b32 v93, v93, v252, s63 bitop3:0x78
	v_or3_b32 v254, v88, v92, v89
	v_bitop3_b32 v254, v254, v93, s63 bitop3:0xa8
	v_cmp_ne_u32 vcc, 0, v254
	s_add_u32 s69, s69, 1
	s_nop 1
	s_cbranch_vccz L_rest75
	s_cmp_lt_u32 s69, 0x10000
	s_cbranch_scc1 L_spin75
L_rest75:
	s_add_u32 s3, s73, 0
	buffer_load_dwordx4 v[32:35], v250, s[20:23], s3 offen offset:0 sc1
	buffer_load_dwordx4 v[36:39], v250, s[20:23], s3 offen offset:1024 sc1
	buffer_load_dwordx4 v[40:43], v250, s[20:23], s3 offen offset:2048 sc1
	buffer_load_dwordx4 v[44:47], v250, s[20:23], s3 offen offset:3072 sc1
	s_add_u32 s3, s73, 4096
	buffer_load_dwordx4 v[48:51], v250, s[20:23], s3 offen offset:0 sc1
	buffer_load_dwordx4 v[52:55], v250, s[20:23], s3 offen offset:1024 sc1
	buffer_load_dwordx4 v[56:59], v250, s[20:23], s3 offen offset:2048 sc1
	buffer_load_dwordx4 v[60:63], v250, s[20:23], s3 offen offset:3072 sc1
	s_waitcnt vmcnt(0)
	s_branch L_back75
L_slow76:
L_spin76:
	s_sleep 2
	s_add_u32 s3, s73, 0
	buffer_load_dwordx4 v[32:35], v250, s[20:23], s3 offen offset:0 sc1
	buffer_load_dwordx4 v[36:39], v250, s[20:23], s3 offen offset:1024 sc1
	s_waitcnt vmcnt(0)
	v_bitop3_b32 v32, v32, v251, s63 bitop3:0x78
	v_bitop3_b32 v36, v36, v251, s63 bitop3:0x78
	v_bitop3_b32 v33, v33, v252, s63 bitop3:0x78
	v_bitop3_b32 v37, v37, v252, s63 bitop3:0x78
	v_or3_b32 v254, v32, v36, v33
	v_bitop3_b32 v254, v254, v37, s63 bitop3:0xa8
	v_cmp_ne_u32 vcc, 0, v254
	s_add_u32 s69, s69, 1
	s_nop 1
	s_cbranch_vccz L_rest76
	s_cmp_lt_u32 s69, 0x10000
	s_cbranch_scc1 L_spin76
L_rest76:
	buffer_load_dwordx4 v[40:43], v250, s[20:23], s3 offen offset:2048 sc1
	buffer_load_dwordx4 v[44:47], v250, s[20:23], s3 offen offset:3072 sc1
	s_add_u32 s3, s73, 4096
	buffer_load_dwordx4 v[48:51], v250, s[20:23], s3 offen offset:0 sc1
	buffer_load_dwordx4 v[52:55], v250, s[20:23], s3 offen offset:1024 sc1
	buffer_load_dwordx4 v[56:59], v250, s[20:23], s3 offen offset:2048 sc1
	buffer_load_dwordx4 v[60:63], v250, s[20:23], s3 offen offset:3072 sc1
	s_waitcnt vmcnt(0)
	s_branch L_back76
L_slow77:
L_spin77:
	s_sleep 2
	s_add_u32 s3, s73, 0
	buffer_load_dwordx4 v[40:43], v250, s[20:23], s3 offen offset:2048 sc1
	buffer_load_dwordx4 v[44:47], v250, s[20:23], s3 offen offset:3072 sc1
	s_waitcnt vmcnt(0)
	v_bitop3_b32 v40, v40, v251, s63 bitop3:0x78
	v_bitop3_b32 v44, v44, v251, s63 bitop3:0x78
	v_bitop3_b32 v41, v41, v252, s63 bitop3:0x78
	v_bitop3_b32 v45, v45, v252, s63 bitop3:0x78
	v_or3_b32 v254, v40, v44, v41
	v_bitop3_b32 v254, v254, v45, s63 bitop3:0xa8
	v_cmp_ne_u32 vcc, 0, v254
	s_add_u32 s69, s69, 1
	s_nop 1
	s_cbranch_vccz L_rest77
	s_cmp_lt_u32 s69, 0x10000
	s_cbranch_scc1 L_spin77
L_rest77:
	s_add_u32 s3, s73, 4096
	buffer_load_dwordx4 v[48:51], v250, s[20:23], s3 offen offset:0 sc1
	buffer_load_dwordx4 v[52:55], v250, s[20:23], s3 offen offset:1024 sc1
	buffer_load_dwordx4 v[56:59], v250, s[20:23], s3 offen offset:2048 sc1
	buffer_load_dwordx4 v[60:63], v250, s[20:23], s3 offen offset:3072 sc1
	s_waitcnt vmcnt(0)
	s_branch L_back77
L_slow78:
L_spin78:
	s_sleep 2
	s_add_u32 s3, s73, 4096
	buffer_load_dwordx4 v[48:51], v250, s[20:23], s3 offen offset:0 sc1
	buffer_load_dwordx4 v[52:55], v250, s[20:23], s3 offen offset:1024 sc1
	s_waitcnt vmcnt(0)
	v_bitop3_b32 v48, v48, v251, s63 bitop3:0x78
	v_bitop3_b32 v52, v52, v251, s63 bitop3:0x78
	v_bitop3_b32 v49, v49, v252, s63 bitop3:0x78
	v_bitop3_b32 v53, v53, v252, s63 bitop3:0x78
	v_or3_b32 v254, v48, v52, v49
	v_bitop3_b32 v254, v254, v53, s63 bitop3:0xa8
	v_cmp_ne_u32 vcc, 0, v254
	s_add_u32 s69, s69, 1
	s_nop 1
	s_cbranch_vccz L_rest78
	s_cmp_lt_u32 s69, 0x10000
	s_cbranch_scc1 L_spin78
L_rest78:
	buffer_load_dwordx4 v[56:59], v250, s[20:23], s3 offen offset:2048 sc1
	buffer_load_dwordx4 v[60:63], v250, s[20:23], s3 offen offset:3072 sc1
	s_waitcnt vmcnt(0)
	s_branch L_back78
L_slow79:
L_spin79:
	s_sleep 2
	s_add_u32 s3, s73, 4096
	buffer_load_dwordx4 v[56:59], v250, s[20:23], s3 offen offset:2048 sc1
	buffer_load_dwordx4 v[60:63], v250, s[20:23], s3 offen offset:3072 sc1
	s_waitcnt vmcnt(0)
	v_bitop3_b32 v56, v56, v251, s63 bitop3:0x78
	v_bitop3_b32 v60, v60, v251, s63 bitop3:0x78
	v_bitop3_b32 v57, v57, v252, s63 bitop3:0x78
	v_bitop3_b32 v61, v61, v252, s63 bitop3:0x78
	v_or3_b32 v254, v56, v60, v57
	v_bitop3_b32 v254, v254, v61, s63 bitop3:0xa8
	v_cmp_ne_u32 vcc, 0, v254
	s_add_u32 s69, s69, 1
	s_nop 1
	s_cbranch_vccz L_back79
	s_cmp_lt_u32 s69, 0x10000
	s_cbranch_scc1 L_spin79
	s_branch L_back79
L_last:
.section .rodata,"a"
.p2align 6
.amdhsa_kernel recurrent_scan__linear_attn_block__dense_activation_squared_relu__prompt_kernel
  .amdhsa_next_free_vgpr 512
  .amdhsa_next_free_sgpr 102
  .amdhsa_accum_offset 256
  .amdhsa_group_segment_fixed_size 0
  .amdhsa_kernarg_size 88
  .amdhsa_user_sgpr_count 2
  .amdhsa_user_sgpr_kernarg_segment_ptr 1
  .amdhsa_system_sgpr_workgroup_id_x 1
.end_amdhsa_kernel
```
